```python
import torch

def _softmax(x, axis=-1):
    return torch.softmax(x, dim=axis)

def _gelu(x):
    return torch.nn.functional.gelu(x, approximate='tanh')

def _silu(x):
    return torch.nn.functional.silu(x)

def _sigmoid(x):
    return torch.sigmoid(x)

def _layernorm(x, axis=-1, eps=1e-05):
    m = x.mean(dim=axis, keepdim=True)
    v = x.var(dim=axis, keepdim=True, unbiased=False)
    return (x - m) / torch.sqrt(v + eps)

def _scatter_add(tgt, idx, src, axis=0):
    return tgt.clone().index_add_(axis, idx, src)

def _segment_sum(src, seg, n):
    out = torch.zeros((n,) + src.shape[1:], dtype=src.dtype)
    return out.index_add_(0, seg, src)

def _pad(x, pw):
    flat = tuple((v for pair in reversed(pw) for v in pair))
    return torch.nn.functional.pad(x, flat)
kernel_name = 'interleave_layers__memory_aug_recurrent_mem_tr__glu_gated_bilinear__prompt'

def setup_inputs():

    _w = lambda a: (lambda t: t.to(torch.bfloat16) if t.is_floating_point() else t)(torch.as_tensor(a))

    def _A_setup():
        B, S, Dm = (1, 2048, 512)
        H, Dh = (32, 128)
        M, seg = (8, 32)
        seg = min(seg, S)
        S = S // seg * seg
        return {'x': _w((lambda *s: torch.randn(*s, dtype=torch.bfloat16) * 0.05)(B, S, Dm)), 'mem0': _w((lambda *s: torch.randn(*s, dtype=torch.bfloat16) * 0.2)(B, M, Dm)), 'Wq': _w((lambda *s: torch.randn(*s, dtype=torch.bfloat16) * 1.6)(Dm, H, Dh) * Dm ** (-0.5)), 'Wk': _w((lambda *s: torch.randn(*s, dtype=torch.bfloat16) * 1.6)(Dm, H, Dh) * Dm ** (-0.5)), 'Wv': _w((lambda *s: torch.randn(*s, dtype=torch.bfloat16) * 0.2)(Dm, H, Dh) * Dm ** (-0.5)), 'Wo': _w((lambda *s: torch.randn(*s, dtype=torch.bfloat16) * 0.2)(H, Dh, Dm) * (H * Dh) ** (-0.5)), 'seg_len': seg}
    _A_in = _A_setup()

    def _B_setup():
        B, S, D, F = (1, 2048, 512, 1376)
        return {'x': _w((lambda *s: torch.randn(*s, dtype=torch.bfloat16) * 0.05)(B, S, D)), 'w_gate': _w((lambda *s: torch.randn(*s, dtype=torch.bfloat16) * 0.4)(D, F) * D ** (-0.5)), 'w_up': _w((lambda *s: torch.randn(*s, dtype=torch.bfloat16) * 0.4)(D, F) * D ** (-0.5)), 'w_down': _w((lambda *s: torch.randn(*s, dtype=torch.bfloat16) * 0.4)(F, D) * F ** (-0.5))}
    _B_in = _B_setup()
    return {'A_x': _A_in['x'], 'A_mem0': _A_in['mem0'], 'A_Wq': _A_in['Wq'], 'A_Wk': _A_in['Wk'], 'A_Wv': _A_in['Wv'], 'A_Wo': _A_in['Wo'], 'A_seg_len': _A_in['seg_len'], 'B_x': _B_in['x'], 'B_w_gate': _B_in['w_gate'], 'B_w_up': _B_in['w_up'], 'B_w_down': _B_in['w_down']}

def reference(A_x, A_mem0, A_Wq, A_Wk, A_Wv, A_Wo, A_seg_len, B_x, B_w_gate, B_w_up, B_w_down):

    def _A_ref(x, mem0, Wq, Wk, Wv, Wo, seg_len):
        B, S, Dm = x.shape
        H, Dh = (Wq.shape[1], Wq.shape[2])
        M = mem0.shape[1]
        scale = Dh ** (-0.5)
        n_seg = S // seg_len
        L = M + seg_len
        idx = torch.arange(L)
        mask = (idx[:, None] < M) | (idx[:, None] >= idx[None, :])
        mem = mem0
        outs = []
        for s in range(n_seg):
            xs = x[:, s * seg_len:(s + 1) * seg_len, :].clone()
            h = torch.concatenate([mem, xs], axis=1)
            q = torch.einsum('btd,dhe->bhte', h, Wq)
            k = torch.einsum('btd,dhe->bhte', h, Wk)
            v = torch.einsum('btd,dhe->bhte', h, Wv)
            scores = torch.einsum('bhqe,bhke->bhqk', q, k) * scale
            scores = torch.where(mask[None, None], scores, -1000000000.0)
            p = _softmax(scores, axis=-1)
            o = torch.einsum('bhqk,bhke->bhqe', p, v)
            o = torch.einsum('bhte,hed->btd', o, Wo)
            mem = o[:, :M, :].clone()
            outs.append(o[:, M:, :])
        return torch.concatenate(outs, axis=1)

    def _B_ref(x, w_gate, w_up, w_down):
        g = torch.einsum('bsd,df->bsf', x, w_gate)
        u = torch.einsum('bsd,df->bsf', x, w_up)
        h = g * u
        return torch.einsum('bsf,fd->bsd', h, w_down)
    x = A_x
    x = x + _A_ref(_layernorm(x, axis=-1), A_mem0, A_Wq, A_Wk, A_Wv, A_Wo, A_seg_len)
    x = x + _B_ref(_layernorm(x, axis=-1), B_w_gate, B_w_up, B_w_down)
    x = x + _A_ref(_layernorm(x, axis=-1), A_mem0, A_Wq, A_Wk, A_Wv, A_Wo, A_seg_len)
    x = x + _B_ref(_layernorm(x, axis=-1), B_w_gate, B_w_up, B_w_down)
    return x
```

```asm
; @launch grid=(256,1,1) block=(256,1,1) lds=163840
.amdgcn_target "amdgcn-amd-amdhsa--gfx950"
.text
.globl interleave_layers__memory_aug_recurrent_mem_tr__glu_gated_bilinear__prompt_kernel
.p2align 8
.type interleave_layers__memory_aug_recurrent_mem_tr__glu_gated_bilinear__prompt_kernel,@function
interleave_layers__memory_aug_recurrent_mem_tr__glu_gated_bilinear__prompt_kernel:
  s_cmp_ge_u32 s2, 256
  s_cbranch_scc1 L_end
  s_load_dwordx2 s[4:5], s[0:1], 104
  s_mov_b32 s6, 1073741824
  s_mov_b32 s7, 0x20000
  s_load_dwordx2 s[8:9], s[0:1], 96
  s_mov_b32 s10, 256
  s_mov_b32 s11, 0x20000
  s_load_dwordx2 s[12:13], s[0:1], 0
  s_mov_b32 s14, 2097152
  s_mov_b32 s15, 0x20000
  v_and_b32 v1, 63, v0
  v_lshrrev_b32 v3, 6, v0
  v_lshlrev_b32 v2, 4, v1
  v_readfirstlane_b32 s28, v3
  s_getreg_b32 s30, hwreg(HW_REG_XCC_ID)
  s_and_b32 s30, s30, 15
  s_mov_b32 s45, 0xffff0000
  s_and_b32 s31, s2, 7
  s_lshr_b32 s46, s2, 3
  s_lshl_b32 s29, s31, 5
  s_add_u32 s29, s29, s46
  s_mul_i32 s40, s30, s30
  s_lshl_b32 s40, s40, 9
  s_add_u32 s40, s40, s30
  s_add_u32 s40, s40, 0x400000
  v_mov_b32 v9, s40
  v_mov_b32 v3, 0
  v_mov_b32 v4, 1
  v_mov_b64 v[12:13], 0
  v_mov_b64 v[14:15], 0
  v_lshlrev_b32 v11, 4, v0
  s_lshl_b32 s40, s2, 12
  s_waitcnt lgkmcnt(0)
  buffer_store_dwordx4 v[12:15], v11, s[4:7], s40 offen sc1
  v_mov_b32 v10, -1
  v_and_b32 v5, 0xfc, v0
  s_lshl_b32 s40, s2, 8
  s_add_u32 s40, s40, 1048576
  buffer_store_dword v10, v5, s[4:7], s40 offen sc1
  s_cmp_lt_u32 s31, 2
  s_cbranch_scc1 J_CH
  s_sub_u32 s30, s31, 2
  s_bfe_u32 s35, s46, 0x10002
  s_cmp_ge_u32 s31, 6
  s_cselect_b32 s35, s31, s35
  s_and_b32 s35, s35, 1
  s_lshl_b32 s35, s35, 6
  s_add_u32 s34, s35, 64
  s_cmp_ge_u32 s31, 6
  s_cbranch_scc1 L_st2
  s_cmp_lt_u32 s46, 16
  s_cbranch_scc1 J_P
  s_cmp_lt_u32 s46, 24
  s_cbranch_scc1 J_A
  s_branch J_W
L_st2:
  s_cmp_lt_u32 s46, 8
  s_cbranch_scc1 J_R1
  s_cmp_lt_u32 s46, 19
  s_cbranch_scc1 J_FA
  s_cmp_lt_u32 s46, 27
  s_cbranch_scc1 J_FB
  s_cmp_lt_u32 s29, 223
  s_cbranch_scc1 J_R2
J_X:
  s_waitcnt vmcnt(0)
  s_barrier
  s_lshl_b32 s40, s31, 2
  s_cmp_lg_u32 s28, 0
  s_cbranch_scc1 ar_1
  s_mov_b64 exec, 1
  buffer_atomic_add v9, v3, s[8:11], s40 offen sc1
  s_mov_b64 exec, -1
ar_1:
  s_endpgm
J_CH:
  s_load_dwordx2 s[64:65], s[0:1], 16
  s_mov_b32 s66, 4194304
  s_mov_b32 s67, 0x20000
  s_load_dwordx2 s[16:17], s[0:1], 24
  s_mov_b32 s18, 4194304
  s_mov_b32 s19, 0x20000
  s_load_dwordx2 s[20:21], s[0:1], 32
  s_mov_b32 s22, 4194304
  s_mov_b32 s23, 0x20000
  s_load_dwordx2 s[24:25], s[0:1], 40
  s_mov_b32 s26, 4194304
  s_mov_b32 s27, 0x20000
  s_and_b32 s49, s29, 31
  s_lshr_b32 s50, s29, 5
  s_lshl_b32 s41, s49, 8
  s_lshl_b32 s40, s28, 6
  v_lshrrev_b32 v11, 4, v1
  v_add_u32 v11, s40, v11
  s_mov_b32 s40, 8192
  v_mul_lo_u32 v11, v11, s40
  v_and_b32 v10, 15, v1
  v_lshl_add_u32 v11, v10, 4, v11
  v_add_u32 v11, s41, v11
  s_lshl_b32 s40, s28, 6
  v_bfe_u32 v12, v1, 5, 1
  v_lshlrev_b32 v12, 10, v12
  v_bfe_u32 v10, v1, 2, 2
  v_lshl_add_u32 v12, v10, 8, v12
  v_bfe_u32 v10, v1, 4, 1
  v_lshl_add_u32 v12, v10, 5, v12
  v_bfe_u32 v10, v1, 0, 2
  v_lshl_add_u32 v12, v10, 3, v12
  v_add_u32 v12, s40, v12
  v_add_u32 v13, 0x10000, v12
  s_lshl_b32 s40, s28, 6
  v_bfe_u32 v12, v1, 2, 1
  v_lshlrev_b32 v12, 12, v12
  v_bfe_u32 v10, v1, 5, 1
  v_lshl_add_u32 v12, v10, 11, v12
  v_bfe_u32 v10, v1, 3, 1
  v_lshl_add_u32 v12, v10, 10, v12
  v_bfe_u32 v10, v1, 4, 1
  v_lshl_add_u32 v12, v10, 9, v12
  v_bfe_u32 v10, v1, 0, 2
  v_lshl_add_u32 v12, v10, 3, v12
  v_add_u32 v12, s40, v12
  v_add_u32 v13, 0x10000, v12
  s_waitcnt lgkmcnt(0)
  s_lshl_b32 s42, s28, 14
  s_add_u32 s42, s42, 0
  s_add_u32 m0, s42, 0
  s_mov_b32 s43, 0
  buffer_load_dwordx4 v11, s[64:67], s43 offen lds
  s_add_u32 m0, s42, 1024
  s_mov_b32 s43, 32768
  buffer_load_dwordx4 v11, s[64:67], s43 offen lds
  s_add_u32 m0, s42, 2048
  s_mov_b32 s43, 65536
  buffer_load_dwordx4 v11, s[64:67], s43 offen lds
  s_add_u32 m0, s42, 3072
  s_mov_b32 s43, 98304
  buffer_load_dwordx4 v11, s[64:67], s43 offen lds
  s_add_u32 m0, s42, 4096
  s_mov_b32 s43, 131072
  buffer_load_dwordx4 v11, s[64:67], s43 offen lds
  s_add_u32 m0, s42, 5120
  s_mov_b32 s43, 163840
  buffer_load_dwordx4 v11, s[64:67], s43 offen lds
  s_add_u32 m0, s42, 6144
  s_mov_b32 s43, 196608
  buffer_load_dwordx4 v11, s[64:67], s43 offen lds
  s_add_u32 m0, s42, 7168
  s_mov_b32 s43, 229376
  buffer_load_dwordx4 v11, s[64:67], s43 offen lds
  s_add_u32 m0, s42, 8192
  s_mov_b32 s43, 262144
  buffer_load_dwordx4 v11, s[64:67], s43 offen lds
  s_add_u32 m0, s42, 9216
  s_mov_b32 s43, 294912
  buffer_load_dwordx4 v11, s[64:67], s43 offen lds
  s_add_u32 m0, s42, 10240
  s_mov_b32 s43, 327680
  buffer_load_dwordx4 v11, s[64:67], s43 offen lds
  s_add_u32 m0, s42, 11264
  s_mov_b32 s43, 360448
  buffer_load_dwordx4 v11, s[64:67], s43 offen lds
  s_add_u32 m0, s42, 12288
  s_mov_b32 s43, 393216
  buffer_load_dwordx4 v11, s[64:67], s43 offen lds
  s_add_u32 m0, s42, 13312
  s_mov_b32 s43, 425984
  buffer_load_dwordx4 v11, s[64:67], s43 offen lds
  s_add_u32 m0, s42, 14336
  s_mov_b32 s43, 458752
  buffer_load_dwordx4 v11, s[64:67], s43 offen lds
  s_add_u32 m0, s42, 15360
  s_mov_b32 s43, 491520
  buffer_load_dwordx4 v11, s[64:67], s43 offen lds
  s_lshl_b32 s42, s28, 14
  s_add_u32 s42, s42, 65536
  s_add_u32 m0, s42, 0
  s_mov_b32 s43, 2097152
  buffer_load_dwordx4 v11, s[64:67], s43 offen lds
  s_add_u32 m0, s42, 1024
  s_mov_b32 s43, 2129920
  buffer_load_dwordx4 v11, s[64:67], s43 offen lds
  s_add_u32 m0, s42, 2048
  s_mov_b32 s43, 2162688
  buffer_load_dwordx4 v11, s[64:67], s43 offen lds
  s_add_u32 m0, s42, 3072
  s_mov_b32 s43, 2195456
  buffer_load_dwordx4 v11, s[64:67], s43 offen lds
  s_add_u32 m0, s42, 4096
  s_mov_b32 s43, 2228224
  buffer_load_dwordx4 v11, s[64:67], s43 offen lds
  s_add_u32 m0, s42, 5120
  s_mov_b32 s43, 2260992
  buffer_load_dwordx4 v11, s[64:67], s43 offen lds
  s_add_u32 m0, s42, 6144
  s_mov_b32 s43, 2293760
  buffer_load_dwordx4 v11, s[64:67], s43 offen lds
  s_add_u32 m0, s42, 7168
  s_mov_b32 s43, 2326528
  buffer_load_dwordx4 v11, s[64:67], s43 offen lds
  s_add_u32 m0, s42, 8192
  s_mov_b32 s43, 2359296
  buffer_load_dwordx4 v11, s[64:67], s43 offen lds
  s_add_u32 m0, s42, 9216
  s_mov_b32 s43, 2392064
  buffer_load_dwordx4 v11, s[64:67], s43 offen lds
  s_add_u32 m0, s42, 10240
  s_mov_b32 s43, 2424832
  buffer_load_dwordx4 v11, s[64:67], s43 offen lds
  s_add_u32 m0, s42, 11264
  s_mov_b32 s43, 2457600
  buffer_load_dwordx4 v11, s[64:67], s43 offen lds
  s_add_u32 m0, s42, 12288
  s_mov_b32 s43, 2490368
  buffer_load_dwordx4 v11, s[64:67], s43 offen lds
  s_add_u32 m0, s42, 13312
  s_mov_b32 s43, 2523136
  buffer_load_dwordx4 v11, s[64:67], s43 offen lds
  s_add_u32 m0, s42, 14336
  s_mov_b32 s43, 2555904
  buffer_load_dwordx4 v11, s[64:67], s43 offen lds
  s_add_u32 m0, s42, 15360
  s_mov_b32 s43, 2588672
  buffer_load_dwordx4 v11, s[64:67], s43 offen lds
  s_waitcnt vmcnt(32)
  s_barrier
  s_lshl_b32 s40, s31, 2
  s_cmp_lg_u32 s28, 0
  s_cbranch_scc1 ar_2
  s_mov_b64 exec, 1
  buffer_atomic_add v9, v3, s[8:11], s40 offen sc1
  s_mov_b64 exec, -1
ar_2:
  s_waitcnt vmcnt(16)
  s_barrier
  ds_read_b64_tr_b16 a[0:1], v12 offset:0
  ds_read_b64_tr_b16 a[2:3], v12 offset:256
  ds_read_b64_tr_b16 a[4:5], v12 offset:8192
  ds_read_b64_tr_b16 a[6:7], v12 offset:8448
  ds_read_b64_tr_b16 a[8:9], v12 offset:32
  ds_read_b64_tr_b16 a[10:11], v12 offset:288
  ds_read_b64_tr_b16 a[12:13], v12 offset:8224
  ds_read_b64_tr_b16 a[14:15], v12 offset:8480
  ds_read_b64_tr_b16 a[16:17], v12 offset:16384
  ds_read_b64_tr_b16 a[18:19], v12 offset:16640
  ds_read_b64_tr_b16 a[20:21], v12 offset:24576
  ds_read_b64_tr_b16 a[22:23], v12 offset:24832
  ds_read_b64_tr_b16 a[24:25], v12 offset:16416
  ds_read_b64_tr_b16 a[26:27], v12 offset:16672
  ds_read_b64_tr_b16 a[28:29], v12 offset:24608
  ds_read_b64_tr_b16 a[30:31], v12 offset:24864
  ds_read_b64_tr_b16 a[32:33], v12 offset:32768
  ds_read_b64_tr_b16 a[34:35], v12 offset:33024
  ds_read_b64_tr_b16 a[36:37], v12 offset:40960
  ds_read_b64_tr_b16 a[38:39], v12 offset:41216
  ds_read_b64_tr_b16 a[40:41], v12 offset:32800
  ds_read_b64_tr_b16 a[42:43], v12 offset:33056
  ds_read_b64_tr_b16 a[44:45], v12 offset:40992
  ds_read_b64_tr_b16 a[46:47], v12 offset:41248
  ds_read_b64_tr_b16 a[48:49], v12 offset:49152
  ds_read_b64_tr_b16 a[50:51], v12 offset:49408
  ds_read_b64_tr_b16 a[52:53], v12 offset:57344
  ds_read_b64_tr_b16 a[54:55], v12 offset:57600
  ds_read_b64_tr_b16 a[56:57], v12 offset:49184
  ds_read_b64_tr_b16 a[58:59], v12 offset:49440
  ds_read_b64_tr_b16 a[60:61], v12 offset:57376
  ds_read_b64_tr_b16 a[62:63], v12 offset:57632
  s_waitcnt lgkmcnt(0)
  s_barrier
  s_lshl_b32 s42, s28, 14
  s_add_u32 s42, s42, 0
  s_add_u32 m0, s42, 0
  s_mov_b32 s43, 0
  buffer_load_dwordx4 v11, s[16:19], s43 offen lds
  s_add_u32 m0, s42, 1024
  s_mov_b32 s43, 32768
  buffer_load_dwordx4 v11, s[16:19], s43 offen lds
  s_add_u32 m0, s42, 2048
  s_mov_b32 s43, 65536
  buffer_load_dwordx4 v11, s[16:19], s43 offen lds
  s_add_u32 m0, s42, 3072
  s_mov_b32 s43, 98304
  buffer_load_dwordx4 v11, s[16:19], s43 offen lds
  s_add_u32 m0, s42, 4096
  s_mov_b32 s43, 131072
  buffer_load_dwordx4 v11, s[16:19], s43 offen lds
  s_add_u32 m0, s42, 5120
  s_mov_b32 s43, 163840
  buffer_load_dwordx4 v11, s[16:19], s43 offen lds
  s_add_u32 m0, s42, 6144
  s_mov_b32 s43, 196608
  buffer_load_dwordx4 v11, s[16:19], s43 offen lds
  s_add_u32 m0, s42, 7168
  s_mov_b32 s43, 229376
  buffer_load_dwordx4 v11, s[16:19], s43 offen lds
  s_add_u32 m0, s42, 8192
  s_mov_b32 s43, 262144
  buffer_load_dwordx4 v11, s[16:19], s43 offen lds
  s_add_u32 m0, s42, 9216
  s_mov_b32 s43, 294912
  buffer_load_dwordx4 v11, s[16:19], s43 offen lds
  s_add_u32 m0, s42, 10240
  s_mov_b32 s43, 327680
  buffer_load_dwordx4 v11, s[16:19], s43 offen lds
  s_add_u32 m0, s42, 11264
  s_mov_b32 s43, 360448
  buffer_load_dwordx4 v11, s[16:19], s43 offen lds
  s_add_u32 m0, s42, 12288
  s_mov_b32 s43, 393216
  buffer_load_dwordx4 v11, s[16:19], s43 offen lds
  s_add_u32 m0, s42, 13312
  s_mov_b32 s43, 425984
  buffer_load_dwordx4 v11, s[16:19], s43 offen lds
  s_add_u32 m0, s42, 14336
  s_mov_b32 s43, 458752
  buffer_load_dwordx4 v11, s[16:19], s43 offen lds
  s_add_u32 m0, s42, 15360
  s_mov_b32 s43, 491520
  buffer_load_dwordx4 v11, s[16:19], s43 offen lds
  s_waitcnt vmcnt(16)
  s_barrier
  ds_read_b64_tr_b16 a[64:65], v13 offset:0
  ds_read_b64_tr_b16 a[66:67], v13 offset:256
  ds_read_b64_tr_b16 a[68:69], v13 offset:8192
  ds_read_b64_tr_b16 a[70:71], v13 offset:8448
  ds_read_b64_tr_b16 a[72:73], v13 offset:32
  ds_read_b64_tr_b16 a[74:75], v13 offset:288
  ds_read_b64_tr_b16 a[76:77], v13 offset:8224
  ds_read_b64_tr_b16 a[78:79], v13 offset:8480
  ds_read_b64_tr_b16 a[80:81], v13 offset:16384
  ds_read_b64_tr_b16 a[82:83], v13 offset:16640
  ds_read_b64_tr_b16 a[84:85], v13 offset:24576
  ds_read_b64_tr_b16 a[86:87], v13 offset:24832
  ds_read_b64_tr_b16 a[88:89], v13 offset:16416
  ds_read_b64_tr_b16 a[90:91], v13 offset:16672
  ds_read_b64_tr_b16 a[92:93], v13 offset:24608
  ds_read_b64_tr_b16 a[94:95], v13 offset:24864
  ds_read_b64_tr_b16 a[96:97], v13 offset:32768
  ds_read_b64_tr_b16 a[98:99], v13 offset:33024
  ds_read_b64_tr_b16 a[100:101], v13 offset:40960
  ds_read_b64_tr_b16 a[102:103], v13 offset:41216
  ds_read_b64_tr_b16 a[104:105], v13 offset:32800
  ds_read_b64_tr_b16 a[106:107], v13 offset:33056
  ds_read_b64_tr_b16 a[108:109], v13 offset:40992
  ds_read_b64_tr_b16 a[110:111], v13 offset:41248
  ds_read_b64_tr_b16 a[112:113], v13 offset:49152
  ds_read_b64_tr_b16 a[114:115], v13 offset:49408
  ds_read_b64_tr_b16 a[116:117], v13 offset:57344
  ds_read_b64_tr_b16 a[118:119], v13 offset:57600
  ds_read_b64_tr_b16 a[120:121], v13 offset:49184
  ds_read_b64_tr_b16 a[122:123], v13 offset:49440
  ds_read_b64_tr_b16 a[124:125], v13 offset:57376
  ds_read_b64_tr_b16 a[126:127], v13 offset:57632
  s_waitcnt lgkmcnt(0)
  s_barrier
  s_lshl_b32 s42, s28, 14
  s_add_u32 s42, s42, 65536
  s_add_u32 m0, s42, 0
  s_mov_b32 s43, 2097152
  buffer_load_dwordx4 v11, s[16:19], s43 offen lds
  s_add_u32 m0, s42, 1024
  s_mov_b32 s43, 2129920
  buffer_load_dwordx4 v11, s[16:19], s43 offen lds
  s_add_u32 m0, s42, 2048
  s_mov_b32 s43, 2162688
  buffer_load_dwordx4 v11, s[16:19], s43 offen lds
  s_add_u32 m0, s42, 3072
  s_mov_b32 s43, 2195456
  buffer_load_dwordx4 v11, s[16:19], s43 offen lds
  s_add_u32 m0, s42, 4096
  s_mov_b32 s43, 2228224
  buffer_load_dwordx4 v11, s[16:19], s43 offen lds
  s_add_u32 m0, s42, 5120
  s_mov_b32 s43, 2260992
  buffer_load_dwordx4 v11, s[16:19], s43 offen lds
  s_add_u32 m0, s42, 6144
  s_mov_b32 s43, 2293760
  buffer_load_dwordx4 v11, s[16:19], s43 offen lds
  s_add_u32 m0, s42, 7168
  s_mov_b32 s43, 2326528
  buffer_load_dwordx4 v11, s[16:19], s43 offen lds
  s_add_u32 m0, s42, 8192
  s_mov_b32 s43, 2359296
  buffer_load_dwordx4 v11, s[16:19], s43 offen lds
  s_add_u32 m0, s42, 9216
  s_mov_b32 s43, 2392064
  buffer_load_dwordx4 v11, s[16:19], s43 offen lds
  s_add_u32 m0, s42, 10240
  s_mov_b32 s43, 2424832
  buffer_load_dwordx4 v11, s[16:19], s43 offen lds
  s_add_u32 m0, s42, 11264
  s_mov_b32 s43, 2457600
  buffer_load_dwordx4 v11, s[16:19], s43 offen lds
  s_add_u32 m0, s42, 12288
  s_mov_b32 s43, 2490368
  buffer_load_dwordx4 v11, s[16:19], s43 offen lds
  s_add_u32 m0, s42, 13312
  s_mov_b32 s43, 2523136
  buffer_load_dwordx4 v11, s[16:19], s43 offen lds
  s_add_u32 m0, s42, 14336
  s_mov_b32 s43, 2555904
  buffer_load_dwordx4 v11, s[16:19], s43 offen lds
  s_add_u32 m0, s42, 15360
  s_mov_b32 s43, 2588672
  buffer_load_dwordx4 v11, s[16:19], s43 offen lds
  s_waitcnt vmcnt(16)
  s_barrier
  ds_read_b64_tr_b16 a[128:129], v12 offset:0
  ds_read_b64_tr_b16 a[130:131], v12 offset:256
  ds_read_b64_tr_b16 a[132:133], v12 offset:8192
  ds_read_b64_tr_b16 a[134:135], v12 offset:8448
  ds_read_b64_tr_b16 a[136:137], v12 offset:32
  ds_read_b64_tr_b16 a[138:139], v12 offset:288
  ds_read_b64_tr_b16 a[140:141], v12 offset:8224
  ds_read_b64_tr_b16 a[142:143], v12 offset:8480
  ds_read_b64_tr_b16 a[144:145], v12 offset:16384
  ds_read_b64_tr_b16 a[146:147], v12 offset:16640
  ds_read_b64_tr_b16 a[148:149], v12 offset:24576
  ds_read_b64_tr_b16 a[150:151], v12 offset:24832
  ds_read_b64_tr_b16 a[152:153], v12 offset:16416
  ds_read_b64_tr_b16 a[154:155], v12 offset:16672
  ds_read_b64_tr_b16 a[156:157], v12 offset:24608
  ds_read_b64_tr_b16 a[158:159], v12 offset:24864
  ds_read_b64_tr_b16 a[160:161], v12 offset:32768
  ds_read_b64_tr_b16 a[162:163], v12 offset:33024
  ds_read_b64_tr_b16 a[164:165], v12 offset:40960
  ds_read_b64_tr_b16 a[166:167], v12 offset:41216
  ds_read_b64_tr_b16 a[168:169], v12 offset:32800
  ds_read_b64_tr_b16 a[170:171], v12 offset:33056
  ds_read_b64_tr_b16 a[172:173], v12 offset:40992
  ds_read_b64_tr_b16 a[174:175], v12 offset:41248
  ds_read_b64_tr_b16 a[176:177], v12 offset:49152
  ds_read_b64_tr_b16 a[178:179], v12 offset:49408
  ds_read_b64_tr_b16 a[180:181], v12 offset:57344
  ds_read_b64_tr_b16 a[182:183], v12 offset:57600
  ds_read_b64_tr_b16 a[184:185], v12 offset:49184
  ds_read_b64_tr_b16 a[186:187], v12 offset:49440
  ds_read_b64_tr_b16 a[188:189], v12 offset:57376
  ds_read_b64_tr_b16 a[190:191], v12 offset:57632
  s_waitcnt lgkmcnt(0)
  s_barrier
  s_lshl_b32 s42, s28, 14
  s_add_u32 s42, s42, 0
  s_add_u32 m0, s42, 0
  s_mov_b32 s43, 0
  buffer_load_dwordx4 v11, s[20:23], s43 offen lds
  s_add_u32 m0, s42, 1024
  s_mov_b32 s43, 32768
  buffer_load_dwordx4 v11, s[20:23], s43 offen lds
  s_add_u32 m0, s42, 2048
  s_mov_b32 s43, 65536
  buffer_load_dwordx4 v11, s[20:23], s43 offen lds
  s_add_u32 m0, s42, 3072
  s_mov_b32 s43, 98304
  buffer_load_dwordx4 v11, s[20:23], s43 offen lds
  s_add_u32 m0, s42, 4096
  s_mov_b32 s43, 131072
  buffer_load_dwordx4 v11, s[20:23], s43 offen lds
  s_add_u32 m0, s42, 5120
  s_mov_b32 s43, 163840
  buffer_load_dwordx4 v11, s[20:23], s43 offen lds
  s_add_u32 m0, s42, 6144
  s_mov_b32 s43, 196608
  buffer_load_dwordx4 v11, s[20:23], s43 offen lds
  s_add_u32 m0, s42, 7168
  s_mov_b32 s43, 229376
  buffer_load_dwordx4 v11, s[20:23], s43 offen lds
  s_add_u32 m0, s42, 8192
  s_mov_b32 s43, 262144
  buffer_load_dwordx4 v11, s[20:23], s43 offen lds
  s_add_u32 m0, s42, 9216
  s_mov_b32 s43, 294912
  buffer_load_dwordx4 v11, s[20:23], s43 offen lds
  s_add_u32 m0, s42, 10240
  s_mov_b32 s43, 327680
  buffer_load_dwordx4 v11, s[20:23], s43 offen lds
  s_add_u32 m0, s42, 11264
  s_mov_b32 s43, 360448
  buffer_load_dwordx4 v11, s[20:23], s43 offen lds
  s_add_u32 m0, s42, 12288
  s_mov_b32 s43, 393216
  buffer_load_dwordx4 v11, s[20:23], s43 offen lds
  s_add_u32 m0, s42, 13312
  s_mov_b32 s43, 425984
  buffer_load_dwordx4 v11, s[20:23], s43 offen lds
  s_add_u32 m0, s42, 14336
  s_mov_b32 s43, 458752
  buffer_load_dwordx4 v11, s[20:23], s43 offen lds
  s_add_u32 m0, s42, 15360
  s_mov_b32 s43, 491520
  buffer_load_dwordx4 v11, s[20:23], s43 offen lds
  s_waitcnt vmcnt(16)
  s_barrier
  ds_read_b64_tr_b16 a[192:193], v13 offset:0
  ds_read_b64_tr_b16 a[194:195], v13 offset:256
  ds_read_b64_tr_b16 a[196:197], v13 offset:8192
  ds_read_b64_tr_b16 a[198:199], v13 offset:8448
  ds_read_b64_tr_b16 a[200:201], v13 offset:32
  ds_read_b64_tr_b16 a[202:203], v13 offset:288
  ds_read_b64_tr_b16 a[204:205], v13 offset:8224
  ds_read_b64_tr_b16 a[206:207], v13 offset:8480
  ds_read_b64_tr_b16 a[208:209], v13 offset:16384
  ds_read_b64_tr_b16 a[210:211], v13 offset:16640
  ds_read_b64_tr_b16 a[212:213], v13 offset:24576
  ds_read_b64_tr_b16 a[214:215], v13 offset:24832
  ds_read_b64_tr_b16 a[216:217], v13 offset:16416
  ds_read_b64_tr_b16 a[218:219], v13 offset:16672
  ds_read_b64_tr_b16 a[220:221], v13 offset:24608
  ds_read_b64_tr_b16 a[222:223], v13 offset:24864
  ds_read_b64_tr_b16 a[224:225], v13 offset:32768
  ds_read_b64_tr_b16 a[226:227], v13 offset:33024
  ds_read_b64_tr_b16 a[228:229], v13 offset:40960
  ds_read_b64_tr_b16 a[230:231], v13 offset:41216
  ds_read_b64_tr_b16 a[232:233], v13 offset:32800
  ds_read_b64_tr_b16 a[234:235], v13 offset:33056
  ds_read_b64_tr_b16 a[236:237], v13 offset:40992
  ds_read_b64_tr_b16 a[238:239], v13 offset:41248
  ds_read_b64_tr_b16 a[240:241], v13 offset:49152
  ds_read_b64_tr_b16 a[242:243], v13 offset:49408
  ds_read_b64_tr_b16 a[244:245], v13 offset:57344
  ds_read_b64_tr_b16 a[246:247], v13 offset:57600
  ds_read_b64_tr_b16 a[248:249], v13 offset:49184
  ds_read_b64_tr_b16 a[250:251], v13 offset:49440
  ds_read_b64_tr_b16 a[252:253], v13 offset:57376
  ds_read_b64_tr_b16 a[254:255], v13 offset:57632
  s_waitcnt lgkmcnt(0)
  s_barrier
  s_lshl_b32 s42, s28, 14
  s_add_u32 s42, s42, 65536
  s_add_u32 m0, s42, 0
  s_mov_b32 s43, 2097152
  buffer_load_dwordx4 v11, s[20:23], s43 offen lds
  s_add_u32 m0, s42, 1024
  s_mov_b32 s43, 2129920
  buffer_load_dwordx4 v11, s[20:23], s43 offen lds
  s_add_u32 m0, s42, 2048
  s_mov_b32 s43, 2162688
  buffer_load_dwordx4 v11, s[20:23], s43 offen lds
  s_add_u32 m0, s42, 3072
  s_mov_b32 s43, 2195456
  buffer_load_dwordx4 v11, s[20:23], s43 offen lds
  s_add_u32 m0, s42, 4096
  s_mov_b32 s43, 2228224
  buffer_load_dwordx4 v11, s[20:23], s43 offen lds
  s_add_u32 m0, s42, 5120
  s_mov_b32 s43, 2260992
  buffer_load_dwordx4 v11, s[20:23], s43 offen lds
  s_add_u32 m0, s42, 6144
  s_mov_b32 s43, 2293760
  buffer_load_dwordx4 v11, s[20:23], s43 offen lds
  s_add_u32 m0, s42, 7168
  s_mov_b32 s43, 2326528
  buffer_load_dwordx4 v11, s[20:23], s43 offen lds
  s_add_u32 m0, s42, 8192
  s_mov_b32 s43, 2359296
  buffer_load_dwordx4 v11, s[20:23], s43 offen lds
  s_add_u32 m0, s42, 9216
  s_mov_b32 s43, 2392064
  buffer_load_dwordx4 v11, s[20:23], s43 offen lds
  s_add_u32 m0, s42, 10240
  s_mov_b32 s43, 2424832
  buffer_load_dwordx4 v11, s[20:23], s43 offen lds
  s_add_u32 m0, s42, 11264
  s_mov_b32 s43, 2457600
  buffer_load_dwordx4 v11, s[20:23], s43 offen lds
  s_add_u32 m0, s42, 12288
  s_mov_b32 s43, 2490368
  buffer_load_dwordx4 v11, s[20:23], s43 offen lds
  s_add_u32 m0, s42, 13312
  s_mov_b32 s43, 2523136
  buffer_load_dwordx4 v11, s[20:23], s43 offen lds
  s_add_u32 m0, s42, 14336
  s_mov_b32 s43, 2555904
  buffer_load_dwordx4 v11, s[20:23], s43 offen lds
  s_add_u32 m0, s42, 15360
  s_mov_b32 s43, 2588672
  buffer_load_dwordx4 v11, s[20:23], s43 offen lds
  s_waitcnt vmcnt(16)
  s_barrier
  ds_read_b64_tr_b16 v[128:129], v12 offset:0
  ds_read_b64_tr_b16 v[130:131], v12 offset:256
  ds_read_b64_tr_b16 v[132:133], v12 offset:8192
  ds_read_b64_tr_b16 v[134:135], v12 offset:8448
  ds_read_b64_tr_b16 v[136:137], v12 offset:32
  ds_read_b64_tr_b16 v[138:139], v12 offset:288
  ds_read_b64_tr_b16 v[140:141], v12 offset:8224
  ds_read_b64_tr_b16 v[142:143], v12 offset:8480
  ds_read_b64_tr_b16 v[144:145], v12 offset:16384
  ds_read_b64_tr_b16 v[146:147], v12 offset:16640
  ds_read_b64_tr_b16 v[148:149], v12 offset:24576
  ds_read_b64_tr_b16 v[150:151], v12 offset:24832
  ds_read_b64_tr_b16 v[152:153], v12 offset:16416
  ds_read_b64_tr_b16 v[154:155], v12 offset:16672
  ds_read_b64_tr_b16 v[156:157], v12 offset:24608
  ds_read_b64_tr_b16 v[158:159], v12 offset:24864
  ds_read_b64_tr_b16 v[160:161], v12 offset:32768
  ds_read_b64_tr_b16 v[162:163], v12 offset:33024
  ds_read_b64_tr_b16 v[164:165], v12 offset:40960
  ds_read_b64_tr_b16 v[166:167], v12 offset:41216
  ds_read_b64_tr_b16 v[168:169], v12 offset:32800
  ds_read_b64_tr_b16 v[170:171], v12 offset:33056
  ds_read_b64_tr_b16 v[172:173], v12 offset:40992
  ds_read_b64_tr_b16 v[174:175], v12 offset:41248
  ds_read_b64_tr_b16 v[176:177], v12 offset:49152
  ds_read_b64_tr_b16 v[178:179], v12 offset:49408
  ds_read_b64_tr_b16 v[180:181], v12 offset:57344
  ds_read_b64_tr_b16 v[182:183], v12 offset:57600
  ds_read_b64_tr_b16 v[184:185], v12 offset:49184
  ds_read_b64_tr_b16 v[186:187], v12 offset:49440
  ds_read_b64_tr_b16 v[188:189], v12 offset:57376
  ds_read_b64_tr_b16 v[190:191], v12 offset:57632
  s_waitcnt lgkmcnt(0)
  s_barrier
  s_waitcnt vmcnt(0)
  s_barrier
  ds_read_b64_tr_b16 v[192:193], v13 offset:0
  ds_read_b64_tr_b16 v[194:195], v13 offset:256
  ds_read_b64_tr_b16 v[196:197], v13 offset:8192
  ds_read_b64_tr_b16 v[198:199], v13 offset:8448
  ds_read_b64_tr_b16 v[200:201], v13 offset:32
  ds_read_b64_tr_b16 v[202:203], v13 offset:288
  ds_read_b64_tr_b16 v[204:205], v13 offset:8224
  ds_read_b64_tr_b16 v[206:207], v13 offset:8480
  ds_read_b64_tr_b16 v[208:209], v13 offset:16384
  ds_read_b64_tr_b16 v[210:211], v13 offset:16640
  ds_read_b64_tr_b16 v[212:213], v13 offset:24576
  ds_read_b64_tr_b16 v[214:215], v13 offset:24832
  ds_read_b64_tr_b16 v[216:217], v13 offset:16416
  ds_read_b64_tr_b16 v[218:219], v13 offset:16672
  ds_read_b64_tr_b16 v[220:221], v13 offset:24608
  ds_read_b64_tr_b16 v[222:223], v13 offset:24864
  ds_read_b64_tr_b16 v[224:225], v13 offset:32768
  ds_read_b64_tr_b16 v[226:227], v13 offset:33024
  ds_read_b64_tr_b16 v[228:229], v13 offset:40960
  ds_read_b64_tr_b16 v[230:231], v13 offset:41216
  ds_read_b64_tr_b16 v[232:233], v13 offset:32800
  ds_read_b64_tr_b16 v[234:235], v13 offset:33056
  ds_read_b64_tr_b16 v[236:237], v13 offset:40992
  ds_read_b64_tr_b16 v[238:239], v13 offset:41248
  ds_read_b64_tr_b16 v[240:241], v13 offset:49152
  ds_read_b64_tr_b16 v[242:243], v13 offset:49408
  ds_read_b64_tr_b16 v[244:245], v13 offset:57344
  ds_read_b64_tr_b16 v[246:247], v13 offset:57600
  ds_read_b64_tr_b16 v[248:249], v13 offset:49184
  ds_read_b64_tr_b16 v[250:251], v13 offset:49440
  ds_read_b64_tr_b16 v[252:253], v13 offset:57376
  ds_read_b64_tr_b16 v[254:255], v13 offset:57632
  s_waitcnt lgkmcnt(0)
  s_barrier
  s_lshl_b32 s40, s49, 17
  s_lshl_b32 s41, s28, 8
  s_add_u32 s40, s40, s41
  v_bfe_u32 v11, v1, 4, 2
  v_lshlrev_b32 v11, 10, v11
  v_bfe_u32 v10, v1, 0, 4
  v_lshl_add_u32 v11, v10, 4, v11
  v_add_u32 v11, s40, v11
  s_lshl_b32 s42, s28, 15
  s_add_u32 s42, s42, 32768
  s_add_u32 m0, s42, 0
  s_mov_b32 s43, 0
  buffer_load_dwordx4 v11, s[24:27], s43 offen lds
  s_add_u32 m0, s42, 1024
  s_mov_b32 s43, 4096
  buffer_load_dwordx4 v11, s[24:27], s43 offen lds
  s_add_u32 m0, s42, 2048
  s_mov_b32 s43, 8192
  buffer_load_dwordx4 v11, s[24:27], s43 offen lds
  s_add_u32 m0, s42, 3072
  s_mov_b32 s43, 12288
  buffer_load_dwordx4 v11, s[24:27], s43 offen lds
  s_add_u32 m0, s42, 4096
  s_mov_b32 s43, 16384
  buffer_load_dwordx4 v11, s[24:27], s43 offen lds
  s_add_u32 m0, s42, 5120
  s_mov_b32 s43, 20480
  buffer_load_dwordx4 v11, s[24:27], s43 offen lds
  s_add_u32 m0, s42, 6144
  s_mov_b32 s43, 24576
  buffer_load_dwordx4 v11, s[24:27], s43 offen lds
  s_add_u32 m0, s42, 7168
  s_mov_b32 s43, 28672
  buffer_load_dwordx4 v11, s[24:27], s43 offen lds
  s_add_u32 m0, s42, 8192
  s_mov_b32 s43, 32768
  buffer_load_dwordx4 v11, s[24:27], s43 offen lds
  s_add_u32 m0, s42, 9216
  s_mov_b32 s43, 36864
  buffer_load_dwordx4 v11, s[24:27], s43 offen lds
  s_add_u32 m0, s42, 10240
  s_mov_b32 s43, 40960
  buffer_load_dwordx4 v11, s[24:27], s43 offen lds
  s_add_u32 m0, s42, 11264
  s_mov_b32 s43, 45056
  buffer_load_dwordx4 v11, s[24:27], s43 offen lds
  s_add_u32 m0, s42, 12288
  s_mov_b32 s43, 49152
  buffer_load_dwordx4 v11, s[24:27], s43 offen lds
  s_add_u32 m0, s42, 13312
  s_mov_b32 s43, 53248
  buffer_load_dwordx4 v11, s[24:27], s43 offen lds
  s_add_u32 m0, s42, 14336
  s_mov_b32 s43, 57344
  buffer_load_dwordx4 v11, s[24:27], s43 offen lds
  s_add_u32 m0, s42, 15360
  s_mov_b32 s43, 61440
  buffer_load_dwordx4 v11, s[24:27], s43 offen lds
  s_add_u32 m0, s42, 16384
  s_mov_b32 s43, 65536
  buffer_load_dwordx4 v11, s[24:27], s43 offen lds
  s_add_u32 m0, s42, 17408
  s_mov_b32 s43, 69632
  buffer_load_dwordx4 v11, s[24:27], s43 offen lds
  s_add_u32 m0, s42, 18432
  s_mov_b32 s43, 73728
  buffer_load_dwordx4 v11, s[24:27], s43 offen lds
  s_add_u32 m0, s42, 19456
  s_mov_b32 s43, 77824
  buffer_load_dwordx4 v11, s[24:27], s43 offen lds
  s_add_u32 m0, s42, 20480
  s_mov_b32 s43, 81920
  buffer_load_dwordx4 v11, s[24:27], s43 offen lds
  s_add_u32 m0, s42, 21504
  s_mov_b32 s43, 86016
  buffer_load_dwordx4 v11, s[24:27], s43 offen lds
  s_add_u32 m0, s42, 22528
  s_mov_b32 s43, 90112
  buffer_load_dwordx4 v11, s[24:27], s43 offen lds
  s_add_u32 m0, s42, 23552
  s_mov_b32 s43, 94208
  buffer_load_dwordx4 v11, s[24:27], s43 offen lds
  s_add_u32 m0, s42, 24576
  s_mov_b32 s43, 98304
  buffer_load_dwordx4 v11, s[24:27], s43 offen lds
  s_add_u32 m0, s42, 25600
  s_mov_b32 s43, 102400
  buffer_load_dwordx4 v11, s[24:27], s43 offen lds
  s_add_u32 m0, s42, 26624
  s_mov_b32 s43, 106496
  buffer_load_dwordx4 v11, s[24:27], s43 offen lds
  s_add_u32 m0, s42, 27648
  s_mov_b32 s43, 110592
  buffer_load_dwordx4 v11, s[24:27], s43 offen lds
  s_add_u32 m0, s42, 28672
  s_mov_b32 s43, 114688
  buffer_load_dwordx4 v11, s[24:27], s43 offen lds
  s_add_u32 m0, s42, 29696
  s_mov_b32 s43, 118784
  buffer_load_dwordx4 v11, s[24:27], s43 offen lds
  s_add_u32 m0, s42, 30720
  s_mov_b32 s43, 122880
  buffer_load_dwordx4 v11, s[24:27], s43 offen lds
  s_add_u32 m0, s42, 31744
  s_mov_b32 s43, 126976
  buffer_load_dwordx4 v11, s[24:27], s43 offen lds
  v_bfe_u32 v12, v1, 4, 1
  v_lshlrev_b32 v12, 12, v12
  v_bfe_u32 v10, v1, 5, 1
  v_lshl_add_u32 v12, v10, 11, v12
  v_bfe_u32 v10, v1, 3, 1
  v_lshl_add_u32 v12, v10, 10, v12
  v_bfe_u32 v10, v1, 2, 1
  v_lshl_add_u32 v12, v10, 8, v12
  v_bfe_u32 v10, v1, 0, 2
  v_lshl_add_u32 v12, v10, 3, v12
  v_add_u32 v12, s42, v12
  v_add_u32 v17, s42, v2
  s_load_dwordx2 s[12:13], s[0:1], 8
  s_mov_b32 s14, 8192
  s_mov_b32 s15, 0x20000
  s_waitcnt vmcnt(16)
  ds_read_b64_tr_b16 v[40:41], v12 offset:0
  ds_read_b64_tr_b16 v[42:43], v12 offset:512
  ds_read_b64_tr_b16 v[44:45], v12 offset:8192
  ds_read_b64_tr_b16 v[46:47], v12 offset:8704
  ds_read_b64_tr_b16 v[48:49], v12 offset:64
  ds_read_b64_tr_b16 v[50:51], v12 offset:576
  ds_read_b64_tr_b16 v[52:53], v12 offset:8256
  ds_read_b64_tr_b16 v[54:55], v12 offset:8768
  ds_read_b64_tr_b16 v[56:57], v12 offset:32
  ds_read_b64_tr_b16 v[58:59], v12 offset:544
  ds_read_b64_tr_b16 v[60:61], v12 offset:8224
  ds_read_b64_tr_b16 v[62:63], v12 offset:8736
  ds_read_b64_tr_b16 v[64:65], v12 offset:96
  ds_read_b64_tr_b16 v[66:67], v12 offset:608
  ds_read_b64_tr_b16 v[68:69], v12 offset:8288
  ds_read_b64_tr_b16 v[70:71], v12 offset:8800
  ds_read_b64_tr_b16 v[72:73], v12 offset:128
  ds_read_b64_tr_b16 v[74:75], v12 offset:640
  ds_read_b64_tr_b16 v[76:77], v12 offset:8320
  ds_read_b64_tr_b16 v[78:79], v12 offset:8832
  ds_read_b64_tr_b16 v[80:81], v12 offset:192
  ds_read_b64_tr_b16 v[82:83], v12 offset:704
  ds_read_b64_tr_b16 v[84:85], v12 offset:8384
  ds_read_b64_tr_b16 v[86:87], v12 offset:8896
  ds_read_b64_tr_b16 v[88:89], v12 offset:160
  ds_read_b64_tr_b16 v[90:91], v12 offset:672
  ds_read_b64_tr_b16 v[92:93], v12 offset:8352
  ds_read_b64_tr_b16 v[94:95], v12 offset:8864
  ds_read_b64_tr_b16 v[96:97], v12 offset:224
  ds_read_b64_tr_b16 v[98:99], v12 offset:736
  ds_read_b64_tr_b16 v[100:101], v12 offset:8416
  ds_read_b64_tr_b16 v[102:103], v12 offset:8928
  s_waitcnt lgkmcnt(0)
  ds_write_b128 v17, v[40:43] offset:0
  ds_write_b128 v17, v[44:47] offset:1024
  ds_write_b128 v17, v[48:51] offset:2048
  ds_write_b128 v17, v[52:55] offset:3072
  ds_write_b128 v17, v[56:59] offset:4096
  ds_write_b128 v17, v[60:63] offset:5120
  ds_write_b128 v17, v[64:67] offset:6144
  ds_write_b128 v17, v[68:71] offset:7168
  ds_write_b128 v17, v[72:75] offset:8192
  ds_write_b128 v17, v[76:79] offset:9216
  ds_write_b128 v17, v[80:83] offset:10240
  ds_write_b128 v17, v[84:87] offset:11264
  ds_write_b128 v17, v[88:91] offset:12288
  ds_write_b128 v17, v[92:95] offset:13312
  ds_write_b128 v17, v[96:99] offset:14336
  ds_write_b128 v17, v[100:103] offset:15360
  s_waitcnt lgkmcnt(0)
  s_waitcnt vmcnt(0)
  ds_read_b64_tr_b16 v[40:41], v12 offset:16384
  ds_read_b64_tr_b16 v[42:43], v12 offset:16896
  ds_read_b64_tr_b16 v[44:45], v12 offset:24576
  ds_read_b64_tr_b16 v[46:47], v12 offset:25088
  ds_read_b64_tr_b16 v[48:49], v12 offset:16448
  ds_read_b64_tr_b16 v[50:51], v12 offset:16960
  ds_read_b64_tr_b16 v[52:53], v12 offset:24640
  ds_read_b64_tr_b16 v[54:55], v12 offset:25152
  ds_read_b64_tr_b16 v[56:57], v12 offset:16416
  ds_read_b64_tr_b16 v[58:59], v12 offset:16928
  ds_read_b64_tr_b16 v[60:61], v12 offset:24608
  ds_read_b64_tr_b16 v[62:63], v12 offset:25120
  ds_read_b64_tr_b16 v[64:65], v12 offset:16480
  ds_read_b64_tr_b16 v[66:67], v12 offset:16992
  ds_read_b64_tr_b16 v[68:69], v12 offset:24672
  ds_read_b64_tr_b16 v[70:71], v12 offset:25184
  ds_read_b64_tr_b16 v[72:73], v12 offset:16512
  ds_read_b64_tr_b16 v[74:75], v12 offset:17024
  ds_read_b64_tr_b16 v[76:77], v12 offset:24704
  ds_read_b64_tr_b16 v[78:79], v12 offset:25216
  ds_read_b64_tr_b16 v[80:81], v12 offset:16576
  ds_read_b64_tr_b16 v[82:83], v12 offset:17088
  ds_read_b64_tr_b16 v[84:85], v12 offset:24768
  ds_read_b64_tr_b16 v[86:87], v12 offset:25280
  ds_read_b64_tr_b16 v[88:89], v12 offset:16544
  ds_read_b64_tr_b16 v[90:91], v12 offset:17056
  ds_read_b64_tr_b16 v[92:93], v12 offset:24736
  ds_read_b64_tr_b16 v[94:95], v12 offset:25248
  ds_read_b64_tr_b16 v[96:97], v12 offset:16608
  ds_read_b64_tr_b16 v[98:99], v12 offset:17120
  ds_read_b64_tr_b16 v[100:101], v12 offset:24800
  ds_read_b64_tr_b16 v[102:103], v12 offset:25312
  s_waitcnt lgkmcnt(0)
  ds_write_b128 v17, v[40:43] offset:16384
  ds_write_b128 v17, v[44:47] offset:17408
  ds_write_b128 v17, v[48:51] offset:18432
  ds_write_b128 v17, v[52:55] offset:19456
  ds_write_b128 v17, v[56:59] offset:20480
  ds_write_b128 v17, v[60:63] offset:21504
  ds_write_b128 v17, v[64:67] offset:22528
  ds_write_b128 v17, v[68:71] offset:23552
  ds_write_b128 v17, v[72:75] offset:24576
  ds_write_b128 v17, v[76:79] offset:25600
  ds_write_b128 v17, v[80:83] offset:26624
  ds_write_b128 v17, v[84:87] offset:27648
  ds_write_b128 v17, v[88:91] offset:28672
  ds_write_b128 v17, v[92:95] offset:29696
  ds_write_b128 v17, v[96:99] offset:30720
  ds_write_b128 v17, v[100:103] offset:31744
  s_waitcnt lgkmcnt(0)
  v_and_b32 v11, 7, v1
  v_lshlrev_b32 v11, 2, v11
  s_mov_b32 s42, 0
vf_3:
  buffer_load_dword v10, v11, s[8:11], 0 offen sc0 sc1
  s_add_u32 s42, s42, 1
  s_waitcnt vmcnt(0)
  v_readlane_b32 s43, v10, s31
  v_lshrrev_b32 v10, 22, v10
  v_cmp_ne_u32 vcc, 32, v10
  s_cbranch_vccz vk_4
  s_movk_i32 s41, 1
  s_cmp_gt_u32 s42, 262144
  s_cbranch_scc1 L_fail
  s_sleep 2
  s_branch vf_3
vk_4:
  s_and_b32 s40, s43, 0x1ff
  s_mul_i32 s40, s40, s40
  s_bfe_u32 s41, s43, 0xd0009
  s_lshl_b32 s41, s41, 5
  s_cmp_eq_u32 s40, s41
  s_cselect_b32 s47, 1, 0
  s_lshl_b32 s40, s28, 11
  v_add_u32 v5, s40, v2
  s_add_u32 s38, s40, 16384
  s_add_u32 s40, s40, 24576
  v_bfe_u32 v6, v1, 4, 2
  v_lshlrev_b32 v6, 9, v6
  v_bfe_u32 v10, v1, 0, 4
  v_lshl_add_u32 v6, v10, 4, v6
  v_add_u32 v6, s40, v6
  v_bfe_u32 v7, v1, 4, 2
  v_lshlrev_b32 v7, 9, v7
  v_bfe_u32 v10, v1, 3, 1
  v_lshl_add_u32 v7, v10, 8, v7
  v_bfe_u32 v10, v1, 2, 1
  v_lshl_add_u32 v7, v10, 6, v7
  v_bfe_u32 v10, v1, 0, 2
  v_lshl_add_u32 v7, v10, 4, v7
  v_add_u32 v7, 16384, v7
  s_lshl_b32 s40, s28, 9
  s_add_u32 s41, s40, 8192
  v_bfe_u32 v8, v1, 5, 1
  v_lshlrev_b32 v8, 8, v8
  v_bfe_u32 v10, v1, 0, 4
  v_lshl_add_u32 v8, v10, 4, v8
  v_bfe_u32 v10, v1, 4, 1
  v_lshl_add_u32 v8, v10, 3, v8
  v_add_u32 v8, s41, v8
  v_bfe_u32 v12, v1, 5, 1
  v_lshlrev_b32 v12, 8, v12
  v_bfe_u32 v10, v1, 4, 1
  v_lshl_add_u32 v12, v10, 6, v12
  v_bfe_u32 v10, v1, 2, 2
  v_lshl_add_u32 v12, v10, 4, v12
  v_bfe_u32 v10, v1, 0, 1
  v_lshl_add_u32 v12, v10, 3, v12
  v_add_u32 v12, 8192, v12
  v_add_u32 v13, s40, v12
  v_bfe_u32 v14, v1, 4, 2
  v_lshlrev_b32 v14, 7, v14
  v_bfe_u32 v10, v1, 0, 3
  v_lshl_add_u32 v14, v10, 4, v14
  v_add_u32 v14, s40, v14
  v_bfe_u32 v4, v1, 4, 2
  v_lshlrev_b32 v4, 7, v4
  v_bfe_u32 v10, v1, 0, 3
  v_lshl_add_u32 v4, v10, 4, v4
  v_bfe_u32 v10, v1, 3, 1
  v_lshl_add_u32 v4, v10, 11, v4
  v_add_u32 v4, s40, v4
  v_bfe_u32 v15, v1, 4, 1
  v_lshlrev_b32 v15, 8, v15
  v_bfe_u32 v10, v1, 5, 1
  v_lshl_add_u32 v15, v10, 7, v15
  v_bfe_u32 v10, v1, 0, 4
  v_lshl_add_u32 v15, v10, 3, v15
  v_add_u32 v15, s40, v15
  s_lshl_b32 s40, s49, 4
  v_bfe_u32 v9, v1, 0, 2
  v_lshlrev_b32 v9, 2, v9
  v_add_u32 v9, s40, v9
  s_lshl_b32 s40, s28, 16
  s_lshl_b32 s41, s49, 6
  s_add_u32 s40, s40, s41
  v_bfe_u32 v18, v1, 5, 1
  v_lshlrev_b32 v18, 14, v18
  v_bfe_u32 v10, v1, 2, 2
  v_lshl_add_u32 v18, v10, 12, v18
  v_bfe_u32 v10, v1, 4, 1
  v_lshl_add_u32 v18, v10, 11, v18
  v_bfe_u32 v10, v1, 0, 2
  v_lshl_add_u32 v18, v10, 4, v18
  v_add_u32 v18, s40, v18
  s_lshl_b32 s52, s49, 2
  s_add_u32 s52, s52, s28
  s_lshl_b32 s40, s52, 6
  v_bfe_u32 v19, v1, 0, 2
  v_lshlrev_b32 v19, 4, v19
  v_bfe_u32 v10, v1, 4, 1
  v_lshl_add_u32 v19, v10, 3, v19
  v_bfe_u32 v10, v1, 5, 1
  v_lshl_add_u32 v19, v10, 2, v19
  v_add_u32 v19, s40, v19
  s_lshl_b32 s53, s50, 18
  s_add_u32 s53, s53, 524288
  s_add_u32 s54, s53, 0x8000
  s_lshl_b32 s55, s52, 11
  s_add_u32 s55, s55, s53
  s_lshl_b32 s52, s52, 2
  s_lshl_b32 s56, s50, 15
  s_add_u32 s56, s56, 1048576
  s_add_u32 s57, s56, 0x2000
  s_add_u32 s58, s56, 0x4000
  s_lshl_b32 s35, s50, 6
  s_add_u32 s34, s35, 63
  s_mov_b32 s59, 1
  s_mov_b32 s44, 1040356334
  s_mov_b32 s60, -1
  s_mov_b32 s61, 0
  s_mov_b32 s62, 0xff00ff00
  s_mov_b32 s63, 0xff00ff00
  s_lshl_b32 s51, s49, 13
  s_lshl_b32 s48, s49, 11
  v_and_b32 v11, 15, v1
  v_mov_b32 v16, 0x4444
  v_mov_b32 v10, 0xeeee
  v_cmp_le_u32 vcc, 8, v11
  s_nop 1
  v_cndmask_b32 v16, v16, v10, vcc
  v_mov_b32 v0, -1
  v_mov_b32 v10, 0x3f80
  v_mov_b32 v24, 1.0
  v_cmp_eq_u32 vcc, 0, v11
  s_nop 1
  v_cndmask_b32 v20, 0, v10, vcc
  v_cmp_eq_u32 vcc, 4, v11
  s_nop 1
  v_cndmask_b32 v20, v20, v24, vcc
  v_cmp_eq_u32 vcc, 1, v11
  s_nop 1
  v_cndmask_b32 v21, 0, v10, vcc
  v_cmp_eq_u32 vcc, 5, v11
  s_nop 1
  v_cndmask_b32 v21, v21, v24, vcc
  v_cmp_eq_u32 vcc, 2, v11
  s_nop 1
  v_cndmask_b32 v22, 0, v10, vcc
  v_cmp_eq_u32 vcc, 6, v11
  s_nop 1
  v_cndmask_b32 v22, v22, v24, vcc
  v_cmp_eq_u32 vcc, 3, v11
  s_nop 1
  v_cndmask_b32 v23, 0, v10, vcc
  v_cmp_eq_u32 vcc, 7, v11
  s_nop 1
  v_cndmask_b32 v23, v23, v24, vcc
  s_lshl_b32 s40, s28, 8
  v_bfe_u32 v11, v1, 0, 3
  v_lshlrev_b32 v11, 10, v11
  v_bfe_u32 v10, v1, 5, 1
  v_lshl_add_u32 v11, v10, 6, v11
  v_bfe_u32 v10, v1, 3, 2
  v_lshl_add_u32 v11, v10, 3, v11
  v_add_u32 v11, s40, v11
  buffer_load_dwordx2 v[80:81], v11, s[12:15], 0 offen offset:0
  buffer_load_dwordx2 v[82:83], v11, s[12:15], 0 offen offset:32
  buffer_load_dwordx2 v[84:85], v11, s[12:15], 0 offen offset:128
  buffer_load_dwordx2 v[86:87], v11, s[12:15], 0 offen offset:160
  s_lshl_b32 s39, s35, 18
  s_add_u32 s39, s39, s51
  s_add_u32 s30, s39, 132120576
  s_add_u32 s31, s39, 165675008
  s_lshl_b32 s32, s35, 16
  s_add_u32 s32, s32, s48
  s_add_u32 s32, s32, 18874368
  s_lshl_b32 s33, s35, 9
  s_add_u32 s33, s33, 65536
  s_mov_b32 s40, 0
poll_5:
  buffer_load_dword v10, v9, s[4:7], s33 offen sc1
  s_add_u32 s40, s40, 1
  s_waitcnt vmcnt(0)
  v_cmp_eq_u32 vcc, 0, v10
  s_cbranch_vccz pd_6
  s_movk_i32 s41, 50
  s_cmp_gt_u32 s40, 262144
  s_cbranch_scc1 L_fail
  s_sleep 1
  s_branch poll_5
pd_6:
  s_mov_b32 m0, s38
  s_nop 0
  buffer_load_dwordx4 v5, s[4:7], s30 offen offset:0 sc1 lds
  buffer_load_dwordx4 v5, s[4:7], s30 offen offset:1024 sc1 lds
  s_add_u32 m0, s38, 0x2000
  s_add_u32 s30, s30, 0x40000
  buffer_load_dwordx4 v5, s[4:7], s31 offen offset:0 sc1 lds
  buffer_load_dwordx4 v5, s[4:7], s31 offen offset:1024 sc1 lds
  s_add_u32 s31, s31, 0x40000
  s_mov_b32 s40, 0x05040100
  s_mov_b32 s41, 0x07060302
  v_perm_b32 v64, v82, v80, s40
  v_perm_b32 v65, v82, v80, s41
  v_perm_b32 v66, v83, v81, s40
  v_perm_b32 v67, v83, v81, s41
  v_perm_b32 v68, v86, v84, s40
  v_perm_b32 v69, v86, v84, s41
  v_perm_b32 v70, v87, v85, s40
  v_perm_b32 v71, v87, v85, s41
  v_mov_b64 v[112:113], 0
  v_mov_b64 v[114:115], 0
  v_mov_b64 v[116:117], 0
  v_mov_b64 v[118:119], 0
  v_mov_b64 v[120:121], 0
  v_mov_b64 v[122:123], 0
  v_mov_b64 v[124:125], 0
  v_mov_b64 v[126:127], 0
  s_add_u32 s33, s33, 512
  buffer_load_dword v1, v9, s[4:7], s33 offen sc1
  s_mov_b32 s43, 491520
  s_waitcnt vmcnt(0)
  s_barrier
  ds_read_b128 v[32:35], v7 offset:0
  ds_read_b128 v[36:39], v7 offset:2048
  ds_read_b128 v[40:43], v7 offset:4096
  ds_read_b128 v[44:47], v7 offset:6144
  ds_read_b128 v[48:51], v7 offset:128
  ds_read_b128 v[52:55], v7 offset:2176
  ds_read_b128 v[56:59], v7 offset:4224
  ds_read_b128 v[60:63], v7 offset:6272
  ds_read_b128 v[24:27], v6 offset:0
  ds_read_b128 v[28:31], v6 offset:256
  s_cmp_eq_u32 s47, 0
  s_cbranch_scc1 L_CHs_in
  s_branch L_CHf_in
L_CHf:
  s_mov_b32 s40, 0
L_CHf_g:
  buffer_load_dwordx4 v[64:67], v5, s[4:7], s56 offen offset:0 sc1
  buffer_load_dwordx4 v[68:71], v5, s[4:7], s56 offen offset:1024 sc1
  s_add_u32 s40, s40, 1
  s_movk_i32 s41, 51
  s_cmp_gt_u32 s40, 262144
  s_cbranch_scc1 L_fail
  s_waitcnt vmcnt(1)
  v_max3_u32 v11, v64, v65, v66
  v_max_u32 v11, v11, v67
  s_waitcnt vmcnt(0)
  v_max3_u32 v10, v68, v69, v70
  v_max3_u32 v11, v11, v71, v10
  v_cmp_eq_u32 vcc, -1, v11
  s_cbranch_vccnz L_CHf_g
L_CHf_in:
  ds_write_b128 v5, v[64:67]
  ds_write_b128 v5, v[68:71] offset:1024
  v_cmp_eq_u32 vcc, 0, v1
  s_cmp_eq_u32 s35, s34
  s_cselect_b64 s[36:37], -1, vcc
  s_cmp_lg_u64 s[36:37], 0
  s_cselect_b32 s42, 0, 0x40000
  s_mov_b64 vcc, s[36:37]
  s_mov_b32 m0, s38
  s_waitcnt lgkmcnt(0)
  s_barrier
  ds_read_b128 v[64:67], v2 offset:0
  ds_read_b128 v[68:71], v2 offset:1024
  ds_read_b128 v[72:75], v2 offset:2048
  ds_read_b128 v[76:79], v2 offset:3072
  ds_read_b128 v[80:83], v2 offset:4096
  ds_read_b128 v[84:87], v2 offset:5120
  ds_read_b128 v[88:91], v2 offset:6144
  ds_read_b128 v[92:95], v2 offset:7168
  s_waitcnt lgkmcnt(7)
  v_smfmac_f32_16x16x64_bf16 v[112:115], v[64:67], a[0:7], v16
  v_smfmac_f32_16x16x64_bf16 v[116:119], v[64:67], a[8:15], v16
  s_cbranch_vccnz L_CHf_nks300
  buffer_load_dwordx4 v5, s[4:7], s30 offen offset:0 sc1 lds
L_CHf_nks300:
  s_waitcnt lgkmcnt(6)
  v_smfmac_f32_16x16x64_bf16 v[112:115], v[68:71], a[16:23], v16
  v_smfmac_f32_16x16x64_bf16 v[116:119], v[68:71], a[24:31], v16
  s_cbranch_vccnz L_CHf_nks301
  buffer_load_dwordx4 v5, s[4:7], s30 offen offset:1024 sc1 lds
L_CHf_nks301:
  s_waitcnt lgkmcnt(5)
  v_smfmac_f32_16x16x64_bf16 v[112:115], v[72:75], a[32:39], v16
  v_smfmac_f32_16x16x64_bf16 v[116:119], v[72:75], a[40:47], v16
  s_add_u32 m0, s38, 0x2000
  s_add_u32 s30, s30, s42
  s_waitcnt lgkmcnt(4)
  v_smfmac_f32_16x16x64_bf16 v[112:115], v[76:79], a[48:55], v16
  v_smfmac_f32_16x16x64_bf16 v[116:119], v[76:79], a[56:63], v16
  s_cbranch_vccnz L_CHf_nks310
  buffer_load_dwordx4 v5, s[4:7], s31 offen offset:0 sc1 lds
L_CHf_nks310:
  s_waitcnt lgkmcnt(3)
  v_smfmac_f32_16x16x64_bf16 v[112:115], v[80:83], a[64:71], v16
  v_smfmac_f32_16x16x64_bf16 v[116:119], v[80:83], a[72:79], v16
  s_cbranch_vccnz L_CHf_nks311
  buffer_load_dwordx4 v5, s[4:7], s31 offen offset:1024 sc1 lds
L_CHf_nks311:
  s_waitcnt lgkmcnt(2)
  v_smfmac_f32_16x16x64_bf16 v[112:115], v[84:87], a[80:87], v16
  v_smfmac_f32_16x16x64_bf16 v[116:119], v[84:87], a[88:95], v16
  s_add_u32 s31, s31, s42
  s_waitcnt lgkmcnt(1)
  v_smfmac_f32_16x16x64_bf16 v[112:115], v[88:91], a[96:103], v16
  s_mov_b64 exec, 1
  buffer_store_dword v0, v3, s[4:7], s43 offen sc1
  s_mov_b64 exec, -1
  v_smfmac_f32_16x16x64_bf16 v[116:119], v[88:91], a[104:111], v16
  s_waitcnt lgkmcnt(0)
  v_smfmac_f32_16x16x64_bf16 v[112:115], v[92:95], a[112:119], v16
  v_smfmac_f32_16x16x64_bf16 v[116:119], v[92:95], a[120:127], v16
  v_smfmac_f32_16x16x64_bf16 v[120:123], v[64:67], a[128:135], v16
  v_smfmac_f32_16x16x64_bf16 v[124:127], v[64:67], a[136:143], v16
  v_smfmac_f32_16x16x64_bf16 v[120:123], v[68:71], a[144:151], v16
  v_smfmac_f32_16x16x64_bf16 v[124:127], v[68:71], a[152:159], v16
  s_nop 3
  v_permlane32_swap_b32 v112, v116
  v_permlane32_swap_b32 v113, v117
  v_smfmac_f32_16x16x64_bf16 v[120:123], v[72:75], a[160:167], v16
  v_permlane32_swap_b32 v114, v118
  v_permlane32_swap_b32 v115, v119
  v_smfmac_f32_16x16x64_bf16 v[124:127], v[72:75], a[168:175], v16
  v_add_f32 v112, v112, v116
  v_add_f32 v113, v113, v117
  v_smfmac_f32_16x16x64_bf16 v[120:123], v[76:79], a[176:183], v16
  v_add_f32 v114, v114, v118
  v_add_f32 v115, v115, v119
  v_smfmac_f32_16x16x64_bf16 v[124:127], v[76:79], a[184:191], v16
  v_cvt_pk_bf16_f32 v10, v112, v113
  v_cvt_pk_bf16_f32 v11, v114, v115
  v_smfmac_f32_16x16x64_bf16 v[120:123], v[80:83], a[192:199], v16
  ds_write_b64 v8, v[10:11]
  s_waitcnt lgkmcnt(0)
  v_smfmac_f32_16x16x64_bf16 v[124:127], v[80:83], a[200:207], v16
  s_barrier
  ds_read_b64_tr_b16 v[96:97], v12 offset:0
  v_smfmac_f32_16x16x64_bf16 v[120:123], v[84:87], a[208:215], v16
  ds_read_b64_tr_b16 v[98:99], v12 offset:128
  ds_read_b64_tr_b16 v[100:101], v12 offset:512
  v_smfmac_f32_16x16x64_bf16 v[124:127], v[84:87], a[216:223], v16
  ds_read_b64_tr_b16 v[102:103], v12 offset:640
  ds_read_b64_tr_b16 v[104:105], v12 offset:1024
  v_smfmac_f32_16x16x64_bf16 v[120:123], v[88:91], a[224:231], v16
  ds_read_b64_tr_b16 v[106:107], v12 offset:1152
  ds_read_b64_tr_b16 v[108:109], v12 offset:1536
  v_smfmac_f32_16x16x64_bf16 v[124:127], v[88:91], a[232:239], v16
  ds_read_b64_tr_b16 v[110:111], v12 offset:1664
  v_smfmac_f32_16x16x64_bf16 v[120:123], v[92:95], a[240:247], v16
  v_smfmac_f32_16x16x64_bf16 v[124:127], v[92:95], a[248:255], v16
  s_waitcnt lgkmcnt(6)
  v_mfma_f32_16x16x32_bf16 v[112:115], v[32:35], v[96:99], 0
  v_mfma_f32_16x16x32_bf16 v[116:119], v[48:51], v[96:99], 0
  s_waitcnt lgkmcnt(4)
  v_mfma_f32_16x16x32_bf16 v[112:115], v[36:39], v[100:103], v[112:115]
  v_mfma_f32_16x16x32_bf16 v[116:119], v[52:55], v[100:103], v[116:119]
  s_waitcnt lgkmcnt(0)
  v_mfma_f32_16x16x32_bf16 v[112:115], v[40:43], v[104:107], v[112:115]
  v_permlane32_swap_b32 v120, v124
  v_permlane32_swap_b32 v121, v125
  v_permlane32_swap_b32 v122, v126
  v_mfma_f32_16x16x32_bf16 v[116:119], v[56:59], v[104:107], v[116:119]
  v_permlane32_swap_b32 v123, v127
  v_add_f32 v120, v120, v124
  v_add_f32 v121, v121, v125
  v_mfma_f32_16x16x32_bf16 v[112:115], v[44:47], v[108:111], v[112:115]
  v_add_f32 v122, v122, v126
  v_add_f32 v123, v123, v127
  v_cvt_pk_bf16_f32 v10, v120, v121
  v_mfma_f32_16x16x32_bf16 v[116:119], v[60:63], v[108:111], v[116:119]
  v_cvt_pk_bf16_f32 v11, v122, v123
  ds_write_b64 v8, v[10:11] offset:2048
  v_mov_b64 v[120:121], 0
  v_mov_b64 v[122:123], 0
  v_mov_b64 v[124:125], 0
  v_mov_b64 v[126:127], 0
  s_waitcnt lgkmcnt(0)
  s_barrier
  v_smfmac_f32_16x16x64_bf16 v[120:123], v[64:67], v[128:135], v16
  ds_read_b64_tr_b16 v[32:33], v12 offset:2048
  ds_read_b64_tr_b16 v[34:35], v12 offset:2176
  v_smfmac_f32_16x16x64_bf16 v[124:127], v[64:67], v[136:143], v16
  ds_read_b64_tr_b16 v[36:37], v12 offset:2560
  ds_read_b64_tr_b16 v[38:39], v12 offset:2688
  v_smfmac_f32_16x16x64_bf16 v[120:123], v[68:71], v[144:151], v16
  ds_read_b64_tr_b16 v[40:41], v12 offset:3072
  ds_read_b64_tr_b16 v[42:43], v12 offset:3200
  v_smfmac_f32_16x16x64_bf16 v[124:127], v[68:71], v[152:159], v16
  ds_read_b64_tr_b16 v[44:45], v12 offset:3584
  ds_read_b64_tr_b16 v[46:47], v12 offset:3712
  v_smfmac_f32_16x16x64_bf16 v[120:123], v[72:75], v[160:167], v16
  ds_read_b64_tr_b16 v[52:53], v13 offset:2048
  ds_read_b64_tr_b16 v[54:55], v13 offset:2176
  v_smfmac_f32_16x16x64_bf16 v[124:127], v[72:75], v[168:175], v16
  v_cndmask_b32 v112, v112, v116, s[62:63]
  v_cndmask_b32 v113, v113, v117, s[62:63]
  v_smfmac_f32_16x16x64_bf16 v[120:123], v[76:79], v[176:183], v16
  v_cndmask_b32 v114, v114, v118, s[62:63]
  v_cndmask_b32 v115, v115, v119, s[62:63]
  v_max3_f32 v10, v112, v113, v114
  v_max_f32 v10, v10, v115
  s_waitcnt lgkmcnt(8)
  v_mfma_f32_16x16x32_bf16 v[48:51], v[32:35], v[96:99], 0
  s_waitcnt lgkmcnt(6)
  v_mfma_f32_16x16x32_bf16 v[48:51], v[36:39], v[100:103], v[48:51]
  s_waitcnt lgkmcnt(4)
  v_mfma_f32_16x16x32_bf16 v[48:51], v[40:43], v[104:107], v[48:51]
  s_waitcnt lgkmcnt(2)
  v_mfma_f32_16x16x32_bf16 v[48:51], v[44:47], v[108:111], v[48:51]
  s_waitcnt lgkmcnt(0)
  buffer_store_dwordx4 v[52:55], v14, s[4:7], s32 offen sc1
  v_smfmac_f32_16x16x64_bf16 v[124:127], v[76:79], v[184:191], v16
  v_smfmac_f32_16x16x64_bf16 v[120:123], v[80:83], v[192:199], v16
  v_smfmac_f32_16x16x64_bf16 v[124:127], v[80:83], v[200:207], v16
  s_nop 2
  v_cndmask_b32 v48, v48, v50, s[62:63]
  v_cndmask_b32 v49, v49, v51, s[62:63]
  v_smfmac_f32_16x16x64_bf16 v[120:123], v[84:87], v[208:215], v16
  v_max3_f32 v10, v10, v48, v49
  ds_read_b128 v[96:99], v17 offset:0
  s_nop 0
  v_max_f32_dpp v10, v10, v10 row_ror:8 row_mask:0xf bank_mask:0xf
  v_smfmac_f32_16x16x64_bf16 v[124:127], v[84:87], v[216:223], v16
  v_mov_b32 v11, v10
  ds_read_b128 v[100:103], v17 offset:1024
  s_nop 0
  v_permlane16_swap_b32 v10, v11
  v_smfmac_f32_16x16x64_bf16 v[120:123], v[88:91], v[224:231], v16
  v_max_f32 v10, v10, v11
  ds_read_b128 v[104:107], v17 offset:2048
  v_mov_b32 v11, v10
  v_smfmac_f32_16x16x64_bf16 v[124:127], v[88:91], v[232:239], v16
  s_nop 0
  v_permlane32_swap_b32 v10, v11
  ds_read_b128 v[108:111], v17 offset:3072
  v_max_f32 v10, v10, v11
  v_smfmac_f32_16x16x64_bf16 v[120:123], v[92:95], v[240:247], v16
  v_mul_f32 v10, s44, v10
  ds_read_b128 v[56:59], v17 offset:16384
  v_smfmac_f32_16x16x64_bf16 v[124:127], v[92:95], v[248:255], v16
  v_fma_f32 v112, v112, s44, -v10
  v_fma_f32 v113, v113, s44, -v10
  v_fma_f32 v114, v114, s44, -v10
  ds_read_b128 v[60:63], v17 offset:17408
  v_fma_f32 v115, v115, s44, -v10
  ds_read_b128 v[32:35], v17 offset:18432
  v_fma_f32 v48, v48, s44, -v10
  ds_read_b128 v[36:39], v17 offset:19456
  v_fma_f32 v49, v49, s44, -v10
  ds_read_b128 v[40:43], v17 offset:4096
  v_exp_f32 v112, v112
  ds_read_b128 v[44:47], v17 offset:5120
  v_exp_f32 v113, v113
  v_exp_f32 v114, v114
  v_exp_f32 v115, v115
  v_exp_f32 v48, v48
  v_exp_f32 v49, v49
  v_permlane32_swap_b32 v120, v124
  v_permlane32_swap_b32 v121, v125
  v_permlane32_swap_b32 v122, v126
  v_permlane32_swap_b32 v123, v127
  v_add_f32 v120, v120, v124
  v_add_f32 v121, v121, v125
  v_add_f32 v122, v122, v126
  v_add_f32 v123, v123, v127
  v_cvt_pk_bf16_f32 v124, v112, v113
  v_cvt_pk_bf16_f32 v125, v114, v115
  v_cvt_pk_bf16_f32 v50, v48, v49
  v_cvt_pk_bf16_f32 v120, v120, v121
  v_cvt_pk_bf16_f32 v121, v122, v123
  v_mov_b32_dpp v126, v124 row_ror:8 row_mask:0xf bank_mask:0xf
  v_mov_b32_dpp v127, v125 row_ror:8 row_mask:0xf bank_mask:0xf
  v_mov_b32_dpp v51, v50 row_ror:8 row_mask:0xf bank_mask:0xf
  v_add_f32 v10, v112, v113
  v_add_f32 v11, v114, v115
  v_mfma_f32_16x16x32_bf16 v[116:119], v[28:31], v[124:127], 0
  v_add_f32 v48, v48, v49
  v_add_f32 v10, v10, v11
  v_mfma_f32_16x16x32_bf16 v[112:115], v[24:27], v[124:127], 0
  v_cndmask_b32 v122, 0, v120, s[60:61]
  v_cndmask_b32 v123, 0, v121, s[60:61]
  v_cndmask_b32 v52, v120, 0, s[60:61]
  v_cndmask_b32 v53, v121, 0, s[60:61]
  v_fma_f32 v10, v48, 0.5, v10
  s_add_u32 s39, s32, 8388608
  v_mfma_f32_16x16x16bf16_1k v[116:119], v[52:53], v[50:51], v[116:119]
  v_mfma_f32_16x16x16bf16_1k v[112:115], v[122:123], v[50:51], v[112:115]
  buffer_store_dwordx2 v[120:121], v15, s[4:7], s39 offen sc1
  s_cmp_eq_u32 s35, s34
  s_cbranch_scc1 L_CH_last
  v_add_f32_dpp v10, v10, v10 row_ror:8 row_mask:0xf bank_mask:0xf
  ds_read_b128 v[80:83], v17 offset:6144
  v_mov_b32 v11, v10
  ds_read_b128 v[84:87], v17 offset:7168
  s_nop 0
  v_permlane16_swap_b32 v10, v11
  ds_read_b128 v[88:91], v17 offset:20480
  v_add_f32 v10, v10, v11
  ds_read_b128 v[92:95], v17 offset:21504
  v_mov_b32 v11, v10
  v_mov_b64 v[64:65], 0
  s_nop 0
  v_permlane32_swap_b32 v10, v11
  v_mov_b64 v[66:67], 0
  v_add_f32 v10, v10, v11
  v_mov_b64 v[68:69], 0
  v_rcp_f32 v10, v10
  v_mov_b64 v[70:71], 0
  v_mov_b64 v[72:73], 0
  v_mov_b64 v[74:75], 0
  v_mov_b64 v[76:77], 0
  v_mov_b64 v[78:79], 0
  v_mul_f32 v112, v112, v10
  v_mul_f32 v113, v113, v10
  v_mul_f32 v114, v114, v10
  v_mul_f32 v115, v115, v10
  v_mul_f32 v116, v116, v10
  v_mul_f32 v117, v117, v10
  v_mul_f32 v118, v118, v10
  v_mul_f32 v119, v119, v10
  v_cvt_pk_bf16_f32 v48, v112, v113
  v_cvt_pk_bf16_f32 v49, v114, v115
  v_cvt_pk_bf16_f32 v50, v116, v117
  v_cvt_pk_bf16_f32 v51, v118, v119
  ds_write_b128 v4, v[48:51] offset:12288
  s_cmp_lg_u64 s[36:37], 0
  s_cbranch_scc1 L_CHf_late
  s_waitcnt vmcnt(3)
L_CHf_lr:
  v_mov_b64 v[112:113], 0
  v_mov_b64 v[114:115], 0
  v_mov_b64 v[116:117], 0
  v_mov_b64 v[118:119], 0
  v_mov_b64 v[120:121], 0
  v_mov_b64 v[122:123], 0
  v_mov_b64 v[124:125], 0
  v_mov_b64 v[126:127], 0
  s_waitcnt lgkmcnt(0)
  s_barrier
  ds_read_b128 v[24:27], v2 offset:12288
  ds_read_b128 v[28:31], v2 offset:13312
  s_add_u32 s33, s33, 512
  buffer_load_dword v1, v9, s[4:7], s33 offen sc1
  s_lshl_b32 s43, s35, 9
  s_add_u32 s43, s43, 131072
  s_add_u32 s43, s43, s52
  s_add_u32 s32, s32, 0x10000
  s_add_u32 s35, s35, 1
  s_waitcnt lgkmcnt(1)
  v_smfmac_f32_16x16x64_bf16 v[112:115], v[24:27], v[96:103], v16
  ds_read_b128 v[96:99], v17 offset:22528
  ds_read_b128 v[100:103], v17 offset:23552
  v_smfmac_f32_16x16x64_bf16 v[116:119], v[24:27], v[104:111], v16
  ds_read_b128 v[104:107], v17 offset:8192
  ds_read_b128 v[108:111], v17 offset:9216
  s_waitcnt lgkmcnt(4)
  v_smfmac_f32_16x16x64_bf16 v[112:115], v[28:31], v[56:63], v16
  ds_read_b128 v[56:59], v17 offset:10240
  ds_read_b128 v[60:63], v17 offset:11264
  v_smfmac_f32_16x16x64_bf16 v[116:119], v[28:31], v[32:39], v16
  ds_read_b128 v[32:35], v17 offset:24576
  ds_read_b128 v[36:39], v17 offset:25600
  v_smfmac_f32_16x16x64_bf16 v[120:123], v[24:27], v[40:47], v16
  ds_read_b128 v[40:43], v17 offset:26624
  ds_read_b128 v[44:47], v17 offset:27648
  v_smfmac_f32_16x16x64_bf16 v[124:127], v[24:27], v[80:87], v16
  ds_read_b128 v[80:83], v17 offset:12288
  ds_read_b128 v[84:87], v17 offset:13312
  v_smfmac_f32_16x16x64_bf16 v[120:123], v[28:31], v[88:95], v16
  ds_read_b128 v[88:91], v17 offset:14336
  ds_read_b128 v[92:95], v17 offset:15360
  s_waitcnt lgkmcnt(12)
  v_smfmac_f32_16x16x64_bf16 v[124:127], v[28:31], v[96:103], v16
  ds_read_b128 v[96:99], v17 offset:28672
  ds_read_b128 v[100:103], v17 offset:29696
  s_waitcnt lgkmcnt(12)
  v_smfmac_f32_16x16x64_bf16 v[64:67], v[24:27], v[104:111], v16
  ds_read_b128 v[104:107], v17 offset:30720
  ds_read_b128 v[108:111], v17 offset:31744
  v_permlane32_swap_b32 v112, v116
  v_permlane32_swap_b32 v113, v117
  s_waitcnt lgkmcnt(12)
  v_smfmac_f32_16x16x64_bf16 v[68:71], v[24:27], v[56:63], v16
  v_permlane32_swap_b32 v114, v118
  v_permlane32_swap_b32 v115, v119
  s_waitcnt lgkmcnt(10)
  v_smfmac_f32_16x16x64_bf16 v[64:67], v[28:31], v[32:39], v16
  v_add_f32 v112, v112, v116
  v_add_f32 v113, v113, v117
  v_add_f32 v114, v114, v118
  s_waitcnt lgkmcnt(8)
  v_smfmac_f32_16x16x64_bf16 v[68:71], v[28:31], v[40:47], v16
  v_add_f32 v115, v115, v119
  v_permlane32_swap_b32 v120, v124
  v_permlane32_swap_b32 v121, v125
  s_waitcnt lgkmcnt(6)
  v_smfmac_f32_16x16x64_bf16 v[72:75], v[24:27], v[80:87], v16
  v_permlane32_swap_b32 v122, v126
  v_permlane32_swap_b32 v123, v127
  v_add_f32 v120, v120, v124
  s_waitcnt lgkmcnt(4)
  v_smfmac_f32_16x16x64_bf16 v[76:79], v[24:27], v[88:95], v16
  v_add_f32 v121, v121, v125
  v_add_f32 v122, v122, v126
  v_add_f32 v123, v123, v127
  s_waitcnt lgkmcnt(2)
  v_smfmac_f32_16x16x64_bf16 v[72:75], v[28:31], v[96:103], v16
  v_cvt_pk_bf16_f32 v112, v112, v120
  v_cvt_pk_bf16_f32 v113, v113, v121
  v_cvt_pk_bf16_f32 v114, v114, v122
  s_waitcnt lgkmcnt(0)
  v_smfmac_f32_16x16x64_bf16 v[76:79], v[28:31], v[104:111], v16
  v_cvt_pk_bf16_f32 v115, v115, v123
  v_and_or_b32 v112, v112, -2, s59
  buffer_store_dwordx4 v[112:115], v18, s[4:7], s53 offen
  v_permlane32_swap_b32 v64, v68
  v_permlane32_swap_b32 v65, v69
  v_permlane32_swap_b32 v66, v70
  v_permlane32_swap_b32 v67, v71
  v_add_f32 v64, v64, v68
  v_add_f32 v65, v65, v69
  v_add_f32 v66, v66, v70
  v_add_f32 v67, v67, v71
  v_permlane32_swap_b32 v72, v76
  v_permlane32_swap_b32 v73, v77
  v_permlane32_swap_b32 v74, v78
  v_permlane32_swap_b32 v75, v79
  v_add_f32 v72, v72, v76
  v_add_f32 v73, v73, v77
  v_add_f32 v74, v74, v78
  v_add_f32 v75, v75, v79
  v_cvt_pk_bf16_f32 v64, v64, v72
  v_cvt_pk_bf16_f32 v65, v65, v73
  v_cvt_pk_bf16_f32 v66, v66, v74
  v_cvt_pk_bf16_f32 v67, v67, v75
  v_and_or_b32 v64, v64, -2, s59
  buffer_store_dwordx4 v[64:67], v18, s[4:7], s54 offen
  ds_read_b128 v[32:35], v7 offset:0
  ds_read_b128 v[36:39], v7 offset:2048
  ds_read_b128 v[40:43], v7 offset:4096
  ds_read_b128 v[44:47], v7 offset:6144
  ds_read_b128 v[48:51], v7 offset:128
  ds_read_b128 v[52:55], v7 offset:2176
  ds_read_b128 v[56:59], v7 offset:4224
  ds_read_b128 v[60:63], v7 offset:6272
  ds_read_b128 v[24:27], v6 offset:0
  ds_read_b128 v[28:31], v6 offset:256
  v_mov_b64 v[112:113], 0
  v_mov_b64 v[114:115], 0
  v_mov_b64 v[116:117], 0
  v_mov_b64 v[118:119], 0
  v_mov_b64 v[120:121], 0
  v_mov_b64 v[122:123], 0
  v_mov_b64 v[124:125], 0
  v_mov_b64 v[126:127], 0
  s_mov_b32 s40, 0
  s_waitcnt vmcnt(0)
L_CHf_p:
  buffer_load_dwordx4 v[80:83], v2, s[4:7], s55 offen offset:0 sc1
  buffer_load_dwordx4 v[84:87], v2, s[4:7], s55 offen offset:1024 sc1
  s_add_u32 s40, s40, 1
  s_movk_i32 s41, 53
  s_cmp_gt_u32 s40, 262144
  s_cbranch_scc1 L_fail
  s_waitcnt vmcnt(1)
  v_xor_b32 v11, s59, v80
  v_mfma_f32_16x16x32_bf16 v[88:91], v[80:83], v[20:23], 0
  s_waitcnt vmcnt(0)
  v_bitop3_b32 v11, v84, s59, v11 bitop3:0xbe
  v_mfma_f32_16x16x32_bf16 v[88:91], v[84:87], v[20:23], v[88:91]
  v_and_b32 v11, 1, v11
  v_cmp_ne_u32 vcc, 0, v11
  s_cbranch_vccnz L_CHf_p
  s_xor_b32 s59, s59, 1
  s_nop 3
  v_permlane32_swap_b32 v88, v89
  v_permlane32_swap_b32 v90, v91
  v_add_f32 v88, v88, v89
  v_add_f32 v90, v90, v91
  s_nop 1
  v_permlane16_swap_b32 v88, v90
  v_add_f32 v88, v88, v90
  s_mov_b32 s40, s56
  s_mov_b32 s56, s57
  v_mov_b32_dpp v89, v88 row_shl:4 row_mask:0xf bank_mask:0xf
  v_cvt_pk_bf16_f32 v88, v88, v89
  v_min_u32 v88, -2, v88
  s_mov_b32 exec_lo, 0x000f000f
  s_mov_b32 exec_hi, 0x000f000f
  buffer_store_dword v88, v19, s[4:7], s57 offen
  buffer_store_dword v0, v19, s[4:7], s40 offen
  s_mov_b64 exec, -1
  s_mov_b32 s57, s58
  s_mov_b32 s58, s40
  s_waitcnt vmcnt(1)
  s_branch L_CHf
L_CHf_late:
  s_mov_b32 s40, 0
poll_7:
  buffer_load_dword v10, v9, s[4:7], s33 offen sc1
  s_add_u32 s40, s40, 1
  s_waitcnt vmcnt(0)
  v_cmp_eq_u32 vcc, 0, v10
  s_cbranch_vccz pd_8
  s_movk_i32 s41, 52
  s_cmp_gt_u32 s40, 262144
  s_cbranch_scc1 L_fail
  s_sleep 1
  s_branch poll_7
pd_8:
  s_mov_b32 m0, s38
  s_nop 0
  buffer_load_dwordx4 v5, s[4:7], s30 offen offset:0 sc1 lds
  buffer_load_dwordx4 v5, s[4:7], s30 offen offset:1024 sc1 lds
  s_add_u32 m0, s38, 0x2000
  s_add_u32 s30, s30, 0x40000
  buffer_load_dwordx4 v5, s[4:7], s31 offen offset:0 sc1 lds
  buffer_load_dwordx4 v5, s[4:7], s31 offen offset:1024 sc1 lds
  s_add_u32 s31, s31, 0x40000
  s_waitcnt vmcnt(0)
  s_branch L_CHf_lr
L_CHs:
  s_mov_b32 s40, 0
L_CHs_g:
  buffer_load_dwordx4 v[64:67], v5, s[4:7], s56 offen offset:0 sc1
  buffer_load_dwordx4 v[68:71], v5, s[4:7], s56 offen offset:1024 sc1
  s_add_u32 s40, s40, 1
  s_movk_i32 s41, 51
  s_cmp_gt_u32 s40, 262144
  s_cbranch_scc1 L_fail
  s_waitcnt vmcnt(1)
  v_max3_u32 v11, v64, v65, v66
  v_max_u32 v11, v11, v67
  s_waitcnt vmcnt(0)
  v_max3_u32 v10, v68, v69, v70
  v_max3_u32 v11, v11, v71, v10
  v_cmp_eq_u32 vcc, -1, v11
  s_cbranch_vccnz L_CHs_g
L_CHs_in:
  ds_write_b128 v5, v[64:67]
  ds_write_b128 v5, v[68:71] offset:1024
  v_cmp_eq_u32 vcc, 0, v1
  s_cmp_eq_u32 s35, s34
  s_cselect_b64 s[36:37], -1, vcc
  s_cmp_lg_u64 s[36:37], 0
  s_cselect_b32 s42, 0, 0x40000
  s_mov_b64 vcc, s[36:37]
  s_mov_b32 m0, s38
  s_waitcnt lgkmcnt(0)
  s_barrier
  ds_read_b128 v[64:67], v2 offset:0
  ds_read_b128 v[68:71], v2 offset:1024
  ds_read_b128 v[72:75], v2 offset:2048
  ds_read_b128 v[76:79], v2 offset:3072
  ds_read_b128 v[80:83], v2 offset:4096
  ds_read_b128 v[84:87], v2 offset:5120
  ds_read_b128 v[88:91], v2 offset:6144
  ds_read_b128 v[92:95], v2 offset:7168
  s_waitcnt lgkmcnt(7)
  v_smfmac_f32_16x16x64_bf16 v[112:115], v[64:67], a[0:7], v16
  v_smfmac_f32_16x16x64_bf16 v[116:119], v[64:67], a[8:15], v16
  s_cbranch_vccnz L_CHs_nks300
  buffer_load_dwordx4 v5, s[4:7], s30 offen offset:0 sc1 lds
L_CHs_nks300:
  s_waitcnt lgkmcnt(6)
  v_smfmac_f32_16x16x64_bf16 v[112:115], v[68:71], a[16:23], v16
  v_smfmac_f32_16x16x64_bf16 v[116:119], v[68:71], a[24:31], v16
  s_cbranch_vccnz L_CHs_nks301
  buffer_load_dwordx4 v5, s[4:7], s30 offen offset:1024 sc1 lds
L_CHs_nks301:
  s_waitcnt lgkmcnt(5)
  v_smfmac_f32_16x16x64_bf16 v[112:115], v[72:75], a[32:39], v16
  v_smfmac_f32_16x16x64_bf16 v[116:119], v[72:75], a[40:47], v16
  s_add_u32 m0, s38, 0x2000
  s_add_u32 s30, s30, s42
  s_waitcnt lgkmcnt(4)
  v_smfmac_f32_16x16x64_bf16 v[112:115], v[76:79], a[48:55], v16
  v_smfmac_f32_16x16x64_bf16 v[116:119], v[76:79], a[56:63], v16
  s_cbranch_vccnz L_CHs_nks310
  buffer_load_dwordx4 v5, s[4:7], s31 offen offset:0 sc1 lds
L_CHs_nks310:
  s_waitcnt lgkmcnt(3)
  v_smfmac_f32_16x16x64_bf16 v[112:115], v[80:83], a[64:71], v16
  v_smfmac_f32_16x16x64_bf16 v[116:119], v[80:83], a[72:79], v16
  s_cbranch_vccnz L_CHs_nks311
  buffer_load_dwordx4 v5, s[4:7], s31 offen offset:1024 sc1 lds
L_CHs_nks311:
  s_waitcnt lgkmcnt(2)
  v_smfmac_f32_16x16x64_bf16 v[112:115], v[84:87], a[80:87], v16
  v_smfmac_f32_16x16x64_bf16 v[116:119], v[84:87], a[88:95], v16
  s_add_u32 s31, s31, s42
  s_waitcnt lgkmcnt(1)
  v_smfmac_f32_16x16x64_bf16 v[112:115], v[88:91], a[96:103], v16
  s_mov_b64 exec, 1
  buffer_store_dword v0, v3, s[4:7], s43 offen sc1
  s_mov_b64 exec, -1
  v_smfmac_f32_16x16x64_bf16 v[116:119], v[88:91], a[104:111], v16
  s_waitcnt lgkmcnt(0)
  v_smfmac_f32_16x16x64_bf16 v[112:115], v[92:95], a[112:119], v16
  v_smfmac_f32_16x16x64_bf16 v[116:119], v[92:95], a[120:127], v16
  v_smfmac_f32_16x16x64_bf16 v[120:123], v[64:67], a[128:135], v16
  v_smfmac_f32_16x16x64_bf16 v[124:127], v[64:67], a[136:143], v16
  v_smfmac_f32_16x16x64_bf16 v[120:123], v[68:71], a[144:151], v16
  v_smfmac_f32_16x16x64_bf16 v[124:127], v[68:71], a[152:159], v16
  s_nop 3
  v_permlane32_swap_b32 v112, v116
  v_permlane32_swap_b32 v113, v117
  v_smfmac_f32_16x16x64_bf16 v[120:123], v[72:75], a[160:167], v16
  v_permlane32_swap_b32 v114, v118
  v_permlane32_swap_b32 v115, v119
  v_smfmac_f32_16x16x64_bf16 v[124:127], v[72:75], a[168:175], v16
  v_add_f32 v112, v112, v116
  v_add_f32 v113, v113, v117
  v_smfmac_f32_16x16x64_bf16 v[120:123], v[76:79], a[176:183], v16
  v_add_f32 v114, v114, v118
  v_add_f32 v115, v115, v119
  v_smfmac_f32_16x16x64_bf16 v[124:127], v[76:79], a[184:191], v16
  v_cvt_pk_bf16_f32 v10, v112, v113
  v_cvt_pk_bf16_f32 v11, v114, v115
  v_smfmac_f32_16x16x64_bf16 v[120:123], v[80:83], a[192:199], v16
  ds_write_b64 v8, v[10:11]
  s_waitcnt lgkmcnt(0)
  v_smfmac_f32_16x16x64_bf16 v[124:127], v[80:83], a[200:207], v16
  s_barrier
  ds_read_b64_tr_b16 v[96:97], v12 offset:0
  v_smfmac_f32_16x16x64_bf16 v[120:123], v[84:87], a[208:215], v16
  ds_read_b64_tr_b16 v[98:99], v12 offset:128
  ds_read_b64_tr_b16 v[100:101], v12 offset:512
  v_smfmac_f32_16x16x64_bf16 v[124:127], v[84:87], a[216:223], v16
  ds_read_b64_tr_b16 v[102:103], v12 offset:640
  ds_read_b64_tr_b16 v[104:105], v12 offset:1024
  v_smfmac_f32_16x16x64_bf16 v[120:123], v[88:91], a[224:231], v16
  ds_read_b64_tr_b16 v[106:107], v12 offset:1152
  ds_read_b64_tr_b16 v[108:109], v12 offset:1536
  v_smfmac_f32_16x16x64_bf16 v[124:127], v[88:91], a[232:239], v16
  ds_read_b64_tr_b16 v[110:111], v12 offset:1664
  v_smfmac_f32_16x16x64_bf16 v[120:123], v[92:95], a[240:247], v16
  v_smfmac_f32_16x16x64_bf16 v[124:127], v[92:95], a[248:255], v16
  s_waitcnt lgkmcnt(6)
  v_mfma_f32_16x16x32_bf16 v[112:115], v[32:35], v[96:99], 0
  v_mfma_f32_16x16x32_bf16 v[116:119], v[48:51], v[96:99], 0
  s_waitcnt lgkmcnt(4)
  v_mfma_f32_16x16x32_bf16 v[112:115], v[36:39], v[100:103], v[112:115]
  v_mfma_f32_16x16x32_bf16 v[116:119], v[52:55], v[100:103], v[116:119]
  s_waitcnt lgkmcnt(0)
  v_mfma_f32_16x16x32_bf16 v[112:115], v[40:43], v[104:107], v[112:115]
  v_permlane32_swap_b32 v120, v124
  v_permlane32_swap_b32 v121, v125
  v_permlane32_swap_b32 v122, v126
  v_mfma_f32_16x16x32_bf16 v[116:119], v[56:59], v[104:107], v[116:119]
  v_permlane32_swap_b32 v123, v127
  v_add_f32 v120, v120, v124
  v_add_f32 v121, v121, v125
  v_mfma_f32_16x16x32_bf16 v[112:115], v[44:47], v[108:111], v[112:115]
  v_add_f32 v122, v122, v126
  v_add_f32 v123, v123, v127
  v_cvt_pk_bf16_f32 v10, v120, v121
  v_mfma_f32_16x16x32_bf16 v[116:119], v[60:63], v[108:111], v[116:119]
  v_cvt_pk_bf16_f32 v11, v122, v123
  ds_write_b64 v8, v[10:11] offset:2048
  v_mov_b64 v[120:121], 0
  v_mov_b64 v[122:123], 0
  v_mov_b64 v[124:125], 0
  v_mov_b64 v[126:127], 0
  s_waitcnt lgkmcnt(0)
  s_barrier
  v_smfmac_f32_16x16x64_bf16 v[120:123], v[64:67], v[128:135], v16
  ds_read_b64_tr_b16 v[32:33], v12 offset:2048
  ds_read_b64_tr_b16 v[34:35], v12 offset:2176
  v_smfmac_f32_16x16x64_bf16 v[124:127], v[64:67], v[136:143], v16
  ds_read_b64_tr_b16 v[36:37], v12 offset:2560
  ds_read_b64_tr_b16 v[38:39], v12 offset:2688
  v_smfmac_f32_16x16x64_bf16 v[120:123], v[68:71], v[144:151], v16
  ds_read_b64_tr_b16 v[40:41], v12 offset:3072
  ds_read_b64_tr_b16 v[42:43], v12 offset:3200
  v_smfmac_f32_16x16x64_bf16 v[124:127], v[68:71], v[152:159], v16
  ds_read_b64_tr_b16 v[44:45], v12 offset:3584
  ds_read_b64_tr_b16 v[46:47], v12 offset:3712
  v_smfmac_f32_16x16x64_bf16 v[120:123], v[72:75], v[160:167], v16
  ds_read_b64_tr_b16 v[52:53], v13 offset:2048
  ds_read_b64_tr_b16 v[54:55], v13 offset:2176
  v_smfmac_f32_16x16x64_bf16 v[124:127], v[72:75], v[168:175], v16
  v_cndmask_b32 v112, v112, v116, s[62:63]
  v_cndmask_b32 v113, v113, v117, s[62:63]
  v_smfmac_f32_16x16x64_bf16 v[120:123], v[76:79], v[176:183], v16
  v_cndmask_b32 v114, v114, v118, s[62:63]
  v_cndmask_b32 v115, v115, v119, s[62:63]
  v_max3_f32 v10, v112, v113, v114
  v_max_f32 v10, v10, v115
  s_waitcnt lgkmcnt(8)
  v_mfma_f32_16x16x32_bf16 v[48:51], v[32:35], v[96:99], 0
  s_waitcnt lgkmcnt(6)
  v_mfma_f32_16x16x32_bf16 v[48:51], v[36:39], v[100:103], v[48:51]
  s_waitcnt lgkmcnt(4)
  v_mfma_f32_16x16x32_bf16 v[48:51], v[40:43], v[104:107], v[48:51]
  s_waitcnt lgkmcnt(2)
  v_mfma_f32_16x16x32_bf16 v[48:51], v[44:47], v[108:111], v[48:51]
  s_waitcnt lgkmcnt(0)
  buffer_store_dwordx4 v[52:55], v14, s[4:7], s32 offen sc1
  v_smfmac_f32_16x16x64_bf16 v[124:127], v[76:79], v[184:191], v16
  v_smfmac_f32_16x16x64_bf16 v[120:123], v[80:83], v[192:199], v16
  v_smfmac_f32_16x16x64_bf16 v[124:127], v[80:83], v[200:207], v16
  s_nop 2
  v_cndmask_b32 v48, v48, v50, s[62:63]
  v_cndmask_b32 v49, v49, v51, s[62:63]
  v_smfmac_f32_16x16x64_bf16 v[120:123], v[84:87], v[208:215], v16
  v_max3_f32 v10, v10, v48, v49
  ds_read_b128 v[96:99], v17 offset:0
  s_nop 0
  v_max_f32_dpp v10, v10, v10 row_ror:8 row_mask:0xf bank_mask:0xf
  v_smfmac_f32_16x16x64_bf16 v[124:127], v[84:87], v[216:223], v16
  v_mov_b32 v11, v10
  ds_read_b128 v[100:103], v17 offset:1024
  s_nop 0
  v_permlane16_swap_b32 v10, v11
  v_smfmac_f32_16x16x64_bf16 v[120:123], v[88:91], v[224:231], v16
  v_max_f32 v10, v10, v11
  ds_read_b128 v[104:107], v17 offset:2048
  v_mov_b32 v11, v10
  v_smfmac_f32_16x16x64_bf16 v[124:127], v[88:91], v[232:239], v16
  s_nop 0
  v_permlane32_swap_b32 v10, v11
  ds_read_b128 v[108:111], v17 offset:3072
  v_max_f32 v10, v10, v11
  v_smfmac_f32_16x16x64_bf16 v[120:123], v[92:95], v[240:247], v16
  v_mul_f32 v10, s44, v10
  ds_read_b128 v[56:59], v17 offset:16384
  v_smfmac_f32_16x16x64_bf16 v[124:127], v[92:95], v[248:255], v16
  v_fma_f32 v112, v112, s44, -v10
  v_fma_f32 v113, v113, s44, -v10
  v_fma_f32 v114, v114, s44, -v10
  ds_read_b128 v[60:63], v17 offset:17408
  v_fma_f32 v115, v115, s44, -v10
  ds_read_b128 v[32:35], v17 offset:18432
  v_fma_f32 v48, v48, s44, -v10
  ds_read_b128 v[36:39], v17 offset:19456
  v_fma_f32 v49, v49, s44, -v10
  ds_read_b128 v[40:43], v17 offset:4096
  v_exp_f32 v112, v112
  ds_read_b128 v[44:47], v17 offset:5120
  v_exp_f32 v113, v113
  v_exp_f32 v114, v114
  v_exp_f32 v115, v115
  v_exp_f32 v48, v48
  v_exp_f32 v49, v49
  v_permlane32_swap_b32 v120, v124
  v_permlane32_swap_b32 v121, v125
  v_permlane32_swap_b32 v122, v126
  v_permlane32_swap_b32 v123, v127
  v_add_f32 v120, v120, v124
  v_add_f32 v121, v121, v125
  v_add_f32 v122, v122, v126
  v_add_f32 v123, v123, v127
  v_cvt_pk_bf16_f32 v124, v112, v113
  v_cvt_pk_bf16_f32 v125, v114, v115
  v_cvt_pk_bf16_f32 v50, v48, v49
  v_cvt_pk_bf16_f32 v120, v120, v121
  v_cvt_pk_bf16_f32 v121, v122, v123
  v_mov_b32_dpp v126, v124 row_ror:8 row_mask:0xf bank_mask:0xf
  v_mov_b32_dpp v127, v125 row_ror:8 row_mask:0xf bank_mask:0xf
  v_mov_b32_dpp v51, v50 row_ror:8 row_mask:0xf bank_mask:0xf
  v_add_f32 v10, v112, v113
  v_add_f32 v11, v114, v115
  v_mfma_f32_16x16x32_bf16 v[116:119], v[28:31], v[124:127], 0
  v_add_f32 v48, v48, v49
  v_add_f32 v10, v10, v11
  v_mfma_f32_16x16x32_bf16 v[112:115], v[24:27], v[124:127], 0
  v_cndmask_b32 v122, 0, v120, s[60:61]
  v_cndmask_b32 v123, 0, v121, s[60:61]
  v_cndmask_b32 v52, v120, 0, s[60:61]
  v_cndmask_b32 v53, v121, 0, s[60:61]
  v_fma_f32 v10, v48, 0.5, v10
  s_add_u32 s39, s32, 8388608
  v_mfma_f32_16x16x16bf16_1k v[116:119], v[52:53], v[50:51], v[116:119]
  v_mfma_f32_16x16x16bf16_1k v[112:115], v[122:123], v[50:51], v[112:115]
  buffer_store_dwordx2 v[120:121], v15, s[4:7], s39 offen sc1
  s_cmp_eq_u32 s35, s34
  s_cbranch_scc1 L_CH_last
  v_add_f32_dpp v10, v10, v10 row_ror:8 row_mask:0xf bank_mask:0xf
  ds_read_b128 v[80:83], v17 offset:6144
  v_mov_b32 v11, v10
  ds_read_b128 v[84:87], v17 offset:7168
  s_nop 0
  v_permlane16_swap_b32 v10, v11
  ds_read_b128 v[88:91], v17 offset:20480
  v_add_f32 v10, v10, v11
  ds_read_b128 v[92:95], v17 offset:21504
  v_mov_b32 v11, v10
  v_mov_b64 v[64:65], 0
  s_nop 0
  v_permlane32_swap_b32 v10, v11
  v_mov_b64 v[66:67], 0
  v_add_f32 v10, v10, v11
  v_mov_b64 v[68:69], 0
  v_rcp_f32 v10, v10
  v_mov_b64 v[70:71], 0
  v_mov_b64 v[72:73], 0
  v_mov_b64 v[74:75], 0
  v_mov_b64 v[76:77], 0
  v_mov_b64 v[78:79], 0
  v_mul_f32 v112, v112, v10
  v_mul_f32 v113, v113, v10
  v_mul_f32 v114, v114, v10
  v_mul_f32 v115, v115, v10
  v_mul_f32 v116, v116, v10
  v_mul_f32 v117, v117, v10
  v_mul_f32 v118, v118, v10
  v_mul_f32 v119, v119, v10
  v_cvt_pk_bf16_f32 v48, v112, v113
  v_cvt_pk_bf16_f32 v49, v114, v115
  v_cvt_pk_bf16_f32 v50, v116, v117
  v_cvt_pk_bf16_f32 v51, v118, v119
  ds_write_b128 v4, v[48:51] offset:12288
  s_cmp_lg_u64 s[36:37], 0
  s_cbranch_scc1 L_CHs_late
  s_waitcnt vmcnt(3)
L_CHs_lr:
  v_mov_b64 v[112:113], 0
  v_mov_b64 v[114:115], 0
  v_mov_b64 v[116:117], 0
  v_mov_b64 v[118:119], 0
  v_mov_b64 v[120:121], 0
  v_mov_b64 v[122:123], 0
  v_mov_b64 v[124:125], 0
  v_mov_b64 v[126:127], 0
  s_waitcnt lgkmcnt(0)
  s_barrier
  ds_read_b128 v[24:27], v2 offset:12288
  ds_read_b128 v[28:31], v2 offset:13312
  s_add_u32 s33, s33, 512
  buffer_load_dword v1, v9, s[4:7], s33 offen sc1
  s_lshl_b32 s43, s35, 9
  s_add_u32 s43, s43, 131072
  s_add_u32 s43, s43, s52
  s_add_u32 s32, s32, 0x10000
  s_add_u32 s35, s35, 1
  s_waitcnt lgkmcnt(1)
  v_smfmac_f32_16x16x64_bf16 v[112:115], v[24:27], v[96:103], v16
  ds_read_b128 v[96:99], v17 offset:22528
  ds_read_b128 v[100:103], v17 offset:23552
  v_smfmac_f32_16x16x64_bf16 v[116:119], v[24:27], v[104:111], v16
  ds_read_b128 v[104:107], v17 offset:8192
  ds_read_b128 v[108:111], v17 offset:9216
  s_waitcnt lgkmcnt(4)
  v_smfmac_f32_16x16x64_bf16 v[112:115], v[28:31], v[56:63], v16
  ds_read_b128 v[56:59], v17 offset:10240
  ds_read_b128 v[60:63], v17 offset:11264
  v_smfmac_f32_16x16x64_bf16 v[116:119], v[28:31], v[32:39], v16
  ds_read_b128 v[32:35], v17 offset:24576
  ds_read_b128 v[36:39], v17 offset:25600
  v_smfmac_f32_16x16x64_bf16 v[120:123], v[24:27], v[40:47], v16
  ds_read_b128 v[40:43], v17 offset:26624
  ds_read_b128 v[44:47], v17 offset:27648
  v_smfmac_f32_16x16x64_bf16 v[124:127], v[24:27], v[80:87], v16
  ds_read_b128 v[80:83], v17 offset:12288
  ds_read_b128 v[84:87], v17 offset:13312
  v_smfmac_f32_16x16x64_bf16 v[120:123], v[28:31], v[88:95], v16
  ds_read_b128 v[88:91], v17 offset:14336
  ds_read_b128 v[92:95], v17 offset:15360
  s_waitcnt lgkmcnt(12)
  v_smfmac_f32_16x16x64_bf16 v[124:127], v[28:31], v[96:103], v16
  ds_read_b128 v[96:99], v17 offset:28672
  ds_read_b128 v[100:103], v17 offset:29696
  s_waitcnt lgkmcnt(12)
  v_smfmac_f32_16x16x64_bf16 v[64:67], v[24:27], v[104:111], v16
  ds_read_b128 v[104:107], v17 offset:30720
  ds_read_b128 v[108:111], v17 offset:31744
  v_permlane32_swap_b32 v112, v116
  v_permlane32_swap_b32 v113, v117
  s_waitcnt lgkmcnt(12)
  v_smfmac_f32_16x16x64_bf16 v[68:71], v[24:27], v[56:63], v16
  v_permlane32_swap_b32 v114, v118
  v_permlane32_swap_b32 v115, v119
  s_waitcnt lgkmcnt(10)
  v_smfmac_f32_16x16x64_bf16 v[64:67], v[28:31], v[32:39], v16
  v_add_f32 v112, v112, v116
  v_add_f32 v113, v113, v117
  v_add_f32 v114, v114, v118
  s_waitcnt lgkmcnt(8)
  v_smfmac_f32_16x16x64_bf16 v[68:71], v[28:31], v[40:47], v16
  v_add_f32 v115, v115, v119
  v_permlane32_swap_b32 v120, v124
  v_permlane32_swap_b32 v121, v125
  s_waitcnt lgkmcnt(6)
  v_smfmac_f32_16x16x64_bf16 v[72:75], v[24:27], v[80:87], v16
  v_permlane32_swap_b32 v122, v126
  v_permlane32_swap_b32 v123, v127
  v_add_f32 v120, v120, v124
  s_waitcnt lgkmcnt(4)
  v_smfmac_f32_16x16x64_bf16 v[76:79], v[24:27], v[88:95], v16
  v_add_f32 v121, v121, v125
  v_add_f32 v122, v122, v126
  v_add_f32 v123, v123, v127
  s_waitcnt lgkmcnt(2)
  v_smfmac_f32_16x16x64_bf16 v[72:75], v[28:31], v[96:103], v16
  v_cvt_pk_bf16_f32 v112, v112, v120
  v_cvt_pk_bf16_f32 v113, v113, v121
  v_cvt_pk_bf16_f32 v114, v114, v122
  s_waitcnt lgkmcnt(0)
  v_smfmac_f32_16x16x64_bf16 v[76:79], v[28:31], v[104:111], v16
  v_cvt_pk_bf16_f32 v115, v115, v123
  v_and_or_b32 v112, v112, -2, s59
  buffer_store_dwordx4 v[112:115], v18, s[4:7], s53 offen sc1
  v_permlane32_swap_b32 v64, v68
  v_permlane32_swap_b32 v65, v69
  v_permlane32_swap_b32 v66, v70
  v_permlane32_swap_b32 v67, v71
  v_add_f32 v64, v64, v68
  v_add_f32 v65, v65, v69
  v_add_f32 v66, v66, v70
  v_add_f32 v67, v67, v71
  v_permlane32_swap_b32 v72, v76
  v_permlane32_swap_b32 v73, v77
  v_permlane32_swap_b32 v74, v78
  v_permlane32_swap_b32 v75, v79
  v_add_f32 v72, v72, v76
  v_add_f32 v73, v73, v77
  v_add_f32 v74, v74, v78
  v_add_f32 v75, v75, v79
  v_cvt_pk_bf16_f32 v64, v64, v72
  v_cvt_pk_bf16_f32 v65, v65, v73
  v_cvt_pk_bf16_f32 v66, v66, v74
  v_cvt_pk_bf16_f32 v67, v67, v75
  v_and_or_b32 v64, v64, -2, s59
  buffer_store_dwordx4 v[64:67], v18, s[4:7], s54 offen sc1
  ds_read_b128 v[32:35], v7 offset:0
  ds_read_b128 v[36:39], v7 offset:2048
  ds_read_b128 v[40:43], v7 offset:4096
  ds_read_b128 v[44:47], v7 offset:6144
  ds_read_b128 v[48:51], v7 offset:128
  ds_read_b128 v[52:55], v7 offset:2176
  ds_read_b128 v[56:59], v7 offset:4224
  ds_read_b128 v[60:63], v7 offset:6272
  ds_read_b128 v[24:27], v6 offset:0
  ds_read_b128 v[28:31], v6 offset:256
  v_mov_b64 v[112:113], 0
  v_mov_b64 v[114:115], 0
  v_mov_b64 v[116:117], 0
  v_mov_b64 v[118:119], 0
  v_mov_b64 v[120:121], 0
  v_mov_b64 v[122:123], 0
  v_mov_b64 v[124:125], 0
  v_mov_b64 v[126:127], 0
  s_mov_b32 s40, 0
  s_waitcnt vmcnt(0)
L_CHs_p:
  buffer_load_dwordx4 v[80:83], v2, s[4:7], s55 offen offset:0 sc1
  buffer_load_dwordx4 v[84:87], v2, s[4:7], s55 offen offset:1024 sc1
  s_add_u32 s40, s40, 1
  s_movk_i32 s41, 53
  s_cmp_gt_u32 s40, 262144
  s_cbranch_scc1 L_fail
  s_waitcnt vmcnt(1)
  v_xor_b32 v11, s59, v80
  v_mfma_f32_16x16x32_bf16 v[88:91], v[80:83], v[20:23], 0
  s_waitcnt vmcnt(0)
  v_bitop3_b32 v11, v84, s59, v11 bitop3:0xbe
  v_mfma_f32_16x16x32_bf16 v[88:91], v[84:87], v[20:23], v[88:91]
  v_and_b32 v11, 1, v11
  v_cmp_ne_u32 vcc, 0, v11
  s_cbranch_vccnz L_CHs_p
  s_xor_b32 s59, s59, 1
  s_nop 3
  v_permlane32_swap_b32 v88, v89
  v_permlane32_swap_b32 v90, v91
  v_add_f32 v88, v88, v89
  v_add_f32 v90, v90, v91
  s_nop 1
  v_permlane16_swap_b32 v88, v90
  v_add_f32 v88, v88, v90
  s_mov_b32 s40, s56
  s_mov_b32 s56, s57
  v_mov_b32_dpp v89, v88 row_shl:4 row_mask:0xf bank_mask:0xf
  v_cvt_pk_bf16_f32 v88, v88, v89
  v_min_u32 v88, -2, v88
  s_mov_b32 exec_lo, 0x000f000f
  s_mov_b32 exec_hi, 0x000f000f
  buffer_store_dword v88, v19, s[4:7], s57 offen sc1
  buffer_store_dword v0, v19, s[4:7], s40 offen sc1
  s_mov_b64 exec, -1
  s_mov_b32 s57, s58
  s_mov_b32 s58, s40
  s_waitcnt vmcnt(1)
  s_branch L_CHs
L_CHs_late:
  s_mov_b32 s40, 0
poll_9:
  buffer_load_dword v10, v9, s[4:7], s33 offen sc1
  s_add_u32 s40, s40, 1
  s_waitcnt vmcnt(0)
  v_cmp_eq_u32 vcc, 0, v10
  s_cbranch_vccz pd_10
  s_movk_i32 s41, 52
  s_cmp_gt_u32 s40, 262144
  s_cbranch_scc1 L_fail
  s_sleep 1
  s_branch poll_9
pd_10:
  s_mov_b32 m0, s38
  s_nop 0
  buffer_load_dwordx4 v5, s[4:7], s30 offen offset:0 sc1 lds
  buffer_load_dwordx4 v5, s[4:7], s30 offen offset:1024 sc1 lds
  s_add_u32 m0, s38, 0x2000
  s_add_u32 s30, s30, 0x40000
  buffer_load_dwordx4 v5, s[4:7], s31 offen offset:0 sc1 lds
  buffer_load_dwordx4 v5, s[4:7], s31 offen offset:1024 sc1 lds
  s_add_u32 s31, s31, 0x40000
  s_waitcnt vmcnt(0)
  s_branch L_CHs_lr
L_CH_last:
  s_waitcnt vmcnt(0)
  s_lshl_b32 s40, s35, 9
  s_add_u32 s40, s40, 131072
  s_add_u32 s40, s40, s52
  s_mov_b64 exec, 1
  buffer_store_dword v0, v3, s[4:7], s40 offen sc1
  s_mov_b64 exec, -1
  s_endpgm
J_P:
  s_load_dwordx2 s[12:13], s[0:1], 16
  s_mov_b32 s14, 4194304
  s_mov_b32 s15, 0x20000
  s_load_dwordx2 s[16:17], s[0:1], 24
  s_mov_b32 s18, 4194304
  s_mov_b32 s19, 0x20000
  s_load_dwordx2 s[20:21], s[0:1], 32
  s_mov_b32 s22, 4194304
  s_mov_b32 s23, 0x20000
  s_lshl_b32 s49, s30, 4
  s_add_u32 s49, s49, s46
  s_and_b32 s50, s49, 1
  s_lshr_b32 s49, s49, 1
  s_lshl_b32 s41, s49, 8
  s_lshl_b32 s40, s28, 6
  v_lshrrev_b32 v11, 4, v1
  v_add_u32 v11, s40, v11
  s_mov_b32 s40, 8192
  v_mul_lo_u32 v11, v11, s40
  v_and_b32 v10, 15, v1
  v_lshl_add_u32 v11, v10, 4, v11
  v_add_u32 v11, s41, v11
  s_lshl_b32 s40, s28, 6
  v_bfe_u32 v12, v1, 5, 1
  v_lshlrev_b32 v12, 10, v12
  v_bfe_u32 v10, v1, 2, 2
  v_lshl_add_u32 v12, v10, 8, v12
  v_bfe_u32 v10, v1, 4, 1
  v_lshl_add_u32 v12, v10, 5, v12
  v_bfe_u32 v10, v1, 0, 2
  v_lshl_add_u32 v12, v10, 3, v12
  v_add_u32 v12, s40, v12
  v_add_u32 v13, 0x10000, v12
  s_waitcnt lgkmcnt(0)
  s_lshl_b32 s42, s28, 14
  s_add_u32 s42, s42, 0
  s_add_u32 m0, s42, 0
  s_mov_b32 s43, 0
  buffer_load_dwordx4 v11, s[12:15], s43 offen lds
  s_add_u32 m0, s42, 1024
  s_mov_b32 s43, 32768
  buffer_load_dwordx4 v11, s[12:15], s43 offen lds
  s_add_u32 m0, s42, 2048
  s_mov_b32 s43, 65536
  buffer_load_dwordx4 v11, s[12:15], s43 offen lds
  s_add_u32 m0, s42, 3072
  s_mov_b32 s43, 98304
  buffer_load_dwordx4 v11, s[12:15], s43 offen lds
  s_add_u32 m0, s42, 4096
  s_mov_b32 s43, 131072
  buffer_load_dwordx4 v11, s[12:15], s43 offen lds
  s_add_u32 m0, s42, 5120
  s_mov_b32 s43, 163840
  buffer_load_dwordx4 v11, s[12:15], s43 offen lds
  s_add_u32 m0, s42, 6144
  s_mov_b32 s43, 196608
  buffer_load_dwordx4 v11, s[12:15], s43 offen lds
  s_add_u32 m0, s42, 7168
  s_mov_b32 s43, 229376
  buffer_load_dwordx4 v11, s[12:15], s43 offen lds
  s_add_u32 m0, s42, 8192
  s_mov_b32 s43, 262144
  buffer_load_dwordx4 v11, s[12:15], s43 offen lds
  s_add_u32 m0, s42, 9216
  s_mov_b32 s43, 294912
  buffer_load_dwordx4 v11, s[12:15], s43 offen lds
  s_add_u32 m0, s42, 10240
  s_mov_b32 s43, 327680
  buffer_load_dwordx4 v11, s[12:15], s43 offen lds
  s_add_u32 m0, s42, 11264
  s_mov_b32 s43, 360448
  buffer_load_dwordx4 v11, s[12:15], s43 offen lds
  s_add_u32 m0, s42, 12288
  s_mov_b32 s43, 393216
  buffer_load_dwordx4 v11, s[12:15], s43 offen lds
  s_add_u32 m0, s42, 13312
  s_mov_b32 s43, 425984
  buffer_load_dwordx4 v11, s[12:15], s43 offen lds
  s_add_u32 m0, s42, 14336
  s_mov_b32 s43, 458752
  buffer_load_dwordx4 v11, s[12:15], s43 offen lds
  s_add_u32 m0, s42, 15360
  s_mov_b32 s43, 491520
  buffer_load_dwordx4 v11, s[12:15], s43 offen lds
  s_lshl_b32 s42, s28, 14
  s_add_u32 s42, s42, 65536
  s_add_u32 m0, s42, 0
  s_mov_b32 s43, 2097152
  buffer_load_dwordx4 v11, s[12:15], s43 offen lds
  s_add_u32 m0, s42, 1024
  s_mov_b32 s43, 2129920
  buffer_load_dwordx4 v11, s[12:15], s43 offen lds
  s_add_u32 m0, s42, 2048
  s_mov_b32 s43, 2162688
  buffer_load_dwordx4 v11, s[12:15], s43 offen lds
  s_add_u32 m0, s42, 3072
  s_mov_b32 s43, 2195456
  buffer_load_dwordx4 v11, s[12:15], s43 offen lds
  s_add_u32 m0, s42, 4096
  s_mov_b32 s43, 2228224
  buffer_load_dwordx4 v11, s[12:15], s43 offen lds
  s_add_u32 m0, s42, 5120
  s_mov_b32 s43, 2260992
  buffer_load_dwordx4 v11, s[12:15], s43 offen lds
  s_add_u32 m0, s42, 6144
  s_mov_b32 s43, 2293760
  buffer_load_dwordx4 v11, s[12:15], s43 offen lds
  s_add_u32 m0, s42, 7168
  s_mov_b32 s43, 2326528
  buffer_load_dwordx4 v11, s[12:15], s43 offen lds
  s_add_u32 m0, s42, 8192
  s_mov_b32 s43, 2359296
  buffer_load_dwordx4 v11, s[12:15], s43 offen lds
  s_add_u32 m0, s42, 9216
  s_mov_b32 s43, 2392064
  buffer_load_dwordx4 v11, s[12:15], s43 offen lds
  s_add_u32 m0, s42, 10240
  s_mov_b32 s43, 2424832
  buffer_load_dwordx4 v11, s[12:15], s43 offen lds
  s_add_u32 m0, s42, 11264
  s_mov_b32 s43, 2457600
  buffer_load_dwordx4 v11, s[12:15], s43 offen lds
  s_add_u32 m0, s42, 12288
  s_mov_b32 s43, 2490368
  buffer_load_dwordx4 v11, s[12:15], s43 offen lds
  s_add_u32 m0, s42, 13312
  s_mov_b32 s43, 2523136
  buffer_load_dwordx4 v11, s[12:15], s43 offen lds
  s_add_u32 m0, s42, 14336
  s_mov_b32 s43, 2555904
  buffer_load_dwordx4 v11, s[12:15], s43 offen lds
  s_add_u32 m0, s42, 15360
  s_mov_b32 s43, 2588672
  buffer_load_dwordx4 v11, s[12:15], s43 offen lds
  s_waitcnt vmcnt(32)
  s_barrier
  s_lshl_b32 s40, s31, 2
  s_cmp_lg_u32 s28, 0
  s_cbranch_scc1 ar_11
  s_mov_b64 exec, 1
  buffer_atomic_add v9, v3, s[8:11], s40 offen sc1
  s_mov_b64 exec, -1
ar_11:
  s_waitcnt vmcnt(16)
  s_barrier
  ds_read_b64_tr_b16 a[0:1], v12 offset:0
  ds_read_b64_tr_b16 a[2:3], v12 offset:2048
  ds_read_b64_tr_b16 a[4:5], v12 offset:4096
  ds_read_b64_tr_b16 a[6:7], v12 offset:6144
  ds_read_b64_tr_b16 a[8:9], v12 offset:8192
  ds_read_b64_tr_b16 a[10:11], v12 offset:10240
  ds_read_b64_tr_b16 a[12:13], v12 offset:12288
  ds_read_b64_tr_b16 a[14:15], v12 offset:14336
  ds_read_b64_tr_b16 a[16:17], v12 offset:16384
  ds_read_b64_tr_b16 a[18:19], v12 offset:18432
  ds_read_b64_tr_b16 a[20:21], v12 offset:20480
  ds_read_b64_tr_b16 a[22:23], v12 offset:22528
  ds_read_b64_tr_b16 a[24:25], v12 offset:24576
  ds_read_b64_tr_b16 a[26:27], v12 offset:26624
  ds_read_b64_tr_b16 a[28:29], v12 offset:28672
  ds_read_b64_tr_b16 a[30:31], v12 offset:30720
  ds_read_b64_tr_b16 a[32:33], v12 offset:32768
  ds_read_b64_tr_b16 a[34:35], v12 offset:34816
  ds_read_b64_tr_b16 a[36:37], v12 offset:36864
  ds_read_b64_tr_b16 a[38:39], v12 offset:38912
  ds_read_b64_tr_b16 a[40:41], v12 offset:40960
  ds_read_b64_tr_b16 a[42:43], v12 offset:43008
  ds_read_b64_tr_b16 a[44:45], v12 offset:45056
  ds_read_b64_tr_b16 a[46:47], v12 offset:47104
  ds_read_b64_tr_b16 a[48:49], v12 offset:49152
  ds_read_b64_tr_b16 a[50:51], v12 offset:51200
  ds_read_b64_tr_b16 a[52:53], v12 offset:53248
  ds_read_b64_tr_b16 a[54:55], v12 offset:55296
  ds_read_b64_tr_b16 a[56:57], v12 offset:57344
  ds_read_b64_tr_b16 a[58:59], v12 offset:59392
  ds_read_b64_tr_b16 a[60:61], v12 offset:61440
  ds_read_b64_tr_b16 a[62:63], v12 offset:63488
  s_waitcnt lgkmcnt(0)
  s_barrier
  s_lshl_b32 s42, s28, 14
  s_add_u32 s42, s42, 0
  s_add_u32 m0, s42, 0
  s_mov_b32 s43, 0
  buffer_load_dwordx4 v11, s[16:19], s43 offen lds
  s_add_u32 m0, s42, 1024
  s_mov_b32 s43, 32768
  buffer_load_dwordx4 v11, s[16:19], s43 offen lds
  s_add_u32 m0, s42, 2048
  s_mov_b32 s43, 65536
  buffer_load_dwordx4 v11, s[16:19], s43 offen lds
  s_add_u32 m0, s42, 3072
  s_mov_b32 s43, 98304
  buffer_load_dwordx4 v11, s[16:19], s43 offen lds
  s_add_u32 m0, s42, 4096
  s_mov_b32 s43, 131072
  buffer_load_dwordx4 v11, s[16:19], s43 offen lds
  s_add_u32 m0, s42, 5120
  s_mov_b32 s43, 163840
  buffer_load_dwordx4 v11, s[16:19], s43 offen lds
  s_add_u32 m0, s42, 6144
  s_mov_b32 s43, 196608
  buffer_load_dwordx4 v11, s[16:19], s43 offen lds
  s_add_u32 m0, s42, 7168
  s_mov_b32 s43, 229376
  buffer_load_dwordx4 v11, s[16:19], s43 offen lds
  s_add_u32 m0, s42, 8192
  s_mov_b32 s43, 262144
  buffer_load_dwordx4 v11, s[16:19], s43 offen lds
  s_add_u32 m0, s42, 9216
  s_mov_b32 s43, 294912
  buffer_load_dwordx4 v11, s[16:19], s43 offen lds
  s_add_u32 m0, s42, 10240
  s_mov_b32 s43, 327680
  buffer_load_dwordx4 v11, s[16:19], s43 offen lds
  s_add_u32 m0, s42, 11264
  s_mov_b32 s43, 360448
  buffer_load_dwordx4 v11, s[16:19], s43 offen lds
  s_add_u32 m0, s42, 12288
  s_mov_b32 s43, 393216
  buffer_load_dwordx4 v11, s[16:19], s43 offen lds
  s_add_u32 m0, s42, 13312
  s_mov_b32 s43, 425984
  buffer_load_dwordx4 v11, s[16:19], s43 offen lds
  s_add_u32 m0, s42, 14336
  s_mov_b32 s43, 458752
  buffer_load_dwordx4 v11, s[16:19], s43 offen lds
  s_add_u32 m0, s42, 15360
  s_mov_b32 s43, 491520
  buffer_load_dwordx4 v11, s[16:19], s43 offen lds
  s_waitcnt vmcnt(16)
  s_barrier
  ds_read_b64_tr_b16 a[64:65], v13 offset:0
  ds_read_b64_tr_b16 a[66:67], v13 offset:2048
  ds_read_b64_tr_b16 a[68:69], v13 offset:4096
  ds_read_b64_tr_b16 a[70:71], v13 offset:6144
  ds_read_b64_tr_b16 a[72:73], v13 offset:8192
  ds_read_b64_tr_b16 a[74:75], v13 offset:10240
  ds_read_b64_tr_b16 a[76:77], v13 offset:12288
  ds_read_b64_tr_b16 a[78:79], v13 offset:14336
  ds_read_b64_tr_b16 a[80:81], v13 offset:16384
  ds_read_b64_tr_b16 a[82:83], v13 offset:18432
  ds_read_b64_tr_b16 a[84:85], v13 offset:20480
  ds_read_b64_tr_b16 a[86:87], v13 offset:22528
  ds_read_b64_tr_b16 a[88:89], v13 offset:24576
  ds_read_b64_tr_b16 a[90:91], v13 offset:26624
  ds_read_b64_tr_b16 a[92:93], v13 offset:28672
  ds_read_b64_tr_b16 a[94:95], v13 offset:30720
  ds_read_b64_tr_b16 a[96:97], v13 offset:32768
  ds_read_b64_tr_b16 a[98:99], v13 offset:34816
  ds_read_b64_tr_b16 a[100:101], v13 offset:36864
  ds_read_b64_tr_b16 a[102:103], v13 offset:38912
  ds_read_b64_tr_b16 a[104:105], v13 offset:40960
  ds_read_b64_tr_b16 a[106:107], v13 offset:43008
  ds_read_b64_tr_b16 a[108:109], v13 offset:45056
  ds_read_b64_tr_b16 a[110:111], v13 offset:47104
  ds_read_b64_tr_b16 a[112:113], v13 offset:49152
  ds_read_b64_tr_b16 a[114:115], v13 offset:51200
  ds_read_b64_tr_b16 a[116:117], v13 offset:53248
  ds_read_b64_tr_b16 a[118:119], v13 offset:55296
  ds_read_b64_tr_b16 a[120:121], v13 offset:57344
  ds_read_b64_tr_b16 a[122:123], v13 offset:59392
  ds_read_b64_tr_b16 a[124:125], v13 offset:61440
  ds_read_b64_tr_b16 a[126:127], v13 offset:63488
  s_waitcnt lgkmcnt(0)
  s_barrier
  s_lshl_b32 s42, s28, 14
  s_add_u32 s42, s42, 65536
  s_add_u32 m0, s42, 0
  s_mov_b32 s43, 2097152
  buffer_load_dwordx4 v11, s[16:19], s43 offen lds
  s_add_u32 m0, s42, 1024
  s_mov_b32 s43, 2129920
  buffer_load_dwordx4 v11, s[16:19], s43 offen lds
  s_add_u32 m0, s42, 2048
  s_mov_b32 s43, 2162688
  buffer_load_dwordx4 v11, s[16:19], s43 offen lds
  s_add_u32 m0, s42, 3072
  s_mov_b32 s43, 2195456
  buffer_load_dwordx4 v11, s[16:19], s43 offen lds
  s_add_u32 m0, s42, 4096
  s_mov_b32 s43, 2228224
  buffer_load_dwordx4 v11, s[16:19], s43 offen lds
  s_add_u32 m0, s42, 5120
  s_mov_b32 s43, 2260992
  buffer_load_dwordx4 v11, s[16:19], s43 offen lds
  s_add_u32 m0, s42, 6144
  s_mov_b32 s43, 2293760
  buffer_load_dwordx4 v11, s[16:19], s43 offen lds
  s_add_u32 m0, s42, 7168
  s_mov_b32 s43, 2326528
  buffer_load_dwordx4 v11, s[16:19], s43 offen lds
  s_add_u32 m0, s42, 8192
  s_mov_b32 s43, 2359296
  buffer_load_dwordx4 v11, s[16:19], s43 offen lds
  s_add_u32 m0, s42, 9216
  s_mov_b32 s43, 2392064
  buffer_load_dwordx4 v11, s[16:19], s43 offen lds
  s_add_u32 m0, s42, 10240
  s_mov_b32 s43, 2424832
  buffer_load_dwordx4 v11, s[16:19], s43 offen lds
  s_add_u32 m0, s42, 11264
  s_mov_b32 s43, 2457600
  buffer_load_dwordx4 v11, s[16:19], s43 offen lds
  s_add_u32 m0, s42, 12288
  s_mov_b32 s43, 2490368
  buffer_load_dwordx4 v11, s[16:19], s43 offen lds
  s_add_u32 m0, s42, 13312
  s_mov_b32 s43, 2523136
  buffer_load_dwordx4 v11, s[16:19], s43 offen lds
  s_add_u32 m0, s42, 14336
  s_mov_b32 s43, 2555904
  buffer_load_dwordx4 v11, s[16:19], s43 offen lds
  s_add_u32 m0, s42, 15360
  s_mov_b32 s43, 2588672
  buffer_load_dwordx4 v11, s[16:19], s43 offen lds
  s_waitcnt vmcnt(16)
  s_barrier
  ds_read_b64_tr_b16 a[128:129], v12 offset:0
  ds_read_b64_tr_b16 a[130:131], v12 offset:2048
  ds_read_b64_tr_b16 a[132:133], v12 offset:4096
  ds_read_b64_tr_b16 a[134:135], v12 offset:6144
  ds_read_b64_tr_b16 a[136:137], v12 offset:8192
  ds_read_b64_tr_b16 a[138:139], v12 offset:10240
  ds_read_b64_tr_b16 a[140:141], v12 offset:12288
  ds_read_b64_tr_b16 a[142:143], v12 offset:14336
  ds_read_b64_tr_b16 a[144:145], v12 offset:16384
  ds_read_b64_tr_b16 a[146:147], v12 offset:18432
  ds_read_b64_tr_b16 a[148:149], v12 offset:20480
  ds_read_b64_tr_b16 a[150:151], v12 offset:22528
  ds_read_b64_tr_b16 a[152:153], v12 offset:24576
  ds_read_b64_tr_b16 a[154:155], v12 offset:26624
  ds_read_b64_tr_b16 a[156:157], v12 offset:28672
  ds_read_b64_tr_b16 a[158:159], v12 offset:30720
  ds_read_b64_tr_b16 a[160:161], v12 offset:32768
  ds_read_b64_tr_b16 a[162:163], v12 offset:34816
  ds_read_b64_tr_b16 a[164:165], v12 offset:36864
  ds_read_b64_tr_b16 a[166:167], v12 offset:38912
  ds_read_b64_tr_b16 a[168:169], v12 offset:40960
  ds_read_b64_tr_b16 a[170:171], v12 offset:43008
  ds_read_b64_tr_b16 a[172:173], v12 offset:45056
  ds_read_b64_tr_b16 a[174:175], v12 offset:47104
  ds_read_b64_tr_b16 a[176:177], v12 offset:49152
  ds_read_b64_tr_b16 a[178:179], v12 offset:51200
  ds_read_b64_tr_b16 a[180:181], v12 offset:53248
  ds_read_b64_tr_b16 a[182:183], v12 offset:55296
  ds_read_b64_tr_b16 a[184:185], v12 offset:57344
  ds_read_b64_tr_b16 a[186:187], v12 offset:59392
  ds_read_b64_tr_b16 a[188:189], v12 offset:61440
  ds_read_b64_tr_b16 a[190:191], v12 offset:63488
  s_waitcnt lgkmcnt(0)
  s_barrier
  s_lshl_b32 s42, s28, 14
  s_add_u32 s42, s42, 0
  s_add_u32 m0, s42, 0
  s_mov_b32 s43, 0
  buffer_load_dwordx4 v11, s[20:23], s43 offen lds
  s_add_u32 m0, s42, 1024
  s_mov_b32 s43, 32768
  buffer_load_dwordx4 v11, s[20:23], s43 offen lds
  s_add_u32 m0, s42, 2048
  s_mov_b32 s43, 65536
  buffer_load_dwordx4 v11, s[20:23], s43 offen lds
  s_add_u32 m0, s42, 3072
  s_mov_b32 s43, 98304
  buffer_load_dwordx4 v11, s[20:23], s43 offen lds
  s_add_u32 m0, s42, 4096
  s_mov_b32 s43, 131072
  buffer_load_dwordx4 v11, s[20:23], s43 offen lds
  s_add_u32 m0, s42, 5120
  s_mov_b32 s43, 163840
  buffer_load_dwordx4 v11, s[20:23], s43 offen lds
  s_add_u32 m0, s42, 6144
  s_mov_b32 s43, 196608
  buffer_load_dwordx4 v11, s[20:23], s43 offen lds
  s_add_u32 m0, s42, 7168
  s_mov_b32 s43, 229376
  buffer_load_dwordx4 v11, s[20:23], s43 offen lds
  s_add_u32 m0, s42, 8192
  s_mov_b32 s43, 262144
  buffer_load_dwordx4 v11, s[20:23], s43 offen lds
  s_add_u32 m0, s42, 9216
  s_mov_b32 s43, 294912
  buffer_load_dwordx4 v11, s[20:23], s43 offen lds
  s_add_u32 m0, s42, 10240
  s_mov_b32 s43, 327680
  buffer_load_dwordx4 v11, s[20:23], s43 offen lds
  s_add_u32 m0, s42, 11264
  s_mov_b32 s43, 360448
  buffer_load_dwordx4 v11, s[20:23], s43 offen lds
  s_add_u32 m0, s42, 12288
  s_mov_b32 s43, 393216
  buffer_load_dwordx4 v11, s[20:23], s43 offen lds
  s_add_u32 m0, s42, 13312
  s_mov_b32 s43, 425984
  buffer_load_dwordx4 v11, s[20:23], s43 offen lds
  s_add_u32 m0, s42, 14336
  s_mov_b32 s43, 458752
  buffer_load_dwordx4 v11, s[20:23], s43 offen lds
  s_add_u32 m0, s42, 15360
  s_mov_b32 s43, 491520
  buffer_load_dwordx4 v11, s[20:23], s43 offen lds
  s_waitcnt vmcnt(16)
  s_barrier
  ds_read_b64_tr_b16 a[192:193], v13 offset:0
  ds_read_b64_tr_b16 a[194:195], v13 offset:2048
  ds_read_b64_tr_b16 a[196:197], v13 offset:4096
  ds_read_b64_tr_b16 a[198:199], v13 offset:6144
  ds_read_b64_tr_b16 a[200:201], v13 offset:8192
  ds_read_b64_tr_b16 a[202:203], v13 offset:10240
  ds_read_b64_tr_b16 a[204:205], v13 offset:12288
  ds_read_b64_tr_b16 a[206:207], v13 offset:14336
  ds_read_b64_tr_b16 a[208:209], v13 offset:16384
  ds_read_b64_tr_b16 a[210:211], v13 offset:18432
  ds_read_b64_tr_b16 a[212:213], v13 offset:20480
  ds_read_b64_tr_b16 a[214:215], v13 offset:22528
  ds_read_b64_tr_b16 a[216:217], v13 offset:24576
  ds_read_b64_tr_b16 a[218:219], v13 offset:26624
  ds_read_b64_tr_b16 a[220:221], v13 offset:28672
  ds_read_b64_tr_b16 a[222:223], v13 offset:30720
  ds_read_b64_tr_b16 a[224:225], v13 offset:32768
  ds_read_b64_tr_b16 a[226:227], v13 offset:34816
  ds_read_b64_tr_b16 a[228:229], v13 offset:36864
  ds_read_b64_tr_b16 a[230:231], v13 offset:38912
  ds_read_b64_tr_b16 a[232:233], v13 offset:40960
  ds_read_b64_tr_b16 a[234:235], v13 offset:43008
  ds_read_b64_tr_b16 a[236:237], v13 offset:45056
  ds_read_b64_tr_b16 a[238:239], v13 offset:47104
  ds_read_b64_tr_b16 a[240:241], v13 offset:49152
  ds_read_b64_tr_b16 a[242:243], v13 offset:51200
  ds_read_b64_tr_b16 a[244:245], v13 offset:53248
  ds_read_b64_tr_b16 a[246:247], v13 offset:55296
  ds_read_b64_tr_b16 a[248:249], v13 offset:57344
  ds_read_b64_tr_b16 a[250:251], v13 offset:59392
  ds_read_b64_tr_b16 a[252:253], v13 offset:61440
  ds_read_b64_tr_b16 a[254:255], v13 offset:63488
  s_waitcnt lgkmcnt(0)
  s_barrier
  s_lshl_b32 s42, s28, 14
  s_add_u32 s42, s42, 65536
  s_add_u32 m0, s42, 0
  s_mov_b32 s43, 2097152
  buffer_load_dwordx4 v11, s[20:23], s43 offen lds
  s_add_u32 m0, s42, 1024
  s_mov_b32 s43, 2129920
  buffer_load_dwordx4 v11, s[20:23], s43 offen lds
  s_add_u32 m0, s42, 2048
  s_mov_b32 s43, 2162688
  buffer_load_dwordx4 v11, s[20:23], s43 offen lds
  s_add_u32 m0, s42, 3072
  s_mov_b32 s43, 2195456
  buffer_load_dwordx4 v11, s[20:23], s43 offen lds
  s_add_u32 m0, s42, 4096
  s_mov_b32 s43, 2228224
  buffer_load_dwordx4 v11, s[20:23], s43 offen lds
  s_add_u32 m0, s42, 5120
  s_mov_b32 s43, 2260992
  buffer_load_dwordx4 v11, s[20:23], s43 offen lds
  s_add_u32 m0, s42, 6144
  s_mov_b32 s43, 2293760
  buffer_load_dwordx4 v11, s[20:23], s43 offen lds
  s_add_u32 m0, s42, 7168
  s_mov_b32 s43, 2326528
  buffer_load_dwordx4 v11, s[20:23], s43 offen lds
  s_add_u32 m0, s42, 8192
  s_mov_b32 s43, 2359296
  buffer_load_dwordx4 v11, s[20:23], s43 offen lds
  s_add_u32 m0, s42, 9216
  s_mov_b32 s43, 2392064
  buffer_load_dwordx4 v11, s[20:23], s43 offen lds
  s_add_u32 m0, s42, 10240
  s_mov_b32 s43, 2424832
  buffer_load_dwordx4 v11, s[20:23], s43 offen lds
  s_add_u32 m0, s42, 11264
  s_mov_b32 s43, 2457600
  buffer_load_dwordx4 v11, s[20:23], s43 offen lds
  s_add_u32 m0, s42, 12288
  s_mov_b32 s43, 2490368
  buffer_load_dwordx4 v11, s[20:23], s43 offen lds
  s_add_u32 m0, s42, 13312
  s_mov_b32 s43, 2523136
  buffer_load_dwordx4 v11, s[20:23], s43 offen lds
  s_add_u32 m0, s42, 14336
  s_mov_b32 s43, 2555904
  buffer_load_dwordx4 v11, s[20:23], s43 offen lds
  s_add_u32 m0, s42, 15360
  s_mov_b32 s43, 2588672
  buffer_load_dwordx4 v11, s[20:23], s43 offen lds
  s_waitcnt vmcnt(16)
  s_barrier
  ds_read_b64_tr_b16 v[128:129], v12 offset:0
  ds_read_b64_tr_b16 v[130:131], v12 offset:2048
  ds_read_b64_tr_b16 v[132:133], v12 offset:4096
  ds_read_b64_tr_b16 v[134:135], v12 offset:6144
  ds_read_b64_tr_b16 v[136:137], v12 offset:8192
  ds_read_b64_tr_b16 v[138:139], v12 offset:10240
  ds_read_b64_tr_b16 v[140:141], v12 offset:12288
  ds_read_b64_tr_b16 v[142:143], v12 offset:14336
  ds_read_b64_tr_b16 v[144:145], v12 offset:16384
  ds_read_b64_tr_b16 v[146:147], v12 offset:18432
  ds_read_b64_tr_b16 v[148:149], v12 offset:20480
  ds_read_b64_tr_b16 v[150:151], v12 offset:22528
  ds_read_b64_tr_b16 v[152:153], v12 offset:24576
  ds_read_b64_tr_b16 v[154:155], v12 offset:26624
  ds_read_b64_tr_b16 v[156:157], v12 offset:28672
  ds_read_b64_tr_b16 v[158:159], v12 offset:30720
  ds_read_b64_tr_b16 v[160:161], v12 offset:32768
  ds_read_b64_tr_b16 v[162:163], v12 offset:34816
  ds_read_b64_tr_b16 v[164:165], v12 offset:36864
  ds_read_b64_tr_b16 v[166:167], v12 offset:38912
  ds_read_b64_tr_b16 v[168:169], v12 offset:40960
  ds_read_b64_tr_b16 v[170:171], v12 offset:43008
  ds_read_b64_tr_b16 v[172:173], v12 offset:45056
  ds_read_b64_tr_b16 v[174:175], v12 offset:47104
  ds_read_b64_tr_b16 v[176:177], v12 offset:49152
  ds_read_b64_tr_b16 v[178:179], v12 offset:51200
  ds_read_b64_tr_b16 v[180:181], v12 offset:53248
  ds_read_b64_tr_b16 v[182:183], v12 offset:55296
  ds_read_b64_tr_b16 v[184:185], v12 offset:57344
  ds_read_b64_tr_b16 v[186:187], v12 offset:59392
  ds_read_b64_tr_b16 v[188:189], v12 offset:61440
  ds_read_b64_tr_b16 v[190:191], v12 offset:63488
  s_waitcnt lgkmcnt(0)
  s_barrier
  s_waitcnt vmcnt(0)
  s_barrier
  ds_read_b64_tr_b16 v[192:193], v13 offset:0
  ds_read_b64_tr_b16 v[194:195], v13 offset:2048
  ds_read_b64_tr_b16 v[196:197], v13 offset:4096
  ds_read_b64_tr_b16 v[198:199], v13 offset:6144
  ds_read_b64_tr_b16 v[200:201], v13 offset:8192
  ds_read_b64_tr_b16 v[202:203], v13 offset:10240
  ds_read_b64_tr_b16 v[204:205], v13 offset:12288
  ds_read_b64_tr_b16 v[206:207], v13 offset:14336
  ds_read_b64_tr_b16 v[208:209], v13 offset:16384
  ds_read_b64_tr_b16 v[210:211], v13 offset:18432
  ds_read_b64_tr_b16 v[212:213], v13 offset:20480
  ds_read_b64_tr_b16 v[214:215], v13 offset:22528
  ds_read_b64_tr_b16 v[216:217], v13 offset:24576
  ds_read_b64_tr_b16 v[218:219], v13 offset:26624
  ds_read_b64_tr_b16 v[220:221], v13 offset:28672
  ds_read_b64_tr_b16 v[222:223], v13 offset:30720
  ds_read_b64_tr_b16 v[224:225], v13 offset:32768
  ds_read_b64_tr_b16 v[226:227], v13 offset:34816
  ds_read_b64_tr_b16 v[228:229], v13 offset:36864
  ds_read_b64_tr_b16 v[230:231], v13 offset:38912
  ds_read_b64_tr_b16 v[232:233], v13 offset:40960
  ds_read_b64_tr_b16 v[234:235], v13 offset:43008
  ds_read_b64_tr_b16 v[236:237], v13 offset:45056
  ds_read_b64_tr_b16 v[238:239], v13 offset:47104
  ds_read_b64_tr_b16 v[240:241], v13 offset:49152
  ds_read_b64_tr_b16 v[242:243], v13 offset:51200
  ds_read_b64_tr_b16 v[244:245], v13 offset:53248
  ds_read_b64_tr_b16 v[246:247], v13 offset:55296
  ds_read_b64_tr_b16 v[248:249], v13 offset:57344
  ds_read_b64_tr_b16 v[250:251], v13 offset:59392
  ds_read_b64_tr_b16 v[252:253], v13 offset:61440
  ds_read_b64_tr_b16 v[254:255], v13 offset:63488
  s_waitcnt lgkmcnt(0)
  s_barrier
  v_and_b32 v11, 7, v1
  v_lshlrev_b32 v11, 2, v11
  s_mov_b32 s42, 0
vf_12:
  buffer_load_dword v10, v11, s[8:11], 0 offen sc0 sc1
  s_add_u32 s42, s42, 1
  s_waitcnt vmcnt(0)
  v_readlane_b32 s43, v10, s31
  v_lshrrev_b32 v10, 22, v10
  v_cmp_ne_u32 vcc, 32, v10
  s_cbranch_vccz vk_13
  s_movk_i32 s41, 1
  s_cmp_gt_u32 s42, 262144
  s_cbranch_scc1 L_fail
  s_sleep 2
  s_branch vf_12
vk_13:
  s_and_b32 s40, s43, 0x1ff
  s_mul_i32 s40, s40, s40
  s_bfe_u32 s41, s43, 0xd0009
  s_lshl_b32 s41, s41, 5
  s_cmp_eq_u32 s40, s41
  s_cselect_b32 s47, 1, 0
  v_bfe_u32 v9, v1, 0, 4
  v_lshlrev_b32 v9, 2, v9
  s_mov_b32 s35, s50
  s_mov_b32 s32, 1
  s_mov_b32 s33, 0
  s_mov_b32 s34, 32
  s_lshl_b32 s51, s49, 13
  s_lshl_b32 s40, s28, 11
  s_add_u32 s51, s51, s40
  s_lshl_b32 s52, s49, 2
  s_add_u32 s52, s52, s28
  s_lshl_b32 s52, s52, 2
  s_lshl_b32 s48, s28, 10
  v_add_u32 v6, s48, v2
  v_mov_b32 v5, v2
  s_mov_b32 s38, 0
  s_mov_b32 s58, 0
  s_mov_b32 s53, 8
  s_mov_b32 s37, 0
  v_mov_b32 v8, 0x20000
  s_lshl_b32 s40, s28, 2
  v_add_u32 v7, s40, v8
  v_lshrrev_b32 v14, 4, v1
  v_min_u32 v14, 2, v14
  v_lshlrev_b32 v14, 25, v14
  v_and_b32 v15, 15, v1
  v_lshl_add_u32 v14, v15, 7, v14
L_P_get:
  s_cmp_lt_u32 s35, 64
  s_cbranch_scc1 L_P_g2
  s_lshl_b32 s43, s35, 9
  s_add_u32 s43, s43, 0
  s_mov_b32 s40, 0
poll_14:
  buffer_load_dword v10, v9, s[4:7], s43 offen sc1
  s_add_u32 s40, s40, 1
  s_waitcnt vmcnt(0)
  v_cmp_eq_u32 vcc, 0, v10
  s_cbranch_vccz pd_15
  s_movk_i32 s41, 20
  s_cmp_gt_u32 s40, 262144
  s_cbranch_scc1 L_fail
  s_sleep 1
  s_branch poll_14
pd_15:
L_P_g2:
  s_lshl_b32 s39, s35, 15
  s_add_u32 s39, s39, 2097152
  s_xor_b32 s42, s38, 0
  s_add_u32 m0, s42, s48
  s_nop 0
  buffer_load_dwordx4 v6, s[4:7], s39 offen sc1 lds
  s_add_u32 m0, m0, 4096
  s_add_u32 s39, s39, 4096
  buffer_load_dwordx4 v6, s[4:7], s39 offen sc1 lds
  s_add_u32 m0, m0, 4096
  s_add_u32 s39, s39, 4096
  buffer_load_dwordx4 v6, s[4:7], s39 offen sc1 lds
  s_add_u32 m0, m0, 4096
  s_add_u32 s39, s39, 4096
  buffer_load_dwordx4 v6, s[4:7], s39 offen sc1 lds
  s_add_u32 m0, m0, 4096
  s_add_u32 s39, s39, 4096
  buffer_load_dwordx4 v6, s[4:7], s39 offen sc1 lds
  s_add_u32 m0, m0, 4096
  s_add_u32 s39, s39, 4096
  buffer_load_dwordx4 v6, s[4:7], s39 offen sc1 lds
  s_add_u32 m0, m0, 4096
  s_add_u32 s39, s39, 4096
  buffer_load_dwordx4 v6, s[4:7], s39 offen sc1 lds
  s_add_u32 m0, m0, 4096
  s_add_u32 s39, s39, 4096
  buffer_load_dwordx4 v6, s[4:7], s39 offen sc1 lds
  s_add_u32 m0, m0, 4096
  s_add_u32 s39, s39, 4096
  s_waitcnt vmcnt(4)
L_P_top:
  s_barrier
  ds_read_b128 v[16:19], v5 offset:0
  ds_read_b128 v[20:23], v5 offset:1024
  ds_read_b128 v[24:27], v5 offset:2048
  ds_read_b128 v[28:31], v5 offset:3072
  s_min_u32 s43, s33, 31
  s_lshl_b32 s43, s43, 1
  s_add_u32 s43, s43, s50
  s_lshl_b32 s43, s43, 9
  s_add_u32 s43, s43, 32768
  s_waitcnt lgkmcnt(3)
  v_mfma_f32_32x32x16_bf16 v[64:79], a[0:3], v[16:19], 0
  v_mfma_f32_32x32x16_bf16 v[80:95], a[128:131], v[16:19], 0
  v_mfma_f32_32x32x16_bf16 v[96:111], v[16:19], v[128:131], 0
  ds_read_b128 v[16:19], v5 offset:4096
  s_waitcnt lgkmcnt(3)
  v_mfma_f32_32x32x16_bf16 v[64:79], a[4:7], v[20:23], v[64:79]
  v_mfma_f32_32x32x16_bf16 v[80:95], a[132:135], v[20:23], v[80:95]
  v_mfma_f32_32x32x16_bf16 v[96:111], v[20:23], v[132:135], v[96:111]
  ds_read_b128 v[20:23], v5 offset:5120
  s_lshl_b32 s40, s35, 18
  s_add_u32 s40, s40, s51
  s_add_u32 s40, s40, 98566144
  buffer_load_dword v15, v14, s[4:7], s40 offen
  s_waitcnt lgkmcnt(3)
  v_mfma_f32_32x32x16_bf16 v[64:79], a[8:11], v[24:27], v[64:79]
  v_mfma_f32_32x32x16_bf16 v[80:95], a[136:139], v[24:27], v[80:95]
  v_mfma_f32_32x32x16_bf16 v[96:111], v[24:27], v[136:139], v[96:111]
  ds_read_b128 v[24:27], v5 offset:6144
  s_waitcnt lgkmcnt(3)
  v_mfma_f32_32x32x16_bf16 v[64:79], a[12:15], v[28:31], v[64:79]
  v_mfma_f32_32x32x16_bf16 v[80:95], a[140:143], v[28:31], v[80:95]
  v_mfma_f32_32x32x16_bf16 v[96:111], v[28:31], v[140:143], v[96:111]
  ds_read_b128 v[28:31], v5 offset:7168
  s_waitcnt lgkmcnt(3)
  v_mfma_f32_32x32x16_bf16 v[64:79], a[16:19], v[16:19], v[64:79]
  v_mfma_f32_32x32x16_bf16 v[80:95], a[144:147], v[16:19], v[80:95]
  v_mfma_f32_32x32x16_bf16 v[96:111], v[16:19], v[144:147], v[96:111]
  ds_read_b128 v[16:19], v5 offset:8192
  s_waitcnt lgkmcnt(3)
  v_mfma_f32_32x32x16_bf16 v[64:79], a[20:23], v[20:23], v[64:79]
  v_mfma_f32_32x32x16_bf16 v[80:95], a[148:151], v[20:23], v[80:95]
  v_mfma_f32_32x32x16_bf16 v[96:111], v[20:23], v[148:151], v[96:111]
  ds_read_b128 v[20:23], v5 offset:9216
  s_waitcnt lgkmcnt(3)
  v_mfma_f32_32x32x16_bf16 v[64:79], a[24:27], v[24:27], v[64:79]
  v_mfma_f32_32x32x16_bf16 v[80:95], a[152:155], v[24:27], v[80:95]
  v_mfma_f32_32x32x16_bf16 v[96:111], v[24:27], v[152:155], v[96:111]
  ds_read_b128 v[24:27], v5 offset:10240
  s_waitcnt lgkmcnt(3)
  v_mfma_f32_32x32x16_bf16 v[64:79], a[28:31], v[28:31], v[64:79]
  v_mfma_f32_32x32x16_bf16 v[80:95], a[156:159], v[28:31], v[80:95]
  v_mfma_f32_32x32x16_bf16 v[96:111], v[28:31], v[156:159], v[96:111]
  ds_read_b128 v[28:31], v5 offset:11264
  buffer_load_dword v10, v9, s[4:7], s43 offen sc1
  s_waitcnt lgkmcnt(3)
  v_mfma_f32_32x32x16_bf16 v[64:79], a[32:35], v[16:19], v[64:79]
  v_mfma_f32_32x32x16_bf16 v[80:95], a[160:163], v[16:19], v[80:95]
  v_mfma_f32_32x32x16_bf16 v[96:111], v[16:19], v[160:163], v[96:111]
  ds_read_b128 v[16:19], v5 offset:12288
  s_waitcnt lgkmcnt(3)
  v_mfma_f32_32x32x16_bf16 v[64:79], a[36:39], v[20:23], v[64:79]
  v_mfma_f32_32x32x16_bf16 v[80:95], a[164:167], v[20:23], v[80:95]
  v_mfma_f32_32x32x16_bf16 v[96:111], v[20:23], v[164:167], v[96:111]
  ds_read_b128 v[20:23], v5 offset:13312
  s_waitcnt lgkmcnt(3)
  v_mfma_f32_32x32x16_bf16 v[64:79], a[40:43], v[24:27], v[64:79]
  v_mfma_f32_32x32x16_bf16 v[80:95], a[168:171], v[24:27], v[80:95]
  v_mfma_f32_32x32x16_bf16 v[96:111], v[24:27], v[168:171], v[96:111]
  ds_read_b128 v[24:27], v5 offset:14336
  s_waitcnt lgkmcnt(3)
  v_mfma_f32_32x32x16_bf16 v[64:79], a[44:47], v[28:31], v[64:79]
  v_mfma_f32_32x32x16_bf16 v[80:95], a[172:175], v[28:31], v[80:95]
  v_mfma_f32_32x32x16_bf16 v[96:111], v[28:31], v[172:175], v[96:111]
  ds_read_b128 v[28:31], v5 offset:15360
  s_cmp_eq_u32 s37, 1
  s_cbranch_scc1 L_P_c1
  s_waitcnt vmcnt(2)
L_P_c1:
  s_barrier
  s_waitcnt lgkmcnt(3)
  v_mfma_f32_32x32x16_bf16 v[64:79], a[48:51], v[16:19], v[64:79]
  v_mfma_f32_32x32x16_bf16 v[80:95], a[176:179], v[16:19], v[80:95]
  v_mfma_f32_32x32x16_bf16 v[96:111], v[16:19], v[176:179], v[96:111]
  ds_read_b128 v[16:19], v5 offset:16384
  s_waitcnt lgkmcnt(3)
  v_mfma_f32_32x32x16_bf16 v[64:79], a[52:55], v[20:23], v[64:79]
  v_mfma_f32_32x32x16_bf16 v[80:95], a[180:183], v[20:23], v[80:95]
  v_mfma_f32_32x32x16_bf16 v[96:111], v[20:23], v[180:183], v[96:111]
  ds_read_b128 v[20:23], v5 offset:17408
  s_waitcnt lgkmcnt(3)
  v_mfma_f32_32x32x16_bf16 v[64:79], a[56:59], v[24:27], v[64:79]
  v_mfma_f32_32x32x16_bf16 v[80:95], a[184:187], v[24:27], v[80:95]
  v_mfma_f32_32x32x16_bf16 v[96:111], v[24:27], v[184:187], v[96:111]
  ds_read_b128 v[24:27], v5 offset:18432
  s_waitcnt vmcnt(0)
  v_cmp_eq_u32 vcc, 0, v10
  s_cmp_eq_u64 vcc, 0
  s_cselect_b32 s40, 1, 0
  v_mov_b32 v10, s40
  ds_write_b32 v7, v10
  s_cmp_eq_u32 s58, 0
  s_cbranch_scc1 L_P_ns
  s_mov_b64 exec, 1
  buffer_store_dword v4, v3, s[4:7], s58 offen sc1
  s_mov_b64 exec, -1
L_P_ns:
  s_waitcnt lgkmcnt(0)
  s_barrier
  ds_read_b32 v10, v8
  s_waitcnt lgkmcnt(3)
  v_mfma_f32_32x32x16_bf16 v[64:79], a[60:63], v[28:31], v[64:79]
  v_mfma_f32_32x32x16_bf16 v[80:95], a[188:191], v[28:31], v[80:95]
  v_mfma_f32_32x32x16_bf16 v[96:111], v[28:31], v[188:191], v[96:111]
  ds_read_b128 v[28:31], v5 offset:19456
  s_waitcnt lgkmcnt(3)
  v_mfma_f32_32x32x16_bf16 v[64:79], a[64:67], v[16:19], v[64:79]
  v_mfma_f32_32x32x16_bf16 v[80:95], a[192:195], v[16:19], v[80:95]
  v_mfma_f32_32x32x16_bf16 v[96:111], v[16:19], v[192:195], v[96:111]
  ds_read_b128 v[16:19], v5 offset:20480
  s_waitcnt lgkmcnt(2)
  v_readfirstlane_b32 s40, v10
  s_cmp_lt_u32 s33, 32
  s_cselect_b32 s41, s40, 0
  s_add_u32 s42, s33, s53
  s_cmp_eq_u32 s41, 0
  s_cselect_b32 s53, 12, 9
  s_min_u32 s42, s42, 32
  s_cmp_lt_u32 s32, s42
  s_cselect_b32 s42, 1, 0
  s_or_b32 s37, s41, s42
  s_andn2_b32 s42, s42, s41
  s_cselect_b32 s40, s32, s33
  s_cselect_b32 s41, 0, 64
  s_add_u32 s32, s32, s42
  s_xor_b32 s42, s42, 1
  s_add_u32 s33, s33, s42
  s_lshl_b32 s36, s40, 1
  s_add_u32 s36, s36, s50
  s_add_u32 s36, s36, s41
  s_cmp_lt_u32 s40, 32
  s_cselect_b32 s36, s36, -1
  s_cmp_eq_u32 s37, 0
  s_cbranch_scc1 L_P_n
  s_lshl_b32 s39, s36, 15
  s_add_u32 s39, s39, 2097152
  s_xor_b32 s42, s38, 32768
  s_add_u32 m0, s42, s48
  s_nop 0
  s_waitcnt lgkmcnt(3)
  v_mfma_f32_32x32x16_bf16 v[64:79], a[68:71], v[20:23], v[64:79]
  v_mfma_f32_32x32x16_bf16 v[80:95], a[196:199], v[20:23], v[80:95]
  v_mfma_f32_32x32x16_bf16 v[96:111], v[20:23], v[196:199], v[96:111]
  ds_read_b128 v[20:23], v5 offset:21504
  buffer_load_dwordx4 v6, s[4:7], s39 offen sc1 lds
  s_add_u32 m0, m0, 4096
  s_add_u32 s39, s39, 4096
  s_waitcnt lgkmcnt(3)
  v_mfma_f32_32x32x16_bf16 v[64:79], a[72:75], v[24:27], v[64:79]
  v_mfma_f32_32x32x16_bf16 v[80:95], a[200:203], v[24:27], v[80:95]
  v_mfma_f32_32x32x16_bf16 v[96:111], v[24:27], v[200:203], v[96:111]
  ds_read_b128 v[24:27], v5 offset:22528
  buffer_load_dwordx4 v6, s[4:7], s39 offen sc1 lds
  s_add_u32 m0, m0, 4096
  s_add_u32 s39, s39, 4096
  s_waitcnt lgkmcnt(3)
  v_mfma_f32_32x32x16_bf16 v[64:79], a[76:79], v[28:31], v[64:79]
  v_mfma_f32_32x32x16_bf16 v[80:95], a[204:207], v[28:31], v[80:95]
  v_mfma_f32_32x32x16_bf16 v[96:111], v[28:31], v[204:207], v[96:111]
  ds_read_b128 v[28:31], v5 offset:23552
  buffer_load_dwordx4 v6, s[4:7], s39 offen sc1 lds
  s_add_u32 m0, m0, 4096
  s_add_u32 s39, s39, 4096
  s_waitcnt lgkmcnt(3)
  v_mfma_f32_32x32x16_bf16 v[64:79], a[80:83], v[16:19], v[64:79]
  v_mfma_f32_32x32x16_bf16 v[80:95], a[208:211], v[16:19], v[80:95]
  v_mfma_f32_32x32x16_bf16 v[96:111], v[16:19], v[208:211], v[96:111]
  ds_read_b128 v[16:19], v5 offset:24576
  buffer_load_dwordx4 v6, s[4:7], s39 offen sc1 lds
  s_add_u32 m0, m0, 4096
  s_add_u32 s39, s39, 4096
  s_waitcnt lgkmcnt(3)
  v_mfma_f32_32x32x16_bf16 v[64:79], a[84:87], v[20:23], v[64:79]
  v_mfma_f32_32x32x16_bf16 v[80:95], a[212:215], v[20:23], v[80:95]
  v_mfma_f32_32x32x16_bf16 v[96:111], v[20:23], v[212:215], v[96:111]
  ds_read_b128 v[20:23], v5 offset:25600
  buffer_load_dwordx4 v6, s[4:7], s39 offen sc1 lds
  s_add_u32 m0, m0, 4096
  s_add_u32 s39, s39, 4096
  s_waitcnt lgkmcnt(3)
  v_mfma_f32_32x32x16_bf16 v[64:79], a[88:91], v[24:27], v[64:79]
  v_mfma_f32_32x32x16_bf16 v[80:95], a[216:219], v[24:27], v[80:95]
  v_mfma_f32_32x32x16_bf16 v[96:111], v[24:27], v[216:219], v[96:111]
  ds_read_b128 v[24:27], v5 offset:26624
  buffer_load_dwordx4 v6, s[4:7], s39 offen sc1 lds
  s_add_u32 m0, m0, 4096
  s_add_u32 s39, s39, 4096
  s_waitcnt lgkmcnt(3)
  v_mfma_f32_32x32x16_bf16 v[64:79], a[92:95], v[28:31], v[64:79]
  v_mfma_f32_32x32x16_bf16 v[80:95], a[220:223], v[28:31], v[80:95]
  v_mfma_f32_32x32x16_bf16 v[96:111], v[28:31], v[220:223], v[96:111]
  ds_read_b128 v[28:31], v5 offset:27648
  buffer_load_dwordx4 v6, s[4:7], s39 offen sc1 lds
  s_add_u32 m0, m0, 4096
  s_add_u32 s39, s39, 4096
  s_waitcnt lgkmcnt(3)
  v_mfma_f32_32x32x16_bf16 v[64:79], a[96:99], v[16:19], v[64:79]
  v_mfma_f32_32x32x16_bf16 v[80:95], a[224:227], v[16:19], v[80:95]
  v_mfma_f32_32x32x16_bf16 v[96:111], v[16:19], v[224:227], v[96:111]
  ds_read_b128 v[16:19], v5 offset:28672
  buffer_load_dwordx4 v6, s[4:7], s39 offen sc1 lds
  s_add_u32 m0, m0, 4096
  s_add_u32 s39, s39, 4096
  s_waitcnt lgkmcnt(3)
  v_mfma_f32_32x32x16_bf16 v[64:79], a[100:103], v[20:23], v[64:79]
  v_mfma_f32_32x32x16_bf16 v[80:95], a[228:231], v[20:23], v[80:95]
  v_mfma_f32_32x32x16_bf16 v[96:111], v[20:23], v[228:231], v[96:111]
  ds_read_b128 v[20:23], v5 offset:29696
  s_waitcnt lgkmcnt(3)
  v_mfma_f32_32x32x16_bf16 v[64:79], a[104:107], v[24:27], v[64:79]
  v_mfma_f32_32x32x16_bf16 v[80:95], a[232:235], v[24:27], v[80:95]
  v_mfma_f32_32x32x16_bf16 v[96:111], v[24:27], v[232:235], v[96:111]
  ds_read_b128 v[24:27], v5 offset:30720
  s_waitcnt lgkmcnt(3)
  v_mfma_f32_32x32x16_bf16 v[64:79], a[108:111], v[28:31], v[64:79]
  v_mfma_f32_32x32x16_bf16 v[80:95], a[236:239], v[28:31], v[80:95]
  v_mfma_f32_32x32x16_bf16 v[96:111], v[28:31], v[236:239], v[96:111]
  ds_read_b128 v[28:31], v5 offset:31744
  s_branch L_P_epi
L_P_n:
  s_waitcnt lgkmcnt(3)
  v_mfma_f32_32x32x16_bf16 v[64:79], a[68:71], v[20:23], v[64:79]
  v_mfma_f32_32x32x16_bf16 v[80:95], a[196:199], v[20:23], v[80:95]
  v_mfma_f32_32x32x16_bf16 v[96:111], v[20:23], v[196:199], v[96:111]
  ds_read_b128 v[20:23], v5 offset:21504
  s_waitcnt lgkmcnt(3)
  v_mfma_f32_32x32x16_bf16 v[64:79], a[72:75], v[24:27], v[64:79]
  v_mfma_f32_32x32x16_bf16 v[80:95], a[200:203], v[24:27], v[80:95]
  v_mfma_f32_32x32x16_bf16 v[96:111], v[24:27], v[200:203], v[96:111]
  ds_read_b128 v[24:27], v5 offset:22528
  s_waitcnt lgkmcnt(3)
  v_mfma_f32_32x32x16_bf16 v[64:79], a[76:79], v[28:31], v[64:79]
  v_mfma_f32_32x32x16_bf16 v[80:95], a[204:207], v[28:31], v[80:95]
  v_mfma_f32_32x32x16_bf16 v[96:111], v[28:31], v[204:207], v[96:111]
  ds_read_b128 v[28:31], v5 offset:23552
  s_waitcnt lgkmcnt(3)
  v_mfma_f32_32x32x16_bf16 v[64:79], a[80:83], v[16:19], v[64:79]
  v_mfma_f32_32x32x16_bf16 v[80:95], a[208:211], v[16:19], v[80:95]
  v_mfma_f32_32x32x16_bf16 v[96:111], v[16:19], v[208:211], v[96:111]
  ds_read_b128 v[16:19], v5 offset:24576
  s_waitcnt lgkmcnt(3)
  v_mfma_f32_32x32x16_bf16 v[64:79], a[84:87], v[20:23], v[64:79]
  v_mfma_f32_32x32x16_bf16 v[80:95], a[212:215], v[20:23], v[80:95]
  v_mfma_f32_32x32x16_bf16 v[96:111], v[20:23], v[212:215], v[96:111]
  ds_read_b128 v[20:23], v5 offset:25600
  s_waitcnt lgkmcnt(3)
  v_mfma_f32_32x32x16_bf16 v[64:79], a[88:91], v[24:27], v[64:79]
  v_mfma_f32_32x32x16_bf16 v[80:95], a[216:219], v[24:27], v[80:95]
  v_mfma_f32_32x32x16_bf16 v[96:111], v[24:27], v[216:219], v[96:111]
  ds_read_b128 v[24:27], v5 offset:26624
  s_waitcnt lgkmcnt(3)
  v_mfma_f32_32x32x16_bf16 v[64:79], a[92:95], v[28:31], v[64:79]
  v_mfma_f32_32x32x16_bf16 v[80:95], a[220:223], v[28:31], v[80:95]
  v_mfma_f32_32x32x16_bf16 v[96:111], v[28:31], v[220:223], v[96:111]
  ds_read_b128 v[28:31], v5 offset:27648
  s_waitcnt lgkmcnt(3)
  v_mfma_f32_32x32x16_bf16 v[64:79], a[96:99], v[16:19], v[64:79]
  v_mfma_f32_32x32x16_bf16 v[80:95], a[224:227], v[16:19], v[80:95]
  v_mfma_f32_32x32x16_bf16 v[96:111], v[16:19], v[224:227], v[96:111]
  ds_read_b128 v[16:19], v5 offset:28672
  s_waitcnt lgkmcnt(3)
  v_mfma_f32_32x32x16_bf16 v[64:79], a[100:103], v[20:23], v[64:79]
  v_mfma_f32_32x32x16_bf16 v[80:95], a[228:231], v[20:23], v[80:95]
  v_mfma_f32_32x32x16_bf16 v[96:111], v[20:23], v[228:231], v[96:111]
  ds_read_b128 v[20:23], v5 offset:29696
  s_waitcnt lgkmcnt(3)
  v_mfma_f32_32x32x16_bf16 v[64:79], a[104:107], v[24:27], v[64:79]
  v_mfma_f32_32x32x16_bf16 v[80:95], a[232:235], v[24:27], v[80:95]
  v_mfma_f32_32x32x16_bf16 v[96:111], v[24:27], v[232:235], v[96:111]
  ds_read_b128 v[24:27], v5 offset:30720
  s_waitcnt lgkmcnt(3)
  v_mfma_f32_32x32x16_bf16 v[64:79], a[108:111], v[28:31], v[64:79]
  v_mfma_f32_32x32x16_bf16 v[80:95], a[236:239], v[28:31], v[80:95]
  v_mfma_f32_32x32x16_bf16 v[96:111], v[28:31], v[236:239], v[96:111]
  ds_read_b128 v[28:31], v5 offset:31744
L_P_epi:
  s_lshl_b32 s39, s35, 18
  s_add_u32 s39, s39, s51
  s_waitcnt lgkmcnt(0)
  v_mfma_f32_32x32x16_bf16 v[80:95], a[240:243], v[16:19], v[80:95]
  v_mfma_f32_32x32x16_bf16 v[80:95], a[244:247], v[20:23], v[80:95]
  v_mfma_f32_32x32x16_bf16 v[80:95], a[248:251], v[24:27], v[80:95]
  v_mfma_f32_32x32x16_bf16 v[80:95], a[252:255], v[28:31], v[80:95]
  v_mfma_f32_32x32x16_bf16 v[96:111], v[16:19], v[240:243], v[96:111]
  v_mfma_f32_32x32x16_bf16 v[96:111], v[20:23], v[244:247], v[96:111]
  s_nop 9
  v_cvt_pk_bf16_f32 v40, v80, v81
  v_cvt_pk_bf16_f32 v41, v82, v83
  v_cvt_pk_bf16_f32 v42, v84, v85
  v_cvt_pk_bf16_f32 v43, v86, v87
  v_mfma_f32_32x32x16_bf16 v[96:111], v[24:27], v[248:251], v[96:111]
  v_cvt_pk_bf16_f32 v44, v88, v89
  v_cvt_pk_bf16_f32 v45, v90, v91
  v_cvt_pk_bf16_f32 v46, v92, v93
  v_cvt_pk_bf16_f32 v47, v94, v95
  v_mfma_f32_32x32x16_bf16 v[96:111], v[28:31], v[252:255], v[96:111]
  s_add_u32 s40, s39, 132120576
  buffer_store_dwordx4 v[40:43], v2, s[4:7], s40 offen offset:0 sc1
  buffer_store_dwordx4 v[44:47], v2, s[4:7], s40 offen offset:1024 sc1
  v_mfma_f32_32x32x16_bf16 v[64:79], a[112:115], v[16:19], v[64:79]
  v_mfma_f32_32x32x16_bf16 v[64:79], a[116:119], v[20:23], v[64:79]
  s_nop 6
  v_cvt_pk_bf16_f32 v48, v96, v97
  v_cvt_pk_bf16_f32 v49, v98, v99
  v_cvt_pk_bf16_f32 v50, v100, v101
  v_cvt_pk_bf16_f32 v51, v102, v103
  v_mfma_f32_32x32x16_bf16 v[64:79], a[120:123], v[24:27], v[64:79]
  v_cvt_pk_bf16_f32 v52, v104, v105
  v_cvt_pk_bf16_f32 v53, v106, v107
  v_cvt_pk_bf16_f32 v54, v108, v109
  v_cvt_pk_bf16_f32 v55, v110, v111
  v_mfma_f32_32x32x16_bf16 v[64:79], a[124:127], v[28:31], v[64:79]
  s_add_u32 s40, s39, 165675008
  buffer_store_dwordx4 v[48:51], v2, s[4:7], s40 offen offset:0 sc1
  buffer_store_dwordx4 v[52:55], v2, s[4:7], s40 offen offset:1024 sc1
  s_nop 8
  v_cvt_pk_bf16_f32 v32, v64, v65
  v_cvt_pk_bf16_f32 v33, v66, v67
  v_cvt_pk_bf16_f32 v34, v68, v69
  v_cvt_pk_bf16_f32 v35, v70, v71
  v_cvt_pk_bf16_f32 v36, v72, v73
  v_cvt_pk_bf16_f32 v37, v74, v75
  v_cvt_pk_bf16_f32 v38, v76, v77
  v_cvt_pk_bf16_f32 v39, v78, v79
  s_add_u32 s40, s39, 98566144
  buffer_store_dwordx4 v[32:35], v2, s[4:7], s40 offen offset:0 sc1
  buffer_store_dwordx4 v[36:39], v2, s[4:7], s40 offen offset:1024 sc1
  s_lshl_b32 s58, s35, 9
  s_add_u32 s58, s58, 65536
  s_add_u32 s58, s58, s52
  s_mov_b32 s54, s35
  s_mov_b32 s35, s36
  s_xor_b32 s38, s38, 32768
  v_xor_b32 v5, 32768, v5
  s_waitcnt vmcnt(6)
  s_cmp_eq_u32 s37, 1
  s_cbranch_scc1 L_P_top
  s_waitcnt vmcnt(0)
  s_mov_b64 exec, 1
  buffer_store_dword v4, v3, s[4:7], s58 offen sc1
  s_mov_b64 exec, -1
  s_mov_b32 s58, 0
  s_cmp_lt_i32 s35, 0
  s_cbranch_scc0 L_P_get
  s_endpgm
J_W:
  s_load_dwordx2 s[12:13], s[0:1], 40
  s_mov_b32 s14, 4194304
  s_mov_b32 s15, 0x20000
  s_mov_b32 s49, s30
  s_and_b32 s50, s46, 3
  s_lshl_b32 s41, s49, 20
  s_lshl_b32 s42, s50, 8
  s_add_u32 s41, s41, s42
  s_lshl_b32 s40, s28, 6
  v_lshrrev_b32 v11, 4, v1
  v_add_u32 v11, s40, v11
  s_mov_b32 s40, 1024
  v_mul_lo_u32 v11, v11, s40
  v_and_b32 v10, 15, v1
  v_lshl_add_u32 v11, v10, 4, v11
  v_add_u32 v11, s41, v11
  s_lshl_b32 s40, s28, 6
  v_bfe_u32 v12, v1, 5, 1
  v_lshlrev_b32 v12, 10, v12
  v_bfe_u32 v10, v1, 2, 2
  v_lshl_add_u32 v12, v10, 8, v12
  v_bfe_u32 v10, v1, 4, 1
  v_lshl_add_u32 v12, v10, 5, v12
  v_bfe_u32 v10, v1, 0, 2
  v_lshl_add_u32 v12, v10, 3, v12
  v_add_u32 v12, s40, v12
  v_add_u32 v13, 0x10000, v12
  s_waitcnt lgkmcnt(0)
  s_lshl_b32 s42, s28, 14
  s_add_u32 s42, s42, 0
  s_add_u32 m0, s42, 0
  s_mov_b32 s43, 0
  buffer_load_dwordx4 v11, s[12:15], s43 offen lds
  s_add_u32 m0, s42, 1024
  s_mov_b32 s43, 4096
  buffer_load_dwordx4 v11, s[12:15], s43 offen lds
  s_add_u32 m0, s42, 2048
  s_mov_b32 s43, 8192
  buffer_load_dwordx4 v11, s[12:15], s43 offen lds
  s_add_u32 m0, s42, 3072
  s_mov_b32 s43, 12288
  buffer_load_dwordx4 v11, s[12:15], s43 offen lds
  s_add_u32 m0, s42, 4096
  s_mov_b32 s43, 16384
  buffer_load_dwordx4 v11, s[12:15], s43 offen lds
  s_add_u32 m0, s42, 5120
  s_mov_b32 s43, 20480
  buffer_load_dwordx4 v11, s[12:15], s43 offen lds
  s_add_u32 m0, s42, 6144
  s_mov_b32 s43, 24576
  buffer_load_dwordx4 v11, s[12:15], s43 offen lds
  s_add_u32 m0, s42, 7168
  s_mov_b32 s43, 28672
  buffer_load_dwordx4 v11, s[12:15], s43 offen lds
  s_add_u32 m0, s42, 8192
  s_mov_b32 s43, 32768
  buffer_load_dwordx4 v11, s[12:15], s43 offen lds
  s_add_u32 m0, s42, 9216
  s_mov_b32 s43, 36864
  buffer_load_dwordx4 v11, s[12:15], s43 offen lds
  s_add_u32 m0, s42, 10240
  s_mov_b32 s43, 40960
  buffer_load_dwordx4 v11, s[12:15], s43 offen lds
  s_add_u32 m0, s42, 11264
  s_mov_b32 s43, 45056
  buffer_load_dwordx4 v11, s[12:15], s43 offen lds
  s_add_u32 m0, s42, 12288
  s_mov_b32 s43, 49152
  buffer_load_dwordx4 v11, s[12:15], s43 offen lds
  s_add_u32 m0, s42, 13312
  s_mov_b32 s43, 53248
  buffer_load_dwordx4 v11, s[12:15], s43 offen lds
  s_add_u32 m0, s42, 14336
  s_mov_b32 s43, 57344
  buffer_load_dwordx4 v11, s[12:15], s43 offen lds
  s_add_u32 m0, s42, 15360
  s_mov_b32 s43, 61440
  buffer_load_dwordx4 v11, s[12:15], s43 offen lds
  s_lshl_b32 s42, s28, 14
  s_add_u32 s42, s42, 65536
  s_add_u32 m0, s42, 0
  s_mov_b32 s43, 262144
  buffer_load_dwordx4 v11, s[12:15], s43 offen lds
  s_add_u32 m0, s42, 1024
  s_mov_b32 s43, 266240
  buffer_load_dwordx4 v11, s[12:15], s43 offen lds
  s_add_u32 m0, s42, 2048
  s_mov_b32 s43, 270336
  buffer_load_dwordx4 v11, s[12:15], s43 offen lds
  s_add_u32 m0, s42, 3072
  s_mov_b32 s43, 274432
  buffer_load_dwordx4 v11, s[12:15], s43 offen lds
  s_add_u32 m0, s42, 4096
  s_mov_b32 s43, 278528
  buffer_load_dwordx4 v11, s[12:15], s43 offen lds
  s_add_u32 m0, s42, 5120
  s_mov_b32 s43, 282624
  buffer_load_dwordx4 v11, s[12:15], s43 offen lds
  s_add_u32 m0, s42, 6144
  s_mov_b32 s43, 286720
  buffer_load_dwordx4 v11, s[12:15], s43 offen lds
  s_add_u32 m0, s42, 7168
  s_mov_b32 s43, 290816
  buffer_load_dwordx4 v11, s[12:15], s43 offen lds
  s_add_u32 m0, s42, 8192
  s_mov_b32 s43, 294912
  buffer_load_dwordx4 v11, s[12:15], s43 offen lds
  s_add_u32 m0, s42, 9216
  s_mov_b32 s43, 299008
  buffer_load_dwordx4 v11, s[12:15], s43 offen lds
  s_add_u32 m0, s42, 10240
  s_mov_b32 s43, 303104
  buffer_load_dwordx4 v11, s[12:15], s43 offen lds
  s_add_u32 m0, s42, 11264
  s_mov_b32 s43, 307200
  buffer_load_dwordx4 v11, s[12:15], s43 offen lds
  s_add_u32 m0, s42, 12288
  s_mov_b32 s43, 311296
  buffer_load_dwordx4 v11, s[12:15], s43 offen lds
  s_add_u32 m0, s42, 13312
  s_mov_b32 s43, 315392
  buffer_load_dwordx4 v11, s[12:15], s43 offen lds
  s_add_u32 m0, s42, 14336
  s_mov_b32 s43, 319488
  buffer_load_dwordx4 v11, s[12:15], s43 offen lds
  s_add_u32 m0, s42, 15360
  s_mov_b32 s43, 323584
  buffer_load_dwordx4 v11, s[12:15], s43 offen lds
  s_waitcnt vmcnt(32)
  s_barrier
  s_lshl_b32 s40, s31, 2
  s_cmp_lg_u32 s28, 0
  s_cbranch_scc1 ar_16
  s_mov_b64 exec, 1
  buffer_atomic_add v9, v3, s[8:11], s40 offen sc1
  s_mov_b64 exec, -1
ar_16:
  s_waitcnt vmcnt(16)
  s_barrier
  ds_read_b64_tr_b16 a[0:1], v12 offset:0
  ds_read_b64_tr_b16 a[2:3], v12 offset:2048
  ds_read_b64_tr_b16 a[4:5], v12 offset:4096
  ds_read_b64_tr_b16 a[6:7], v12 offset:6144
  ds_read_b64_tr_b16 a[8:9], v12 offset:8192
  ds_read_b64_tr_b16 a[10:11], v12 offset:10240
  ds_read_b64_tr_b16 a[12:13], v12 offset:12288
  ds_read_b64_tr_b16 a[14:15], v12 offset:14336
  ds_read_b64_tr_b16 a[16:17], v12 offset:16384
  ds_read_b64_tr_b16 a[18:19], v12 offset:18432
  ds_read_b64_tr_b16 a[20:21], v12 offset:20480
  ds_read_b64_tr_b16 a[22:23], v12 offset:22528
  ds_read_b64_tr_b16 a[24:25], v12 offset:24576
  ds_read_b64_tr_b16 a[26:27], v12 offset:26624
  ds_read_b64_tr_b16 a[28:29], v12 offset:28672
  ds_read_b64_tr_b16 a[30:31], v12 offset:30720
  ds_read_b64_tr_b16 a[32:33], v12 offset:32768
  ds_read_b64_tr_b16 a[34:35], v12 offset:34816
  ds_read_b64_tr_b16 a[36:37], v12 offset:36864
  ds_read_b64_tr_b16 a[38:39], v12 offset:38912
  ds_read_b64_tr_b16 a[40:41], v12 offset:40960
  ds_read_b64_tr_b16 a[42:43], v12 offset:43008
  ds_read_b64_tr_b16 a[44:45], v12 offset:45056
  ds_read_b64_tr_b16 a[46:47], v12 offset:47104
  ds_read_b64_tr_b16 a[48:49], v12 offset:49152
  ds_read_b64_tr_b16 a[50:51], v12 offset:51200
  ds_read_b64_tr_b16 a[52:53], v12 offset:53248
  ds_read_b64_tr_b16 a[54:55], v12 offset:55296
  ds_read_b64_tr_b16 a[56:57], v12 offset:57344
  ds_read_b64_tr_b16 a[58:59], v12 offset:59392
  ds_read_b64_tr_b16 a[60:61], v12 offset:61440
  ds_read_b64_tr_b16 a[62:63], v12 offset:63488
  s_waitcnt lgkmcnt(0)
  s_barrier
  s_lshl_b32 s42, s28, 14
  s_add_u32 s42, s42, 0
  s_add_u32 m0, s42, 0
  s_mov_b32 s43, 524288
  buffer_load_dwordx4 v11, s[12:15], s43 offen lds
  s_add_u32 m0, s42, 1024
  s_mov_b32 s43, 528384
  buffer_load_dwordx4 v11, s[12:15], s43 offen lds
  s_add_u32 m0, s42, 2048
  s_mov_b32 s43, 532480
  buffer_load_dwordx4 v11, s[12:15], s43 offen lds
  s_add_u32 m0, s42, 3072
  s_mov_b32 s43, 536576
  buffer_load_dwordx4 v11, s[12:15], s43 offen lds
  s_add_u32 m0, s42, 4096
  s_mov_b32 s43, 540672
  buffer_load_dwordx4 v11, s[12:15], s43 offen lds
  s_add_u32 m0, s42, 5120
  s_mov_b32 s43, 544768
  buffer_load_dwordx4 v11, s[12:15], s43 offen lds
  s_add_u32 m0, s42, 6144
  s_mov_b32 s43, 548864
  buffer_load_dwordx4 v11, s[12:15], s43 offen lds
  s_add_u32 m0, s42, 7168
  s_mov_b32 s43, 552960
  buffer_load_dwordx4 v11, s[12:15], s43 offen lds
  s_add_u32 m0, s42, 8192
  s_mov_b32 s43, 557056
  buffer_load_dwordx4 v11, s[12:15], s43 offen lds
  s_add_u32 m0, s42, 9216
  s_mov_b32 s43, 561152
  buffer_load_dwordx4 v11, s[12:15], s43 offen lds
  s_add_u32 m0, s42, 10240
  s_mov_b32 s43, 565248
  buffer_load_dwordx4 v11, s[12:15], s43 offen lds
  s_add_u32 m0, s42, 11264
  s_mov_b32 s43, 569344
  buffer_load_dwordx4 v11, s[12:15], s43 offen lds
  s_add_u32 m0, s42, 12288
  s_mov_b32 s43, 573440
  buffer_load_dwordx4 v11, s[12:15], s43 offen lds
  s_add_u32 m0, s42, 13312
  s_mov_b32 s43, 577536
  buffer_load_dwordx4 v11, s[12:15], s43 offen lds
  s_add_u32 m0, s42, 14336
  s_mov_b32 s43, 581632
  buffer_load_dwordx4 v11, s[12:15], s43 offen lds
  s_add_u32 m0, s42, 15360
  s_mov_b32 s43, 585728
  buffer_load_dwordx4 v11, s[12:15], s43 offen lds
  s_waitcnt vmcnt(16)
  s_barrier
  ds_read_b64_tr_b16 a[64:65], v13 offset:0
  ds_read_b64_tr_b16 a[66:67], v13 offset:2048
  ds_read_b64_tr_b16 a[68:69], v13 offset:4096
  ds_read_b64_tr_b16 a[70:71], v13 offset:6144
  ds_read_b64_tr_b16 a[72:73], v13 offset:8192
  ds_read_b64_tr_b16 a[74:75], v13 offset:10240
  ds_read_b64_tr_b16 a[76:77], v13 offset:12288
  ds_read_b64_tr_b16 a[78:79], v13 offset:14336
  ds_read_b64_tr_b16 a[80:81], v13 offset:16384
  ds_read_b64_tr_b16 a[82:83], v13 offset:18432
  ds_read_b64_tr_b16 a[84:85], v13 offset:20480
  ds_read_b64_tr_b16 a[86:87], v13 offset:22528
  ds_read_b64_tr_b16 a[88:89], v13 offset:24576
  ds_read_b64_tr_b16 a[90:91], v13 offset:26624
  ds_read_b64_tr_b16 a[92:93], v13 offset:28672
  ds_read_b64_tr_b16 a[94:95], v13 offset:30720
  ds_read_b64_tr_b16 a[96:97], v13 offset:32768
  ds_read_b64_tr_b16 a[98:99], v13 offset:34816
  ds_read_b64_tr_b16 a[100:101], v13 offset:36864
  ds_read_b64_tr_b16 a[102:103], v13 offset:38912
  ds_read_b64_tr_b16 a[104:105], v13 offset:40960
  ds_read_b64_tr_b16 a[106:107], v13 offset:43008
  ds_read_b64_tr_b16 a[108:109], v13 offset:45056
  ds_read_b64_tr_b16 a[110:111], v13 offset:47104
  ds_read_b64_tr_b16 a[112:113], v13 offset:49152
  ds_read_b64_tr_b16 a[114:115], v13 offset:51200
  ds_read_b64_tr_b16 a[116:117], v13 offset:53248
  ds_read_b64_tr_b16 a[118:119], v13 offset:55296
  ds_read_b64_tr_b16 a[120:121], v13 offset:57344
  ds_read_b64_tr_b16 a[122:123], v13 offset:59392
  ds_read_b64_tr_b16 a[124:125], v13 offset:61440
  ds_read_b64_tr_b16 a[126:127], v13 offset:63488
  s_waitcnt lgkmcnt(0)
  s_barrier
  s_lshl_b32 s42, s28, 14
  s_add_u32 s42, s42, 65536
  s_add_u32 m0, s42, 0
  s_mov_b32 s43, 786432
  buffer_load_dwordx4 v11, s[12:15], s43 offen lds
  s_add_u32 m0, s42, 1024
  s_mov_b32 s43, 790528
  buffer_load_dwordx4 v11, s[12:15], s43 offen lds
  s_add_u32 m0, s42, 2048
  s_mov_b32 s43, 794624
  buffer_load_dwordx4 v11, s[12:15], s43 offen lds
  s_add_u32 m0, s42, 3072
  s_mov_b32 s43, 798720
  buffer_load_dwordx4 v11, s[12:15], s43 offen lds
  s_add_u32 m0, s42, 4096
  s_mov_b32 s43, 802816
  buffer_load_dwordx4 v11, s[12:15], s43 offen lds
  s_add_u32 m0, s42, 5120
  s_mov_b32 s43, 806912
  buffer_load_dwordx4 v11, s[12:15], s43 offen lds
  s_add_u32 m0, s42, 6144
  s_mov_b32 s43, 811008
  buffer_load_dwordx4 v11, s[12:15], s43 offen lds
  s_add_u32 m0, s42, 7168
  s_mov_b32 s43, 815104
  buffer_load_dwordx4 v11, s[12:15], s43 offen lds
  s_add_u32 m0, s42, 8192
  s_mov_b32 s43, 819200
  buffer_load_dwordx4 v11, s[12:15], s43 offen lds
  s_add_u32 m0, s42, 9216
  s_mov_b32 s43, 823296
  buffer_load_dwordx4 v11, s[12:15], s43 offen lds
  s_add_u32 m0, s42, 10240
  s_mov_b32 s43, 827392
  buffer_load_dwordx4 v11, s[12:15], s43 offen lds
  s_add_u32 m0, s42, 11264
  s_mov_b32 s43, 831488
  buffer_load_dwordx4 v11, s[12:15], s43 offen lds
  s_add_u32 m0, s42, 12288
  s_mov_b32 s43, 835584
  buffer_load_dwordx4 v11, s[12:15], s43 offen lds
  s_add_u32 m0, s42, 13312
  s_mov_b32 s43, 839680
  buffer_load_dwordx4 v11, s[12:15], s43 offen lds
  s_add_u32 m0, s42, 14336
  s_mov_b32 s43, 843776
  buffer_load_dwordx4 v11, s[12:15], s43 offen lds
  s_add_u32 m0, s42, 15360
  s_mov_b32 s43, 847872
  buffer_load_dwordx4 v11, s[12:15], s43 offen lds
  s_waitcnt vmcnt(16)
  s_barrier
  ds_read_b64_tr_b16 a[128:129], v12 offset:0
  ds_read_b64_tr_b16 a[130:131], v12 offset:2048
  ds_read_b64_tr_b16 a[132:133], v12 offset:4096
  ds_read_b64_tr_b16 a[134:135], v12 offset:6144
  ds_read_b64_tr_b16 a[136:137], v12 offset:8192
  ds_read_b64_tr_b16 a[138:139], v12 offset:10240
  ds_read_b64_tr_b16 a[140:141], v12 offset:12288
  ds_read_b64_tr_b16 a[142:143], v12 offset:14336
  ds_read_b64_tr_b16 a[144:145], v12 offset:16384
  ds_read_b64_tr_b16 a[146:147], v12 offset:18432
  ds_read_b64_tr_b16 a[148:149], v12 offset:20480
  ds_read_b64_tr_b16 a[150:151], v12 offset:22528
  ds_read_b64_tr_b16 a[152:153], v12 offset:24576
  ds_read_b64_tr_b16 a[154:155], v12 offset:26624
  ds_read_b64_tr_b16 a[156:157], v12 offset:28672
  ds_read_b64_tr_b16 a[158:159], v12 offset:30720
  ds_read_b64_tr_b16 a[160:161], v12 offset:32768
  ds_read_b64_tr_b16 a[162:163], v12 offset:34816
  ds_read_b64_tr_b16 a[164:165], v12 offset:36864
  ds_read_b64_tr_b16 a[166:167], v12 offset:38912
  ds_read_b64_tr_b16 a[168:169], v12 offset:40960
  ds_read_b64_tr_b16 a[170:171], v12 offset:43008
  ds_read_b64_tr_b16 a[172:173], v12 offset:45056
  ds_read_b64_tr_b16 a[174:175], v12 offset:47104
  ds_read_b64_tr_b16 a[176:177], v12 offset:49152
  ds_read_b64_tr_b16 a[178:179], v12 offset:51200
  ds_read_b64_tr_b16 a[180:181], v12 offset:53248
  ds_read_b64_tr_b16 a[182:183], v12 offset:55296
  ds_read_b64_tr_b16 a[184:185], v12 offset:57344
  ds_read_b64_tr_b16 a[186:187], v12 offset:59392
  ds_read_b64_tr_b16 a[188:189], v12 offset:61440
  ds_read_b64_tr_b16 a[190:191], v12 offset:63488
  s_waitcnt lgkmcnt(0)
  s_barrier
  s_waitcnt vmcnt(0)
  s_barrier
  ds_read_b64_tr_b16 a[192:193], v13 offset:0
  ds_read_b64_tr_b16 a[194:195], v13 offset:2048
  ds_read_b64_tr_b16 a[196:197], v13 offset:4096
  ds_read_b64_tr_b16 a[198:199], v13 offset:6144
  ds_read_b64_tr_b16 a[200:201], v13 offset:8192
  ds_read_b64_tr_b16 a[202:203], v13 offset:10240
  ds_read_b64_tr_b16 a[204:205], v13 offset:12288
  ds_read_b64_tr_b16 a[206:207], v13 offset:14336
  ds_read_b64_tr_b16 a[208:209], v13 offset:16384
  ds_read_b64_tr_b16 a[210:211], v13 offset:18432
  ds_read_b64_tr_b16 a[212:213], v13 offset:20480
  ds_read_b64_tr_b16 a[214:215], v13 offset:22528
  ds_read_b64_tr_b16 a[216:217], v13 offset:24576
  ds_read_b64_tr_b16 a[218:219], v13 offset:26624
  ds_read_b64_tr_b16 a[220:221], v13 offset:28672
  ds_read_b64_tr_b16 a[222:223], v13 offset:30720
  ds_read_b64_tr_b16 a[224:225], v13 offset:32768
  ds_read_b64_tr_b16 a[226:227], v13 offset:34816
  ds_read_b64_tr_b16 a[228:229], v13 offset:36864
  ds_read_b64_tr_b16 a[230:231], v13 offset:38912
  ds_read_b64_tr_b16 a[232:233], v13 offset:40960
  ds_read_b64_tr_b16 a[234:235], v13 offset:43008
  ds_read_b64_tr_b16 a[236:237], v13 offset:45056
  ds_read_b64_tr_b16 a[238:239], v13 offset:47104
  ds_read_b64_tr_b16 a[240:241], v13 offset:49152
  ds_read_b64_tr_b16 a[242:243], v13 offset:51200
  ds_read_b64_tr_b16 a[244:245], v13 offset:53248
  ds_read_b64_tr_b16 a[246:247], v13 offset:55296
  ds_read_b64_tr_b16 a[248:249], v13 offset:57344
  ds_read_b64_tr_b16 a[250:251], v13 offset:59392
  ds_read_b64_tr_b16 a[252:253], v13 offset:61440
  ds_read_b64_tr_b16 a[254:255], v13 offset:63488
  s_waitcnt lgkmcnt(0)
  s_barrier
  v_and_b32 v11, 7, v1
  v_lshlrev_b32 v11, 2, v11
  s_mov_b32 s42, 0
vf_17:
  buffer_load_dword v10, v11, s[8:11], 0 offen sc0 sc1
  s_add_u32 s42, s42, 1
  s_waitcnt vmcnt(0)
  v_readlane_b32 s43, v10, s31
  v_lshrrev_b32 v10, 22, v10
  v_cmp_ne_u32 vcc, 32, v10
  s_cbranch_vccz vk_18
  s_movk_i32 s41, 1
  s_cmp_gt_u32 s42, 262144
  s_cbranch_scc1 L_fail
  s_sleep 2
  s_branch vf_17
vk_18:
  s_and_b32 s40, s43, 0x1ff
  s_mul_i32 s40, s40, s40
  s_bfe_u32 s41, s43, 0xd0009
  s_lshl_b32 s41, s41, 5
  s_cmp_eq_u32 s40, s41
  s_cselect_b32 s47, 1, 0
  s_lshl_b32 s40, s49, 7
  v_bfe_u32 v9, v1, 0, 3
  v_lshlrev_b32 v9, 2, v9
  v_add_u32 v9, s40, v9
  s_lshl_b32 s51, s49, 15
  s_lshl_b32 s40, s50, 13
  s_add_u32 s51, s51, s40
  s_lshl_b32 s40, s28, 11
  s_add_u32 s51, s51, s40
  s_add_u32 s51, s51, 35651584
  s_lshl_b32 s52, s49, 6
  s_lshl_b32 s40, s50, 4
  s_add_u32 s52, s52, s40
  s_lshl_b32 s40, s28, 2
  s_add_u32 s52, s52, s40
  s_lshl_b32 s49, s49, 16
  s_add_u32 s49, s49, 65011712
  s_lshl_b32 s48, s28, 10
  v_add_u32 v6, s48, v2
  v_mov_b32 v5, v2
  v_add_u32 v7, 0x10000, v2
  s_mov_b32 s38, 0
  s_add_u32 s36, s35, 1
  s_cmp_lt_u32 s36, s34
  s_cselect_b32 s36, s36, -1
  s_cmp_lt_i32 s35, 0
  s_cselect_b32 s36, -1, s36
  s_mov_b32 s58, 0
  s_mov_b32 s57, 0
  v_mov_b32 v14, 0
  s_lshl_b32 s59, s29, 7
  s_add_u32 s59, s59, 491520
L_W_get:
  s_lshl_b32 s43, s35, 9
  s_add_u32 s43, s43, 196608
  s_mov_b32 s40, 0
poll_19:
  buffer_load_dword v10, v9, s[4:7], s43 offen sc1
  s_add_u32 s40, s40, 1
  s_waitcnt vmcnt(0)
  v_cmp_eq_u32 vcc, 0, v10
  s_cbranch_vccz pd_20
  s_movk_i32 s41, 23
  s_cmp_gt_u32 s40, 262144
  s_cbranch_scc1 L_fail
  s_sleep 1
  s_branch poll_19
pd_20:
L_W_g2:
  s_lshl_b32 s39, s35, 18
  s_add_u32 s39, s39, s49
  s_xor_b32 s42, s38, 0
  s_add_u32 m0, s42, s48
  s_nop 0
  buffer_load_dwordx4 v6, s[4:7], s39 offen sc1 lds
  s_add_u32 m0, m0, 4096
  s_add_u32 s39, s39, 4096
  buffer_load_dwordx4 v6, s[4:7], s39 offen sc1 lds
  s_add_u32 m0, m0, 4096
  s_add_u32 s39, s39, 4096
  buffer_load_dwordx4 v6, s[4:7], s39 offen sc1 lds
  s_add_u32 m0, m0, 4096
  s_add_u32 s39, s39, 4096
  buffer_load_dwordx4 v6, s[4:7], s39 offen sc1 lds
  s_add_u32 m0, m0, 4096
  s_add_u32 s39, s39, 4096
  buffer_load_dwordx4 v6, s[4:7], s39 offen sc1 lds
  s_add_u32 m0, m0, 4096
  s_add_u32 s39, s39, 4096
  buffer_load_dwordx4 v6, s[4:7], s39 offen sc1 lds
  s_add_u32 m0, m0, 4096
  s_add_u32 s39, s39, 4096
  buffer_load_dwordx4 v6, s[4:7], s39 offen sc1 lds
  s_add_u32 m0, m0, 4096
  s_add_u32 s39, s39, 4096
  buffer_load_dwordx4 v6, s[4:7], s39 offen sc1 lds
  s_add_u32 m0, m0, 4096
  s_add_u32 s39, s39, 4096
  s_cmp_eq_u32 s57, 0
  s_cbranch_scc1 L_W_d
  s_mov_b64 exec, 1
  buffer_store_dword v4, v3, s[4:7], s58 offen sc1
  s_mov_b64 exec, -1
  s_mov_b32 s58, 0
  s_branch L_W_d2
L_W_d:
  s_mov_b64 exec, 1
  buffer_store_dword v4, v3, s[4:7], s59 offen
  s_mov_b64 exec, -1
L_W_d2:
  s_waitcnt vmcnt(5)
  s_barrier
  ds_read_b128 v[16:19], v5 offset:0
  ds_read_b128 v[20:23], v5 offset:1024
  ds_read_b128 v[24:27], v5 offset:2048
  ds_read_b128 v[28:31], v5 offset:3072
  ds_read_b128 v[32:35], v5 offset:4096
  ds_read_b128 v[36:39], v5 offset:5120
  ds_read_b128 v[40:43], v5 offset:6144
  ds_read_b128 v[44:47], v5 offset:7168
  s_cmp_eq_u32 s58, 0
  s_cbranch_scc1 L_W_d3
  s_mov_b64 exec, 1
  buffer_store_dword v4, v3, s[4:7], s58 offen sc1
  s_mov_b64 exec, -1
L_W_d3:
  s_waitcnt lgkmcnt(7)
  v_mfma_f32_32x32x16_bf16 v[64:79], a[0:3], v[16:19], 0
  ds_read_b128 v[16:19], v5 offset:8192
  buffer_load_dwordx4 v6, s[4:7], s39 offen sc1 lds
  s_add_u32 m0, m0, 4096
  s_add_u32 s39, s39, 4096
  s_waitcnt lgkmcnt(7)
  v_mfma_f32_32x32x16_bf16 v[80:95], a[4:7], v[20:23], 0
  ds_read_b128 v[20:23], v5 offset:9216
  s_waitcnt lgkmcnt(7)
  v_mfma_f32_32x32x16_bf16 v[64:79], a[8:11], v[24:27], v[64:79]
  ds_read_b128 v[24:27], v5 offset:10240
  buffer_load_dwordx4 v6, s[4:7], s39 offen sc1 lds
  s_add_u32 m0, m0, 4096
  s_add_u32 s39, s39, 4096
  s_waitcnt lgkmcnt(7)
  v_mfma_f32_32x32x16_bf16 v[80:95], a[12:15], v[28:31], v[80:95]
  ds_read_b128 v[28:31], v5 offset:11264
  s_waitcnt lgkmcnt(7)
  v_mfma_f32_32x32x16_bf16 v[64:79], a[16:19], v[32:35], v[64:79]
  ds_read_b128 v[32:35], v5 offset:12288
  buffer_load_dwordx4 v6, s[4:7], s39 offen sc1 lds
  s_add_u32 m0, m0, 4096
  s_add_u32 s39, s39, 4096
  s_waitcnt lgkmcnt(7)
  v_mfma_f32_32x32x16_bf16 v[80:95], a[20:23], v[36:39], v[80:95]
  ds_read_b128 v[36:39], v5 offset:13312
  s_waitcnt lgkmcnt(7)
  v_mfma_f32_32x32x16_bf16 v[64:79], a[24:27], v[40:43], v[64:79]
  ds_read_b128 v[40:43], v5 offset:14336
  buffer_load_dwordx4 v6, s[4:7], s39 offen sc1 lds
  s_add_u32 m0, m0, 4096
  s_add_u32 s39, s39, 4096
  s_waitcnt lgkmcnt(7)
  v_mfma_f32_32x32x16_bf16 v[80:95], a[28:31], v[44:47], v[80:95]
  ds_read_b128 v[44:47], v5 offset:15360
  s_waitcnt vmcnt(5)
  s_barrier
  s_waitcnt lgkmcnt(7)
  v_mfma_f32_32x32x16_bf16 v[64:79], a[32:35], v[16:19], v[64:79]
  ds_read_b128 v[16:19], v5 offset:16384
  buffer_load_dwordx4 v6, s[4:7], s39 offen sc1 lds
  s_add_u32 m0, m0, 4096
  s_add_u32 s39, s39, 4096
  s_waitcnt lgkmcnt(7)
  v_mfma_f32_32x32x16_bf16 v[80:95], a[36:39], v[20:23], v[80:95]
  ds_read_b128 v[20:23], v5 offset:17408
  s_waitcnt lgkmcnt(7)
  v_mfma_f32_32x32x16_bf16 v[64:79], a[40:43], v[24:27], v[64:79]
  ds_read_b128 v[24:27], v5 offset:18432
  buffer_load_dwordx4 v6, s[4:7], s39 offen sc1 lds
  s_add_u32 m0, m0, 4096
  s_add_u32 s39, s39, 4096
  s_waitcnt lgkmcnt(7)
  v_mfma_f32_32x32x16_bf16 v[80:95], a[44:47], v[28:31], v[80:95]
  ds_read_b128 v[28:31], v5 offset:19456
  s_waitcnt lgkmcnt(7)
  v_mfma_f32_32x32x16_bf16 v[64:79], a[48:51], v[32:35], v[64:79]
  ds_read_b128 v[32:35], v5 offset:20480
  buffer_load_dwordx4 v6, s[4:7], s39 offen sc1 lds
  s_add_u32 m0, m0, 4096
  s_add_u32 s39, s39, 4096
  s_waitcnt lgkmcnt(7)
  v_mfma_f32_32x32x16_bf16 v[80:95], a[52:55], v[36:39], v[80:95]
  ds_read_b128 v[36:39], v5 offset:21504
  s_waitcnt lgkmcnt(7)
  v_mfma_f32_32x32x16_bf16 v[64:79], a[56:59], v[40:43], v[64:79]
  ds_read_b128 v[40:43], v5 offset:22528
  buffer_load_dwordx4 v6, s[4:7], s39 offen sc1 lds
  s_add_u32 m0, m0, 4096
  s_add_u32 s39, s39, 4096
  s_waitcnt lgkmcnt(7)
  v_mfma_f32_32x32x16_bf16 v[80:95], a[60:63], v[44:47], v[80:95]
  ds_read_b128 v[44:47], v5 offset:23552
  s_waitcnt lgkmcnt(7)
  v_mfma_f32_32x32x16_bf16 v[64:79], a[64:67], v[16:19], v[64:79]
  ds_read_b128 v[16:19], v5 offset:24576
  s_waitcnt lgkmcnt(7)
  v_mfma_f32_32x32x16_bf16 v[80:95], a[68:71], v[20:23], v[80:95]
  ds_read_b128 v[20:23], v5 offset:25600
  s_waitcnt lgkmcnt(7)
  v_mfma_f32_32x32x16_bf16 v[64:79], a[72:75], v[24:27], v[64:79]
  ds_read_b128 v[24:27], v5 offset:26624
  s_waitcnt lgkmcnt(7)
  v_mfma_f32_32x32x16_bf16 v[80:95], a[76:79], v[28:31], v[80:95]
  ds_read_b128 v[28:31], v5 offset:27648
  s_waitcnt lgkmcnt(7)
  v_mfma_f32_32x32x16_bf16 v[64:79], a[80:83], v[32:35], v[64:79]
  ds_read_b128 v[32:35], v5 offset:28672
  s_waitcnt lgkmcnt(7)
  v_mfma_f32_32x32x16_bf16 v[80:95], a[84:87], v[36:39], v[80:95]
  ds_read_b128 v[36:39], v5 offset:29696
  s_waitcnt lgkmcnt(7)
  v_mfma_f32_32x32x16_bf16 v[64:79], a[88:91], v[40:43], v[64:79]
  ds_read_b128 v[40:43], v5 offset:30720
  s_waitcnt lgkmcnt(7)
  v_mfma_f32_32x32x16_bf16 v[80:95], a[92:95], v[44:47], v[80:95]
  ds_read_b128 v[44:47], v5 offset:31744
  s_waitcnt vmcnt(4)
  s_barrier
  s_max_i32 s43, s36, 0
  s_lshl_b32 s43, s43, 9
  s_add_u32 s43, s43, 196608
  buffer_load_dword v10, v9, s[4:7], s43 offen sc1
  s_waitcnt lgkmcnt(7)
  v_mfma_f32_32x32x16_bf16 v[64:79], a[96:99], v[16:19], v[64:79]
  ds_read_b128 v[16:19], v5 offset:32768
  s_waitcnt lgkmcnt(7)
  v_mfma_f32_32x32x16_bf16 v[80:95], a[100:103], v[20:23], v[80:95]
  ds_read_b128 v[20:23], v5 offset:33792
  s_waitcnt lgkmcnt(7)
  v_mfma_f32_32x32x16_bf16 v[64:79], a[104:107], v[24:27], v[64:79]
  ds_read_b128 v[24:27], v5 offset:34816
  s_waitcnt lgkmcnt(7)
  v_mfma_f32_32x32x16_bf16 v[80:95], a[108:111], v[28:31], v[80:95]
  ds_read_b128 v[28:31], v5 offset:35840
  s_waitcnt lgkmcnt(7)
  v_mfma_f32_32x32x16_bf16 v[64:79], a[112:115], v[32:35], v[64:79]
  ds_read_b128 v[32:35], v5 offset:36864
  s_waitcnt lgkmcnt(7)
  v_mfma_f32_32x32x16_bf16 v[80:95], a[116:119], v[36:39], v[80:95]
  ds_read_b128 v[36:39], v5 offset:37888
  s_waitcnt lgkmcnt(7)
  v_mfma_f32_32x32x16_bf16 v[64:79], a[120:123], v[40:43], v[64:79]
  ds_read_b128 v[40:43], v5 offset:38912
  s_waitcnt lgkmcnt(7)
  v_mfma_f32_32x32x16_bf16 v[80:95], a[124:127], v[44:47], v[80:95]
  ds_read_b128 v[44:47], v5 offset:39936
  s_waitcnt lgkmcnt(7)
  v_mfma_f32_32x32x16_bf16 v[64:79], a[128:131], v[16:19], v[64:79]
  ds_read_b128 v[16:19], v5 offset:40960
  s_waitcnt lgkmcnt(7)
  v_mfma_f32_32x32x16_bf16 v[80:95], a[132:135], v[20:23], v[80:95]
  ds_read_b128 v[20:23], v5 offset:41984
  s_waitcnt lgkmcnt(7)
  v_mfma_f32_32x32x16_bf16 v[64:79], a[136:139], v[24:27], v[64:79]
  ds_read_b128 v[24:27], v5 offset:43008
  s_waitcnt lgkmcnt(7)
  v_mfma_f32_32x32x16_bf16 v[80:95], a[140:143], v[28:31], v[80:95]
  ds_read_b128 v[28:31], v5 offset:44032
  s_waitcnt lgkmcnt(7)
  v_mfma_f32_32x32x16_bf16 v[64:79], a[144:147], v[32:35], v[64:79]
  ds_read_b128 v[32:35], v5 offset:45056
  s_waitcnt lgkmcnt(7)
  v_mfma_f32_32x32x16_bf16 v[80:95], a[148:151], v[36:39], v[80:95]
  ds_read_b128 v[36:39], v5 offset:46080
  s_waitcnt lgkmcnt(7)
  v_mfma_f32_32x32x16_bf16 v[64:79], a[152:155], v[40:43], v[64:79]
  ds_read_b128 v[40:43], v5 offset:47104
  s_waitcnt lgkmcnt(7)
  v_mfma_f32_32x32x16_bf16 v[80:95], a[156:159], v[44:47], v[80:95]
  ds_read_b128 v[44:47], v5 offset:48128
  s_waitcnt vmcnt(0)
  s_barrier
  s_mov_b32 s37, 0
  v_cmp_eq_u32 vcc, 0, v10
  s_cmp_lt_i32 s36, 0
  s_cbranch_scc1 L_W_ny
  s_cbranch_vccnz L_W_ny
L_W_yy:
  s_mov_b32 s37, 1
  s_branch L_W_ey
L_W_ny:
  s_waitcnt lgkmcnt(7)
  v_mfma_f32_32x32x16_bf16 v[64:79], a[160:163], v[16:19], v[64:79]
  ds_read_b128 v[16:19], v5 offset:49152
  s_waitcnt lgkmcnt(7)
  v_mfma_f32_32x32x16_bf16 v[80:95], a[164:167], v[20:23], v[80:95]
  ds_read_b128 v[20:23], v5 offset:50176
  s_waitcnt lgkmcnt(7)
  v_mfma_f32_32x32x16_bf16 v[64:79], a[168:171], v[24:27], v[64:79]
  ds_read_b128 v[24:27], v5 offset:51200
  s_waitcnt lgkmcnt(7)
  v_mfma_f32_32x32x16_bf16 v[80:95], a[172:175], v[28:31], v[80:95]
  ds_read_b128 v[28:31], v5 offset:52224
  s_waitcnt lgkmcnt(7)
  v_mfma_f32_32x32x16_bf16 v[64:79], a[176:179], v[32:35], v[64:79]
  ds_read_b128 v[32:35], v5 offset:53248
  s_waitcnt lgkmcnt(7)
  v_mfma_f32_32x32x16_bf16 v[80:95], a[180:183], v[36:39], v[80:95]
  ds_read_b128 v[36:39], v5 offset:54272
  s_waitcnt lgkmcnt(7)
  v_mfma_f32_32x32x16_bf16 v[64:79], a[184:187], v[40:43], v[64:79]
  ds_read_b128 v[40:43], v5 offset:55296
  s_waitcnt lgkmcnt(7)
  v_mfma_f32_32x32x16_bf16 v[80:95], a[188:191], v[44:47], v[80:95]
  ds_read_b128 v[44:47], v5 offset:56320
  s_waitcnt lgkmcnt(7)
  v_mfma_f32_32x32x16_bf16 v[64:79], a[192:195], v[16:19], v[64:79]
  ds_read_b128 v[16:19], v5 offset:57344
  s_waitcnt lgkmcnt(7)
  v_mfma_f32_32x32x16_bf16 v[80:95], a[196:199], v[20:23], v[80:95]
  ds_read_b128 v[20:23], v5 offset:58368
  s_waitcnt lgkmcnt(7)
  v_mfma_f32_32x32x16_bf16 v[64:79], a[200:203], v[24:27], v[64:79]
  ds_read_b128 v[24:27], v5 offset:59392
  s_waitcnt lgkmcnt(7)
  v_mfma_f32_32x32x16_bf16 v[80:95], a[204:207], v[28:31], v[80:95]
  ds_read_b128 v[28:31], v5 offset:60416
  s_waitcnt lgkmcnt(7)
  v_mfma_f32_32x32x16_bf16 v[64:79], a[208:211], v[32:35], v[64:79]
  ds_read_b128 v[32:35], v5 offset:61440
  s_waitcnt lgkmcnt(7)
  v_mfma_f32_32x32x16_bf16 v[80:95], a[212:215], v[36:39], v[80:95]
  ds_read_b128 v[36:39], v5 offset:62464
  s_max_i32 s43, s36, 0
  s_lshl_b32 s43, s43, 9
  s_add_u32 s43, s43, 196608
  buffer_load_dword v10, v9, s[4:7], s43 offen sc1
  s_waitcnt lgkmcnt(7)
  v_mfma_f32_32x32x16_bf16 v[64:79], a[216:219], v[40:43], v[64:79]
  ds_read_b128 v[40:43], v5 offset:63488
  s_waitcnt lgkmcnt(7)
  v_mfma_f32_32x32x16_bf16 v[80:95], a[220:223], v[44:47], v[80:95]
  ds_read_b128 v[44:47], v5 offset:64512
  s_waitcnt lgkmcnt(7)
  v_mfma_f32_32x32x16_bf16 v[64:79], a[224:227], v[16:19], v[64:79]
  s_waitcnt lgkmcnt(6)
  v_mfma_f32_32x32x16_bf16 v[80:95], a[228:231], v[20:23], v[80:95]
  s_waitcnt lgkmcnt(5)
  v_mfma_f32_32x32x16_bf16 v[64:79], a[232:235], v[24:27], v[64:79]
  s_waitcnt lgkmcnt(4)
  v_mfma_f32_32x32x16_bf16 v[80:95], a[236:239], v[28:31], v[80:95]
  s_add_u32 s56, s36, 1
  s_cmp_lt_u32 s56, s34
  s_cselect_b32 s56, s56, -1
  s_cmp_lt_i32 s36, 0
  s_cselect_b32 s56, -1, s56
  s_max_i32 s43, s56, 0
  s_lshl_b32 s43, s43, 9
  s_add_u32 s43, s43, 196608
  buffer_load_dword v14, v9, s[4:7], s43 offen sc1
  s_waitcnt lgkmcnt(3)
  v_mfma_f32_32x32x16_bf16 v[64:79], a[240:243], v[32:35], v[64:79]
  s_waitcnt lgkmcnt(2)
  v_mfma_f32_32x32x16_bf16 v[80:95], a[244:247], v[36:39], v[80:95]
  s_waitcnt lgkmcnt(1)
  v_mfma_f32_32x32x16_bf16 v[64:79], a[248:251], v[40:43], v[64:79]
  s_waitcnt lgkmcnt(0)
  v_mfma_f32_32x32x16_bf16 v[80:95], a[252:255], v[44:47], v[80:95]
  s_branch L_W_epi
L_W_ey:
  s_lshl_b32 s39, s36, 18
  s_add_u32 s39, s39, s49
  s_xor_b32 s42, s38, 65536
  s_add_u32 m0, s42, s48
  s_nop 0
  s_waitcnt lgkmcnt(7)
  v_mfma_f32_32x32x16_bf16 v[64:79], a[160:163], v[16:19], v[64:79]
  ds_read_b128 v[16:19], v5 offset:49152
  buffer_load_dwordx4 v6, s[4:7], s39 offen sc1 lds
  s_add_u32 m0, m0, 4096
  s_add_u32 s39, s39, 4096
  s_waitcnt lgkmcnt(7)
  v_mfma_f32_32x32x16_bf16 v[80:95], a[164:167], v[20:23], v[80:95]
  ds_read_b128 v[20:23], v5 offset:50176
  buffer_load_dwordx4 v6, s[4:7], s39 offen sc1 lds
  s_add_u32 m0, m0, 4096
  s_add_u32 s39, s39, 4096
  s_waitcnt lgkmcnt(7)
  v_mfma_f32_32x32x16_bf16 v[64:79], a[168:171], v[24:27], v[64:79]
  ds_read_b128 v[24:27], v5 offset:51200
  buffer_load_dwordx4 v6, s[4:7], s39 offen sc1 lds
  s_add_u32 m0, m0, 4096
  s_add_u32 s39, s39, 4096
  s_waitcnt lgkmcnt(7)
  v_mfma_f32_32x32x16_bf16 v[80:95], a[172:175], v[28:31], v[80:95]
  ds_read_b128 v[28:31], v5 offset:52224
  buffer_load_dwordx4 v6, s[4:7], s39 offen sc1 lds
  s_add_u32 m0, m0, 4096
  s_add_u32 s39, s39, 4096
  s_waitcnt lgkmcnt(7)
  v_mfma_f32_32x32x16_bf16 v[64:79], a[176:179], v[32:35], v[64:79]
  ds_read_b128 v[32:35], v5 offset:53248
  buffer_load_dwordx4 v6, s[4:7], s39 offen sc1 lds
  s_add_u32 m0, m0, 4096
  s_add_u32 s39, s39, 4096
  s_waitcnt lgkmcnt(7)
  v_mfma_f32_32x32x16_bf16 v[80:95], a[180:183], v[36:39], v[80:95]
  ds_read_b128 v[36:39], v5 offset:54272
  buffer_load_dwordx4 v6, s[4:7], s39 offen sc1 lds
  s_add_u32 m0, m0, 4096
  s_add_u32 s39, s39, 4096
  s_waitcnt lgkmcnt(7)
  v_mfma_f32_32x32x16_bf16 v[64:79], a[184:187], v[40:43], v[64:79]
  ds_read_b128 v[40:43], v5 offset:55296
  buffer_load_dwordx4 v6, s[4:7], s39 offen sc1 lds
  s_add_u32 m0, m0, 4096
  s_add_u32 s39, s39, 4096
  s_waitcnt lgkmcnt(7)
  v_mfma_f32_32x32x16_bf16 v[80:95], a[188:191], v[44:47], v[80:95]
  ds_read_b128 v[44:47], v5 offset:56320
  buffer_load_dwordx4 v6, s[4:7], s39 offen sc1 lds
  s_add_u32 m0, m0, 4096
  s_add_u32 s39, s39, 4096
  s_waitcnt lgkmcnt(7)
  v_mfma_f32_32x32x16_bf16 v[64:79], a[192:195], v[16:19], v[64:79]
  ds_read_b128 v[16:19], v5 offset:57344
  buffer_load_dwordx4 v6, s[4:7], s39 offen sc1 lds
  s_add_u32 m0, m0, 4096
  s_add_u32 s39, s39, 4096
  s_waitcnt lgkmcnt(7)
  v_mfma_f32_32x32x16_bf16 v[80:95], a[196:199], v[20:23], v[80:95]
  ds_read_b128 v[20:23], v5 offset:58368
  buffer_load_dwordx4 v6, s[4:7], s39 offen sc1 lds
  s_add_u32 m0, m0, 4096
  s_add_u32 s39, s39, 4096
  s_waitcnt lgkmcnt(7)
  v_mfma_f32_32x32x16_bf16 v[64:79], a[200:203], v[24:27], v[64:79]
  ds_read_b128 v[24:27], v5 offset:59392
  buffer_load_dwordx4 v6, s[4:7], s39 offen sc1 lds
  s_add_u32 m0, m0, 4096
  s_add_u32 s39, s39, 4096
  s_waitcnt lgkmcnt(7)
  v_mfma_f32_32x32x16_bf16 v[80:95], a[204:207], v[28:31], v[80:95]
  ds_read_b128 v[28:31], v5 offset:60416
  buffer_load_dwordx4 v6, s[4:7], s39 offen sc1 lds
  s_add_u32 m0, m0, 4096
  s_add_u32 s39, s39, 4096
  s_waitcnt lgkmcnt(7)
  v_mfma_f32_32x32x16_bf16 v[64:79], a[208:211], v[32:35], v[64:79]
  ds_read_b128 v[32:35], v5 offset:61440
  buffer_load_dwordx4 v6, s[4:7], s39 offen sc1 lds
  s_add_u32 m0, m0, 4096
  s_add_u32 s39, s39, 4096
  s_waitcnt lgkmcnt(7)
  v_mfma_f32_32x32x16_bf16 v[80:95], a[212:215], v[36:39], v[80:95]
  ds_read_b128 v[36:39], v5 offset:62464
  buffer_load_dwordx4 v6, s[4:7], s39 offen sc1 lds
  s_add_u32 m0, m0, 4096
  s_add_u32 s39, s39, 4096
  s_waitcnt lgkmcnt(7)
  v_mfma_f32_32x32x16_bf16 v[64:79], a[216:219], v[40:43], v[64:79]
  ds_read_b128 v[40:43], v5 offset:63488
  buffer_load_dwordx4 v6, s[4:7], s39 offen sc1 lds
  s_add_u32 m0, m0, 4096
  s_add_u32 s39, s39, 4096
  s_waitcnt lgkmcnt(7)
  v_mfma_f32_32x32x16_bf16 v[80:95], a[220:223], v[44:47], v[80:95]
  ds_read_b128 v[44:47], v5 offset:64512
  buffer_load_dwordx4 v6, s[4:7], s39 offen sc1 lds
  s_add_u32 m0, m0, 4096
  s_add_u32 s39, s39, 4096
  s_waitcnt lgkmcnt(7)
  v_mfma_f32_32x32x16_bf16 v[64:79], a[224:227], v[16:19], v[64:79]
  s_waitcnt lgkmcnt(6)
  v_mfma_f32_32x32x16_bf16 v[80:95], a[228:231], v[20:23], v[80:95]
  s_waitcnt lgkmcnt(5)
  v_mfma_f32_32x32x16_bf16 v[64:79], a[232:235], v[24:27], v[64:79]
  s_waitcnt lgkmcnt(4)
  v_mfma_f32_32x32x16_bf16 v[80:95], a[236:239], v[28:31], v[80:95]
  s_add_u32 s56, s36, 1
  s_cmp_lt_u32 s56, s34
  s_cselect_b32 s56, s56, -1
  s_cmp_lt_i32 s36, 0
  s_cselect_b32 s56, -1, s56
  s_max_i32 s43, s56, 0
  s_lshl_b32 s43, s43, 9
  s_add_u32 s43, s43, 196608
  buffer_load_dword v14, v9, s[4:7], s43 offen sc1
  s_waitcnt lgkmcnt(3)
  v_mfma_f32_32x32x16_bf16 v[64:79], a[240:243], v[32:35], v[64:79]
  s_waitcnt lgkmcnt(2)
  v_mfma_f32_32x32x16_bf16 v[80:95], a[244:247], v[36:39], v[80:95]
  s_waitcnt lgkmcnt(1)
  v_mfma_f32_32x32x16_bf16 v[64:79], a[248:251], v[40:43], v[64:79]
  s_waitcnt lgkmcnt(0)
  v_mfma_f32_32x32x16_bf16 v[80:95], a[252:255], v[44:47], v[80:95]
  s_branch L_W_epi
L_W_top:
  s_barrier
  ds_read_b128 v[16:19], v5 offset:0
  ds_read_b128 v[20:23], v5 offset:1024
  ds_read_b128 v[24:27], v5 offset:2048
  ds_read_b128 v[28:31], v5 offset:3072
  ds_read_b128 v[32:35], v5 offset:4096
  ds_read_b128 v[36:39], v5 offset:5120
  ds_read_b128 v[40:43], v5 offset:6144
  ds_read_b128 v[44:47], v5 offset:7168
  s_mov_b32 s37, 0
  v_cmp_eq_u32 vcc, 0, v14
  s_cmp_lt_i32 s36, 0
  s_cbranch_scc1 L_W_nx
  s_cbranch_vccnz L_W_nx
L_W_yx:
  s_mov_b32 s37, 1
  s_branch L_W_ex
L_W_nx:
  s_waitcnt lgkmcnt(7)
  v_mfma_f32_32x32x16_bf16 v[64:79], a[0:3], v[16:19], 0
  ds_read_b128 v[16:19], v5 offset:8192
  s_waitcnt lgkmcnt(7)
  v_mfma_f32_32x32x16_bf16 v[80:95], a[4:7], v[20:23], 0
  ds_read_b128 v[20:23], v5 offset:9216
  s_waitcnt lgkmcnt(7)
  v_mfma_f32_32x32x16_bf16 v[64:79], a[8:11], v[24:27], v[64:79]
  ds_read_b128 v[24:27], v5 offset:10240
  s_waitcnt lgkmcnt(7)
  v_mfma_f32_32x32x16_bf16 v[80:95], a[12:15], v[28:31], v[80:95]
  ds_read_b128 v[28:31], v5 offset:11264
  s_waitcnt lgkmcnt(7)
  v_mfma_f32_32x32x16_bf16 v[64:79], a[16:19], v[32:35], v[64:79]
  ds_read_b128 v[32:35], v5 offset:12288
  s_waitcnt lgkmcnt(7)
  v_mfma_f32_32x32x16_bf16 v[80:95], a[20:23], v[36:39], v[80:95]
  ds_read_b128 v[36:39], v5 offset:13312
  s_waitcnt lgkmcnt(7)
  v_mfma_f32_32x32x16_bf16 v[64:79], a[24:27], v[40:43], v[64:79]
  ds_read_b128 v[40:43], v5 offset:14336
  s_waitcnt lgkmcnt(7)
  v_mfma_f32_32x32x16_bf16 v[80:95], a[28:31], v[44:47], v[80:95]
  ds_read_b128 v[44:47], v5 offset:15360
  s_barrier
  s_waitcnt lgkmcnt(7)
  v_mfma_f32_32x32x16_bf16 v[64:79], a[32:35], v[16:19], v[64:79]
  ds_read_b128 v[16:19], v5 offset:16384
  s_waitcnt lgkmcnt(7)
  v_mfma_f32_32x32x16_bf16 v[80:95], a[36:39], v[20:23], v[80:95]
  ds_read_b128 v[20:23], v5 offset:17408
  s_waitcnt lgkmcnt(7)
  v_mfma_f32_32x32x16_bf16 v[64:79], a[40:43], v[24:27], v[64:79]
  ds_read_b128 v[24:27], v5 offset:18432
  s_waitcnt lgkmcnt(7)
  v_mfma_f32_32x32x16_bf16 v[80:95], a[44:47], v[28:31], v[80:95]
  ds_read_b128 v[28:31], v5 offset:19456
  s_waitcnt lgkmcnt(7)
  v_mfma_f32_32x32x16_bf16 v[64:79], a[48:51], v[32:35], v[64:79]
  ds_read_b128 v[32:35], v5 offset:20480
  s_waitcnt lgkmcnt(7)
  v_mfma_f32_32x32x16_bf16 v[80:95], a[52:55], v[36:39], v[80:95]
  ds_read_b128 v[36:39], v5 offset:21504
  s_waitcnt lgkmcnt(7)
  v_mfma_f32_32x32x16_bf16 v[64:79], a[56:59], v[40:43], v[64:79]
  ds_read_b128 v[40:43], v5 offset:22528
  s_waitcnt lgkmcnt(7)
  v_mfma_f32_32x32x16_bf16 v[80:95], a[60:63], v[44:47], v[80:95]
  ds_read_b128 v[44:47], v5 offset:23552
  s_waitcnt lgkmcnt(7)
  v_mfma_f32_32x32x16_bf16 v[64:79], a[64:67], v[16:19], v[64:79]
  ds_read_b128 v[16:19], v5 offset:24576
  s_waitcnt lgkmcnt(7)
  v_mfma_f32_32x32x16_bf16 v[80:95], a[68:71], v[20:23], v[80:95]
  ds_read_b128 v[20:23], v5 offset:25600
  s_waitcnt lgkmcnt(7)
  v_mfma_f32_32x32x16_bf16 v[64:79], a[72:75], v[24:27], v[64:79]
  ds_read_b128 v[24:27], v5 offset:26624
  s_waitcnt lgkmcnt(7)
  v_mfma_f32_32x32x16_bf16 v[80:95], a[76:79], v[28:31], v[80:95]
  ds_read_b128 v[28:31], v5 offset:27648
  s_waitcnt lgkmcnt(7)
  v_mfma_f32_32x32x16_bf16 v[64:79], a[80:83], v[32:35], v[64:79]
  ds_read_b128 v[32:35], v5 offset:28672
  s_waitcnt lgkmcnt(7)
  v_mfma_f32_32x32x16_bf16 v[80:95], a[84:87], v[36:39], v[80:95]
  ds_read_b128 v[36:39], v5 offset:29696
  s_waitcnt lgkmcnt(7)
  v_mfma_f32_32x32x16_bf16 v[64:79], a[88:91], v[40:43], v[64:79]
  ds_read_b128 v[40:43], v5 offset:30720
  s_waitcnt lgkmcnt(7)
  v_mfma_f32_32x32x16_bf16 v[80:95], a[92:95], v[44:47], v[80:95]
  ds_read_b128 v[44:47], v5 offset:31744
  s_barrier
  s_waitcnt lgkmcnt(7)
  v_mfma_f32_32x32x16_bf16 v[64:79], a[96:99], v[16:19], v[64:79]
  ds_read_b128 v[16:19], v5 offset:32768
  s_waitcnt lgkmcnt(7)
  v_mfma_f32_32x32x16_bf16 v[80:95], a[100:103], v[20:23], v[80:95]
  ds_read_b128 v[20:23], v5 offset:33792
  s_waitcnt lgkmcnt(7)
  v_mfma_f32_32x32x16_bf16 v[64:79], a[104:107], v[24:27], v[64:79]
  ds_read_b128 v[24:27], v5 offset:34816
  s_waitcnt lgkmcnt(7)
  v_mfma_f32_32x32x16_bf16 v[80:95], a[108:111], v[28:31], v[80:95]
  ds_read_b128 v[28:31], v5 offset:35840
  s_waitcnt lgkmcnt(7)
  v_mfma_f32_32x32x16_bf16 v[64:79], a[112:115], v[32:35], v[64:79]
  ds_read_b128 v[32:35], v5 offset:36864
  s_waitcnt lgkmcnt(7)
  v_mfma_f32_32x32x16_bf16 v[80:95], a[116:119], v[36:39], v[80:95]
  ds_read_b128 v[36:39], v5 offset:37888
  s_waitcnt lgkmcnt(7)
  v_mfma_f32_32x32x16_bf16 v[64:79], a[120:123], v[40:43], v[64:79]
  ds_read_b128 v[40:43], v5 offset:38912
  s_waitcnt lgkmcnt(7)
  v_mfma_f32_32x32x16_bf16 v[80:95], a[124:127], v[44:47], v[80:95]
  ds_read_b128 v[44:47], v5 offset:39936
  s_waitcnt vmcnt(0)
  s_mov_b64 exec, 1
  buffer_store_dword v4, v3, s[4:7], s58 offen sc1
  s_mov_b64 exec, -1
  s_waitcnt lgkmcnt(7)
  v_mfma_f32_32x32x16_bf16 v[64:79], a[128:131], v[16:19], v[64:79]
  ds_read_b128 v[16:19], v5 offset:40960
  s_waitcnt lgkmcnt(7)
  v_mfma_f32_32x32x16_bf16 v[80:95], a[132:135], v[20:23], v[80:95]
  ds_read_b128 v[20:23], v5 offset:41984
  s_waitcnt lgkmcnt(7)
  v_mfma_f32_32x32x16_bf16 v[64:79], a[136:139], v[24:27], v[64:79]
  ds_read_b128 v[24:27], v5 offset:43008
  s_waitcnt lgkmcnt(7)
  v_mfma_f32_32x32x16_bf16 v[80:95], a[140:143], v[28:31], v[80:95]
  ds_read_b128 v[28:31], v5 offset:44032
  s_waitcnt lgkmcnt(7)
  v_mfma_f32_32x32x16_bf16 v[64:79], a[144:147], v[32:35], v[64:79]
  ds_read_b128 v[32:35], v5 offset:45056
  s_waitcnt lgkmcnt(7)
  v_mfma_f32_32x32x16_bf16 v[80:95], a[148:151], v[36:39], v[80:95]
  ds_read_b128 v[36:39], v5 offset:46080
  s_waitcnt lgkmcnt(7)
  v_mfma_f32_32x32x16_bf16 v[64:79], a[152:155], v[40:43], v[64:79]
  ds_read_b128 v[40:43], v5 offset:47104
  s_waitcnt lgkmcnt(7)
  v_mfma_f32_32x32x16_bf16 v[80:95], a[156:159], v[44:47], v[80:95]
  ds_read_b128 v[44:47], v5 offset:48128
  s_barrier
  s_waitcnt lgkmcnt(7)
  v_mfma_f32_32x32x16_bf16 v[64:79], a[160:163], v[16:19], v[64:79]
  ds_read_b128 v[16:19], v5 offset:49152
  s_waitcnt lgkmcnt(7)
  v_mfma_f32_32x32x16_bf16 v[80:95], a[164:167], v[20:23], v[80:95]
  ds_read_b128 v[20:23], v5 offset:50176
  s_waitcnt lgkmcnt(7)
  v_mfma_f32_32x32x16_bf16 v[64:79], a[168:171], v[24:27], v[64:79]
  ds_read_b128 v[24:27], v5 offset:51200
  s_waitcnt lgkmcnt(7)
  v_mfma_f32_32x32x16_bf16 v[80:95], a[172:175], v[28:31], v[80:95]
  ds_read_b128 v[28:31], v5 offset:52224
  s_waitcnt lgkmcnt(7)
  v_mfma_f32_32x32x16_bf16 v[64:79], a[176:179], v[32:35], v[64:79]
  ds_read_b128 v[32:35], v5 offset:53248
  s_waitcnt lgkmcnt(7)
  v_mfma_f32_32x32x16_bf16 v[80:95], a[180:183], v[36:39], v[80:95]
  ds_read_b128 v[36:39], v5 offset:54272
  s_waitcnt lgkmcnt(7)
  v_mfma_f32_32x32x16_bf16 v[64:79], a[184:187], v[40:43], v[64:79]
  ds_read_b128 v[40:43], v5 offset:55296
  s_waitcnt lgkmcnt(7)
  v_mfma_f32_32x32x16_bf16 v[80:95], a[188:191], v[44:47], v[80:95]
  ds_read_b128 v[44:47], v5 offset:56320
  s_waitcnt lgkmcnt(7)
  v_mfma_f32_32x32x16_bf16 v[64:79], a[192:195], v[16:19], v[64:79]
  ds_read_b128 v[16:19], v5 offset:57344
  s_waitcnt lgkmcnt(7)
  v_mfma_f32_32x32x16_bf16 v[80:95], a[196:199], v[20:23], v[80:95]
  ds_read_b128 v[20:23], v5 offset:58368
  s_waitcnt lgkmcnt(7)
  v_mfma_f32_32x32x16_bf16 v[64:79], a[200:203], v[24:27], v[64:79]
  ds_read_b128 v[24:27], v5 offset:59392
  s_waitcnt lgkmcnt(7)
  v_mfma_f32_32x32x16_bf16 v[80:95], a[204:207], v[28:31], v[80:95]
  ds_read_b128 v[28:31], v5 offset:60416
  s_waitcnt lgkmcnt(7)
  v_mfma_f32_32x32x16_bf16 v[64:79], a[208:211], v[32:35], v[64:79]
  ds_read_b128 v[32:35], v5 offset:61440
  s_waitcnt lgkmcnt(7)
  v_mfma_f32_32x32x16_bf16 v[80:95], a[212:215], v[36:39], v[80:95]
  ds_read_b128 v[36:39], v5 offset:62464
  s_max_i32 s43, s36, 0
  s_lshl_b32 s43, s43, 9
  s_add_u32 s43, s43, 196608
  buffer_load_dword v10, v9, s[4:7], s43 offen sc1
  s_waitcnt lgkmcnt(7)
  v_mfma_f32_32x32x16_bf16 v[64:79], a[216:219], v[40:43], v[64:79]
  ds_read_b128 v[40:43], v5 offset:63488
  s_waitcnt lgkmcnt(7)
  v_mfma_f32_32x32x16_bf16 v[80:95], a[220:223], v[44:47], v[80:95]
  ds_read_b128 v[44:47], v5 offset:64512
  s_waitcnt lgkmcnt(7)
  v_mfma_f32_32x32x16_bf16 v[64:79], a[224:227], v[16:19], v[64:79]
  s_waitcnt lgkmcnt(6)
  v_mfma_f32_32x32x16_bf16 v[80:95], a[228:231], v[20:23], v[80:95]
  s_waitcnt lgkmcnt(5)
  v_mfma_f32_32x32x16_bf16 v[64:79], a[232:235], v[24:27], v[64:79]
  s_waitcnt lgkmcnt(4)
  v_mfma_f32_32x32x16_bf16 v[80:95], a[236:239], v[28:31], v[80:95]
  s_add_u32 s56, s36, 1
  s_cmp_lt_u32 s56, s34
  s_cselect_b32 s56, s56, -1
  s_cmp_lt_i32 s36, 0
  s_cselect_b32 s56, -1, s56
  s_max_i32 s43, s56, 0
  s_lshl_b32 s43, s43, 9
  s_add_u32 s43, s43, 196608
  buffer_load_dword v14, v9, s[4:7], s43 offen sc1
  s_waitcnt lgkmcnt(3)
  v_mfma_f32_32x32x16_bf16 v[64:79], a[240:243], v[32:35], v[64:79]
  s_waitcnt lgkmcnt(2)
  v_mfma_f32_32x32x16_bf16 v[80:95], a[244:247], v[36:39], v[80:95]
  s_waitcnt lgkmcnt(1)
  v_mfma_f32_32x32x16_bf16 v[64:79], a[248:251], v[40:43], v[64:79]
  s_waitcnt lgkmcnt(0)
  v_mfma_f32_32x32x16_bf16 v[80:95], a[252:255], v[44:47], v[80:95]
  s_branch L_W_epi
L_W_ex:
  s_lshl_b32 s39, s36, 18
  s_add_u32 s39, s39, s49
  s_xor_b32 s42, s38, 65536
  s_add_u32 m0, s42, s48
  s_nop 0
  s_waitcnt lgkmcnt(7)
  v_mfma_f32_32x32x16_bf16 v[64:79], a[0:3], v[16:19], 0
  ds_read_b128 v[16:19], v5 offset:8192
  buffer_load_dwordx4 v6, s[4:7], s39 offen sc1 lds
  s_add_u32 m0, m0, 4096
  s_add_u32 s39, s39, 4096
  s_waitcnt lgkmcnt(7)
  v_mfma_f32_32x32x16_bf16 v[80:95], a[4:7], v[20:23], 0
  ds_read_b128 v[20:23], v5 offset:9216
  s_waitcnt lgkmcnt(7)
  v_mfma_f32_32x32x16_bf16 v[64:79], a[8:11], v[24:27], v[64:79]
  ds_read_b128 v[24:27], v5 offset:10240
  s_waitcnt lgkmcnt(7)
  v_mfma_f32_32x32x16_bf16 v[80:95], a[12:15], v[28:31], v[80:95]
  ds_read_b128 v[28:31], v5 offset:11264
  buffer_load_dwordx4 v6, s[4:7], s39 offen sc1 lds
  s_add_u32 m0, m0, 4096
  s_add_u32 s39, s39, 4096
  s_waitcnt lgkmcnt(7)
  v_mfma_f32_32x32x16_bf16 v[64:79], a[16:19], v[32:35], v[64:79]
  ds_read_b128 v[32:35], v5 offset:12288
  s_waitcnt lgkmcnt(7)
  v_mfma_f32_32x32x16_bf16 v[80:95], a[20:23], v[36:39], v[80:95]
  ds_read_b128 v[36:39], v5 offset:13312
  s_waitcnt lgkmcnt(7)
  v_mfma_f32_32x32x16_bf16 v[64:79], a[24:27], v[40:43], v[64:79]
  ds_read_b128 v[40:43], v5 offset:14336
  buffer_load_dwordx4 v6, s[4:7], s39 offen sc1 lds
  s_add_u32 m0, m0, 4096
  s_add_u32 s39, s39, 4096
  s_waitcnt lgkmcnt(7)
  v_mfma_f32_32x32x16_bf16 v[80:95], a[28:31], v[44:47], v[80:95]
  ds_read_b128 v[44:47], v5 offset:15360
  s_barrier
  s_waitcnt lgkmcnt(7)
  v_mfma_f32_32x32x16_bf16 v[64:79], a[32:35], v[16:19], v[64:79]
  ds_read_b128 v[16:19], v5 offset:16384
  s_waitcnt lgkmcnt(7)
  v_mfma_f32_32x32x16_bf16 v[80:95], a[36:39], v[20:23], v[80:95]
  ds_read_b128 v[20:23], v5 offset:17408
  buffer_load_dwordx4 v6, s[4:7], s39 offen sc1 lds
  s_add_u32 m0, m0, 4096
  s_add_u32 s39, s39, 4096
  s_waitcnt lgkmcnt(7)
  v_mfma_f32_32x32x16_bf16 v[64:79], a[40:43], v[24:27], v[64:79]
  ds_read_b128 v[24:27], v5 offset:18432
  s_waitcnt lgkmcnt(7)
  v_mfma_f32_32x32x16_bf16 v[80:95], a[44:47], v[28:31], v[80:95]
  ds_read_b128 v[28:31], v5 offset:19456
  s_waitcnt lgkmcnt(7)
  v_mfma_f32_32x32x16_bf16 v[64:79], a[48:51], v[32:35], v[64:79]
  ds_read_b128 v[32:35], v5 offset:20480
  buffer_load_dwordx4 v6, s[4:7], s39 offen sc1 lds
  s_add_u32 m0, m0, 4096
  s_add_u32 s39, s39, 4096
  s_waitcnt lgkmcnt(7)
  v_mfma_f32_32x32x16_bf16 v[80:95], a[52:55], v[36:39], v[80:95]
  ds_read_b128 v[36:39], v5 offset:21504
  s_waitcnt lgkmcnt(7)
  v_mfma_f32_32x32x16_bf16 v[64:79], a[56:59], v[40:43], v[64:79]
  ds_read_b128 v[40:43], v5 offset:22528
  s_waitcnt lgkmcnt(7)
  v_mfma_f32_32x32x16_bf16 v[80:95], a[60:63], v[44:47], v[80:95]
  ds_read_b128 v[44:47], v5 offset:23552
  buffer_load_dwordx4 v6, s[4:7], s39 offen sc1 lds
  s_add_u32 m0, m0, 4096
  s_add_u32 s39, s39, 4096
  s_waitcnt lgkmcnt(7)
  v_mfma_f32_32x32x16_bf16 v[64:79], a[64:67], v[16:19], v[64:79]
  ds_read_b128 v[16:19], v5 offset:24576
  s_waitcnt lgkmcnt(7)
  v_mfma_f32_32x32x16_bf16 v[80:95], a[68:71], v[20:23], v[80:95]
  ds_read_b128 v[20:23], v5 offset:25600
  s_waitcnt lgkmcnt(7)
  v_mfma_f32_32x32x16_bf16 v[64:79], a[72:75], v[24:27], v[64:79]
  ds_read_b128 v[24:27], v5 offset:26624
  buffer_load_dwordx4 v6, s[4:7], s39 offen sc1 lds
  s_add_u32 m0, m0, 4096
  s_add_u32 s39, s39, 4096
  s_waitcnt lgkmcnt(7)
  v_mfma_f32_32x32x16_bf16 v[80:95], a[76:79], v[28:31], v[80:95]
  ds_read_b128 v[28:31], v5 offset:27648
  s_waitcnt lgkmcnt(7)
  v_mfma_f32_32x32x16_bf16 v[64:79], a[80:83], v[32:35], v[64:79]
  ds_read_b128 v[32:35], v5 offset:28672
  s_waitcnt lgkmcnt(7)
  v_mfma_f32_32x32x16_bf16 v[80:95], a[84:87], v[36:39], v[80:95]
  ds_read_b128 v[36:39], v5 offset:29696
  buffer_load_dwordx4 v6, s[4:7], s39 offen sc1 lds
  s_add_u32 m0, m0, 4096
  s_add_u32 s39, s39, 4096
  s_waitcnt lgkmcnt(7)
  v_mfma_f32_32x32x16_bf16 v[64:79], a[88:91], v[40:43], v[64:79]
  ds_read_b128 v[40:43], v5 offset:30720
  s_waitcnt lgkmcnt(7)
  v_mfma_f32_32x32x16_bf16 v[80:95], a[92:95], v[44:47], v[80:95]
  ds_read_b128 v[44:47], v5 offset:31744
  s_barrier
  s_waitcnt lgkmcnt(7)
  v_mfma_f32_32x32x16_bf16 v[64:79], a[96:99], v[16:19], v[64:79]
  ds_read_b128 v[16:19], v5 offset:32768
  buffer_load_dwordx4 v6, s[4:7], s39 offen sc1 lds
  s_add_u32 m0, m0, 4096
  s_add_u32 s39, s39, 4096
  s_waitcnt lgkmcnt(7)
  v_mfma_f32_32x32x16_bf16 v[80:95], a[100:103], v[20:23], v[80:95]
  ds_read_b128 v[20:23], v5 offset:33792
  s_waitcnt lgkmcnt(7)
  v_mfma_f32_32x32x16_bf16 v[64:79], a[104:107], v[24:27], v[64:79]
  ds_read_b128 v[24:27], v5 offset:34816
  s_waitcnt lgkmcnt(7)
  v_mfma_f32_32x32x16_bf16 v[80:95], a[108:111], v[28:31], v[80:95]
  ds_read_b128 v[28:31], v5 offset:35840
  buffer_load_dwordx4 v6, s[4:7], s39 offen sc1 lds
  s_add_u32 m0, m0, 4096
  s_add_u32 s39, s39, 4096
  s_waitcnt lgkmcnt(7)
  v_mfma_f32_32x32x16_bf16 v[64:79], a[112:115], v[32:35], v[64:79]
  ds_read_b128 v[32:35], v5 offset:36864
  s_waitcnt lgkmcnt(7)
  v_mfma_f32_32x32x16_bf16 v[80:95], a[116:119], v[36:39], v[80:95]
  ds_read_b128 v[36:39], v5 offset:37888
  s_waitcnt lgkmcnt(7)
  v_mfma_f32_32x32x16_bf16 v[64:79], a[120:123], v[40:43], v[64:79]
  ds_read_b128 v[40:43], v5 offset:38912
  buffer_load_dwordx4 v6, s[4:7], s39 offen sc1 lds
  s_add_u32 m0, m0, 4096
  s_add_u32 s39, s39, 4096
  s_waitcnt lgkmcnt(7)
  v_mfma_f32_32x32x16_bf16 v[80:95], a[124:127], v[44:47], v[80:95]
  ds_read_b128 v[44:47], v5 offset:39936
  s_waitcnt vmcnt(11)
  s_mov_b64 exec, 1
  buffer_store_dword v4, v3, s[4:7], s58 offen sc1
  s_mov_b64 exec, -1
  s_waitcnt lgkmcnt(7)
  v_mfma_f32_32x32x16_bf16 v[64:79], a[128:131], v[16:19], v[64:79]
  ds_read_b128 v[16:19], v5 offset:40960
  s_waitcnt lgkmcnt(7)
  v_mfma_f32_32x32x16_bf16 v[80:95], a[132:135], v[20:23], v[80:95]
  ds_read_b128 v[20:23], v5 offset:41984
  buffer_load_dwordx4 v6, s[4:7], s39 offen sc1 lds
  s_add_u32 m0, m0, 4096
  s_add_u32 s39, s39, 4096
  s_waitcnt lgkmcnt(7)
  v_mfma_f32_32x32x16_bf16 v[64:79], a[136:139], v[24:27], v[64:79]
  ds_read_b128 v[24:27], v5 offset:43008
  s_waitcnt lgkmcnt(7)
  v_mfma_f32_32x32x16_bf16 v[80:95], a[140:143], v[28:31], v[80:95]
  ds_read_b128 v[28:31], v5 offset:44032
  s_waitcnt lgkmcnt(7)
  v_mfma_f32_32x32x16_bf16 v[64:79], a[144:147], v[32:35], v[64:79]
  ds_read_b128 v[32:35], v5 offset:45056
  buffer_load_dwordx4 v6, s[4:7], s39 offen sc1 lds
  s_add_u32 m0, m0, 4096
  s_add_u32 s39, s39, 4096
  s_waitcnt lgkmcnt(7)
  v_mfma_f32_32x32x16_bf16 v[80:95], a[148:151], v[36:39], v[80:95]
  ds_read_b128 v[36:39], v5 offset:46080
  s_waitcnt lgkmcnt(7)
  v_mfma_f32_32x32x16_bf16 v[64:79], a[152:155], v[40:43], v[64:79]
  ds_read_b128 v[40:43], v5 offset:47104
  s_waitcnt lgkmcnt(7)
  v_mfma_f32_32x32x16_bf16 v[80:95], a[156:159], v[44:47], v[80:95]
  ds_read_b128 v[44:47], v5 offset:48128
  buffer_load_dwordx4 v6, s[4:7], s39 offen sc1 lds
  s_add_u32 m0, m0, 4096
  s_add_u32 s39, s39, 4096
  s_barrier
  s_waitcnt lgkmcnt(7)
  v_mfma_f32_32x32x16_bf16 v[64:79], a[160:163], v[16:19], v[64:79]
  ds_read_b128 v[16:19], v5 offset:49152
  s_waitcnt lgkmcnt(7)
  v_mfma_f32_32x32x16_bf16 v[80:95], a[164:167], v[20:23], v[80:95]
  ds_read_b128 v[20:23], v5 offset:50176
  s_waitcnt lgkmcnt(7)
  v_mfma_f32_32x32x16_bf16 v[64:79], a[168:171], v[24:27], v[64:79]
  ds_read_b128 v[24:27], v5 offset:51200
  buffer_load_dwordx4 v6, s[4:7], s39 offen sc1 lds
  s_add_u32 m0, m0, 4096
  s_add_u32 s39, s39, 4096
  s_waitcnt lgkmcnt(7)
  v_mfma_f32_32x32x16_bf16 v[80:95], a[172:175], v[28:31], v[80:95]
  ds_read_b128 v[28:31], v5 offset:52224
  s_waitcnt lgkmcnt(7)
  v_mfma_f32_32x32x16_bf16 v[64:79], a[176:179], v[32:35], v[64:79]
  ds_read_b128 v[32:35], v5 offset:53248
  s_waitcnt lgkmcnt(7)
  v_mfma_f32_32x32x16_bf16 v[80:95], a[180:183], v[36:39], v[80:95]
  ds_read_b128 v[36:39], v5 offset:54272
  buffer_load_dwordx4 v6, s[4:7], s39 offen sc1 lds
  s_add_u32 m0, m0, 4096
  s_add_u32 s39, s39, 4096
  s_waitcnt lgkmcnt(7)
  v_mfma_f32_32x32x16_bf16 v[64:79], a[184:187], v[40:43], v[64:79]
  ds_read_b128 v[40:43], v5 offset:55296
  s_waitcnt lgkmcnt(7)
  v_mfma_f32_32x32x16_bf16 v[80:95], a[188:191], v[44:47], v[80:95]
  ds_read_b128 v[44:47], v5 offset:56320
  s_waitcnt lgkmcnt(7)
  v_mfma_f32_32x32x16_bf16 v[64:79], a[192:195], v[16:19], v[64:79]
  ds_read_b128 v[16:19], v5 offset:57344
  s_waitcnt lgkmcnt(7)
  v_mfma_f32_32x32x16_bf16 v[80:95], a[196:199], v[20:23], v[80:95]
  ds_read_b128 v[20:23], v5 offset:58368
  s_waitcnt lgkmcnt(7)
  v_mfma_f32_32x32x16_bf16 v[64:79], a[200:203], v[24:27], v[64:79]
  ds_read_b128 v[24:27], v5 offset:59392
  s_waitcnt lgkmcnt(7)
  v_mfma_f32_32x32x16_bf16 v[80:95], a[204:207], v[28:31], v[80:95]
  ds_read_b128 v[28:31], v5 offset:60416
  s_waitcnt lgkmcnt(7)
  v_mfma_f32_32x32x16_bf16 v[64:79], a[208:211], v[32:35], v[64:79]
  ds_read_b128 v[32:35], v5 offset:61440
  s_waitcnt lgkmcnt(7)
  v_mfma_f32_32x32x16_bf16 v[80:95], a[212:215], v[36:39], v[80:95]
  ds_read_b128 v[36:39], v5 offset:62464
  s_waitcnt lgkmcnt(7)
  v_mfma_f32_32x32x16_bf16 v[64:79], a[216:219], v[40:43], v[64:79]
  ds_read_b128 v[40:43], v5 offset:63488
  s_waitcnt lgkmcnt(7)
  v_mfma_f32_32x32x16_bf16 v[80:95], a[220:223], v[44:47], v[80:95]
  ds_read_b128 v[44:47], v5 offset:64512
  s_waitcnt lgkmcnt(7)
  v_mfma_f32_32x32x16_bf16 v[64:79], a[224:227], v[16:19], v[64:79]
  s_waitcnt lgkmcnt(6)
  v_mfma_f32_32x32x16_bf16 v[80:95], a[228:231], v[20:23], v[80:95]
  s_waitcnt lgkmcnt(5)
  v_mfma_f32_32x32x16_bf16 v[64:79], a[232:235], v[24:27], v[64:79]
  s_waitcnt lgkmcnt(4)
  v_mfma_f32_32x32x16_bf16 v[80:95], a[236:239], v[28:31], v[80:95]
  s_add_u32 s56, s36, 1
  s_cmp_lt_u32 s56, s34
  s_cselect_b32 s56, s56, -1
  s_cmp_lt_i32 s36, 0
  s_cselect_b32 s56, -1, s56
  s_max_i32 s43, s56, 0
  s_lshl_b32 s43, s43, 9
  s_add_u32 s43, s43, 196608
  buffer_load_dword v14, v9, s[4:7], s43 offen sc1
  s_waitcnt lgkmcnt(3)
  v_mfma_f32_32x32x16_bf16 v[64:79], a[240:243], v[32:35], v[64:79]
  s_waitcnt lgkmcnt(2)
  v_mfma_f32_32x32x16_bf16 v[80:95], a[244:247], v[36:39], v[80:95]
  s_waitcnt lgkmcnt(1)
  v_mfma_f32_32x32x16_bf16 v[64:79], a[248:251], v[40:43], v[64:79]
  s_waitcnt lgkmcnt(0)
  v_mfma_f32_32x32x16_bf16 v[80:95], a[252:255], v[44:47], v[80:95]
L_W_epi:
  s_nop 11
  v_pk_add_f32 v[64:65], v[64:65], v[80:81]
  v_pk_add_f32 v[66:67], v[66:67], v[82:83]
  v_pk_add_f32 v[68:69], v[68:69], v[84:85]
  v_pk_add_f32 v[70:71], v[70:71], v[86:87]
  v_pk_add_f32 v[72:73], v[72:73], v[88:89]
  v_pk_add_f32 v[74:75], v[74:75], v[90:91]
  v_pk_add_f32 v[76:77], v[76:77], v[92:93]
  v_pk_add_f32 v[78:79], v[78:79], v[94:95]
  v_cvt_pk_bf16_f32 v48, v64, v65
  v_cvt_pk_bf16_f32 v49, v66, v67
  v_cvt_pk_bf16_f32 v50, v68, v69
  v_cvt_pk_bf16_f32 v51, v70, v71
  v_cvt_pk_bf16_f32 v52, v72, v73
  v_cvt_pk_bf16_f32 v53, v74, v75
  v_cvt_pk_bf16_f32 v54, v76, v77
  v_cvt_pk_bf16_f32 v55, v78, v79
  s_lshl_b32 s39, s35, 17
  s_add_u32 s39, s39, s51
  buffer_store_dwordx4 v[48:51], v2, s[4:7], s39 offen offset:0 sc1
  buffer_store_dwordx4 v[52:55], v2, s[4:7], s39 offen offset:1024 sc1
  s_lshl_b32 s58, s35, 9
  s_add_u32 s58, s58, 262144
  s_add_u32 s58, s58, s52
  s_mov_b32 s54, s35
  s_mov_b32 s35, s36
  s_mov_b32 s36, s56
  s_mov_b32 s57, 0
  s_xor_b32 s38, s38, 65536
  v_xor_b32 v5, 65536, v5
  s_waitcnt vmcnt(2)
  s_cmp_eq_u32 s37, 1
  s_cbranch_scc1 L_W_top
  s_cmp_lt_i32 s35, 0
  s_cbranch_scc1 L_W_w
  v_cmp_eq_u32 vcc, 0, v10
  s_cbranch_vccz L_W_g2
L_W_w:
  s_max_i32 s43, s35, 0
  s_lshl_b32 s43, s43, 9
  s_add_u32 s43, s43, 196608
  buffer_load_dword v10, v9, s[4:7], s43 offen sc1
  s_waitcnt vmcnt(0)
  s_cmp_lt_i32 s35, 0
  s_cbranch_scc1 L_W_w2
  s_mov_b32 s57, 1
  v_cmp_eq_u32 vcc, 0, v10
  s_cbranch_vccz L_W_g2
L_W_w2:
  s_mov_b64 exec, 1
  buffer_store_dword v4, v3, s[4:7], s58 offen sc1
  s_mov_b64 exec, -1
  s_mov_b32 s58, 0
  s_mov_b32 s57, 0
  s_cmp_lt_i32 s35, 0
  s_cbranch_scc0 L_W_get
  s_endpgm
J_FA:
  s_load_dwordx2 s[12:13], s[0:1], 64
  s_mov_b32 s14, 1409024
  s_mov_b32 s15, 0x20000
  s_load_dwordx2 s[16:17], s[0:1], 72
  s_mov_b32 s18, 1409024
  s_mov_b32 s19, 0x20000
  s_sub_u32 s49, s46, 8
  s_lshl_b32 s41, s49, 8
  s_cmp_eq_u32 s49, 10
  s_cselect_b32 s43, 11, 15
  s_lshl_b32 s40, s28, 6
  v_lshrrev_b32 v11, 4, v1
  v_add_u32 v11, s40, v11
  s_mov_b32 s40, 2752
  v_mul_lo_u32 v11, v11, s40
  v_and_b32 v10, 15, v1
  v_min_u32 v10, s43, v10
  v_lshl_add_u32 v11, v10, 4, v11
  v_add_u32 v11, s41, v11
  s_lshl_b32 s40, s28, 6
  v_bfe_u32 v12, v1, 5, 1
  v_lshlrev_b32 v12, 10, v12
  v_bfe_u32 v10, v1, 2, 2
  v_lshl_add_u32 v12, v10, 8, v12
  v_bfe_u32 v10, v1, 4, 1
  v_lshl_add_u32 v12, v10, 5, v12
  v_bfe_u32 v10, v1, 0, 2
  v_lshl_add_u32 v12, v10, 3, v12
  v_add_u32 v12, s40, v12
  v_add_u32 v13, 0x10000, v12
  s_waitcnt lgkmcnt(0)
  s_lshl_b32 s42, s28, 14
  s_add_u32 s42, s42, 0
  s_add_u32 m0, s42, 0
  s_mov_b32 s43, 0
  buffer_load_dwordx4 v11, s[12:15], s43 offen lds
  s_add_u32 m0, s42, 1024
  s_mov_b32 s43, 11008
  buffer_load_dwordx4 v11, s[12:15], s43 offen lds
  s_add_u32 m0, s42, 2048
  s_mov_b32 s43, 22016
  buffer_load_dwordx4 v11, s[12:15], s43 offen lds
  s_add_u32 m0, s42, 3072
  s_mov_b32 s43, 33024
  buffer_load_dwordx4 v11, s[12:15], s43 offen lds
  s_add_u32 m0, s42, 4096
  s_mov_b32 s43, 44032
  buffer_load_dwordx4 v11, s[12:15], s43 offen lds
  s_add_u32 m0, s42, 5120
  s_mov_b32 s43, 55040
  buffer_load_dwordx4 v11, s[12:15], s43 offen lds
  s_add_u32 m0, s42, 6144
  s_mov_b32 s43, 66048
  buffer_load_dwordx4 v11, s[12:15], s43 offen lds
  s_add_u32 m0, s42, 7168
  s_mov_b32 s43, 77056
  buffer_load_dwordx4 v11, s[12:15], s43 offen lds
  s_add_u32 m0, s42, 8192
  s_mov_b32 s43, 88064
  buffer_load_dwordx4 v11, s[12:15], s43 offen lds
  s_add_u32 m0, s42, 9216
  s_mov_b32 s43, 99072
  buffer_load_dwordx4 v11, s[12:15], s43 offen lds
  s_add_u32 m0, s42, 10240
  s_mov_b32 s43, 110080
  buffer_load_dwordx4 v11, s[12:15], s43 offen lds
  s_add_u32 m0, s42, 11264
  s_mov_b32 s43, 121088
  buffer_load_dwordx4 v11, s[12:15], s43 offen lds
  s_add_u32 m0, s42, 12288
  s_mov_b32 s43, 132096
  buffer_load_dwordx4 v11, s[12:15], s43 offen lds
  s_add_u32 m0, s42, 13312
  s_mov_b32 s43, 143104
  buffer_load_dwordx4 v11, s[12:15], s43 offen lds
  s_add_u32 m0, s42, 14336
  s_mov_b32 s43, 154112
  buffer_load_dwordx4 v11, s[12:15], s43 offen lds
  s_add_u32 m0, s42, 15360
  s_mov_b32 s43, 165120
  buffer_load_dwordx4 v11, s[12:15], s43 offen lds
  s_lshl_b32 s42, s28, 14
  s_add_u32 s42, s42, 65536
  s_add_u32 m0, s42, 0
  s_mov_b32 s43, 704512
  buffer_load_dwordx4 v11, s[12:15], s43 offen lds
  s_add_u32 m0, s42, 1024
  s_mov_b32 s43, 715520
  buffer_load_dwordx4 v11, s[12:15], s43 offen lds
  s_add_u32 m0, s42, 2048
  s_mov_b32 s43, 726528
  buffer_load_dwordx4 v11, s[12:15], s43 offen lds
  s_add_u32 m0, s42, 3072
  s_mov_b32 s43, 737536
  buffer_load_dwordx4 v11, s[12:15], s43 offen lds
  s_add_u32 m0, s42, 4096
  s_mov_b32 s43, 748544
  buffer_load_dwordx4 v11, s[12:15], s43 offen lds
  s_add_u32 m0, s42, 5120
  s_mov_b32 s43, 759552
  buffer_load_dwordx4 v11, s[12:15], s43 offen lds
  s_add_u32 m0, s42, 6144
  s_mov_b32 s43, 770560
  buffer_load_dwordx4 v11, s[12:15], s43 offen lds
  s_add_u32 m0, s42, 7168
  s_mov_b32 s43, 781568
  buffer_load_dwordx4 v11, s[12:15], s43 offen lds
  s_add_u32 m0, s42, 8192
  s_mov_b32 s43, 792576
  buffer_load_dwordx4 v11, s[12:15], s43 offen lds
  s_add_u32 m0, s42, 9216
  s_mov_b32 s43, 803584
  buffer_load_dwordx4 v11, s[12:15], s43 offen lds
  s_add_u32 m0, s42, 10240
  s_mov_b32 s43, 814592
  buffer_load_dwordx4 v11, s[12:15], s43 offen lds
  s_add_u32 m0, s42, 11264
  s_mov_b32 s43, 825600
  buffer_load_dwordx4 v11, s[12:15], s43 offen lds
  s_add_u32 m0, s42, 12288
  s_mov_b32 s43, 836608
  buffer_load_dwordx4 v11, s[12:15], s43 offen lds
  s_add_u32 m0, s42, 13312
  s_mov_b32 s43, 847616
  buffer_load_dwordx4 v11, s[12:15], s43 offen lds
  s_add_u32 m0, s42, 14336
  s_mov_b32 s43, 858624
  buffer_load_dwordx4 v11, s[12:15], s43 offen lds
  s_add_u32 m0, s42, 15360
  s_mov_b32 s43, 869632
  buffer_load_dwordx4 v11, s[12:15], s43 offen lds
  s_waitcnt vmcnt(32)
  s_barrier
  s_lshl_b32 s40, s31, 2
  s_cmp_lg_u32 s28, 0
  s_cbranch_scc1 ar_21
  s_mov_b64 exec, 1
  buffer_atomic_add v9, v3, s[8:11], s40 offen sc1
  s_mov_b64 exec, -1
ar_21:
  s_waitcnt vmcnt(16)
  s_barrier
  ds_read_b64_tr_b16 a[0:1], v12 offset:0
  ds_read_b64_tr_b16 a[2:3], v12 offset:2048
  ds_read_b64_tr_b16 a[4:5], v12 offset:4096
  ds_read_b64_tr_b16 a[6:7], v12 offset:6144
  ds_read_b64_tr_b16 a[8:9], v12 offset:8192
  ds_read_b64_tr_b16 a[10:11], v12 offset:10240
  ds_read_b64_tr_b16 a[12:13], v12 offset:12288
  ds_read_b64_tr_b16 a[14:15], v12 offset:14336
  ds_read_b64_tr_b16 a[16:17], v12 offset:16384
  ds_read_b64_tr_b16 a[18:19], v12 offset:18432
  ds_read_b64_tr_b16 a[20:21], v12 offset:20480
  ds_read_b64_tr_b16 a[22:23], v12 offset:22528
  ds_read_b64_tr_b16 a[24:25], v12 offset:24576
  ds_read_b64_tr_b16 a[26:27], v12 offset:26624
  ds_read_b64_tr_b16 a[28:29], v12 offset:28672
  ds_read_b64_tr_b16 a[30:31], v12 offset:30720
  ds_read_b64_tr_b16 a[32:33], v12 offset:32768
  ds_read_b64_tr_b16 a[34:35], v12 offset:34816
  ds_read_b64_tr_b16 a[36:37], v12 offset:36864
  ds_read_b64_tr_b16 a[38:39], v12 offset:38912
  ds_read_b64_tr_b16 a[40:41], v12 offset:40960
  ds_read_b64_tr_b16 a[42:43], v12 offset:43008
  ds_read_b64_tr_b16 a[44:45], v12 offset:45056
  ds_read_b64_tr_b16 a[46:47], v12 offset:47104
  ds_read_b64_tr_b16 a[48:49], v12 offset:49152
  ds_read_b64_tr_b16 a[50:51], v12 offset:51200
  ds_read_b64_tr_b16 a[52:53], v12 offset:53248
  ds_read_b64_tr_b16 a[54:55], v12 offset:55296
  ds_read_b64_tr_b16 a[56:57], v12 offset:57344
  ds_read_b64_tr_b16 a[58:59], v12 offset:59392
  ds_read_b64_tr_b16 a[60:61], v12 offset:61440
  ds_read_b64_tr_b16 a[62:63], v12 offset:63488
  s_waitcnt lgkmcnt(0)
  s_barrier
  s_lshl_b32 s42, s28, 14
  s_add_u32 s42, s42, 0
  s_add_u32 m0, s42, 0
  s_mov_b32 s43, 0
  buffer_load_dwordx4 v11, s[16:19], s43 offen lds
  s_add_u32 m0, s42, 1024
  s_mov_b32 s43, 11008
  buffer_load_dwordx4 v11, s[16:19], s43 offen lds
  s_add_u32 m0, s42, 2048
  s_mov_b32 s43, 22016
  buffer_load_dwordx4 v11, s[16:19], s43 offen lds
  s_add_u32 m0, s42, 3072
  s_mov_b32 s43, 33024
  buffer_load_dwordx4 v11, s[16:19], s43 offen lds
  s_add_u32 m0, s42, 4096
  s_mov_b32 s43, 44032
  buffer_load_dwordx4 v11, s[16:19], s43 offen lds
  s_add_u32 m0, s42, 5120
  s_mov_b32 s43, 55040
  buffer_load_dwordx4 v11, s[16:19], s43 offen lds
  s_add_u32 m0, s42, 6144
  s_mov_b32 s43, 66048
  buffer_load_dwordx4 v11, s[16:19], s43 offen lds
  s_add_u32 m0, s42, 7168
  s_mov_b32 s43, 77056
  buffer_load_dwordx4 v11, s[16:19], s43 offen lds
  s_add_u32 m0, s42, 8192
  s_mov_b32 s43, 88064
  buffer_load_dwordx4 v11, s[16:19], s43 offen lds
  s_add_u32 m0, s42, 9216
  s_mov_b32 s43, 99072
  buffer_load_dwordx4 v11, s[16:19], s43 offen lds
  s_add_u32 m0, s42, 10240
  s_mov_b32 s43, 110080
  buffer_load_dwordx4 v11, s[16:19], s43 offen lds
  s_add_u32 m0, s42, 11264
  s_mov_b32 s43, 121088
  buffer_load_dwordx4 v11, s[16:19], s43 offen lds
  s_add_u32 m0, s42, 12288
  s_mov_b32 s43, 132096
  buffer_load_dwordx4 v11, s[16:19], s43 offen lds
  s_add_u32 m0, s42, 13312
  s_mov_b32 s43, 143104
  buffer_load_dwordx4 v11, s[16:19], s43 offen lds
  s_add_u32 m0, s42, 14336
  s_mov_b32 s43, 154112
  buffer_load_dwordx4 v11, s[16:19], s43 offen lds
  s_add_u32 m0, s42, 15360
  s_mov_b32 s43, 165120
  buffer_load_dwordx4 v11, s[16:19], s43 offen lds
  s_waitcnt vmcnt(16)
  s_barrier
  ds_read_b64_tr_b16 a[64:65], v13 offset:0
  ds_read_b64_tr_b16 a[66:67], v13 offset:2048
  ds_read_b64_tr_b16 a[68:69], v13 offset:4096
  ds_read_b64_tr_b16 a[70:71], v13 offset:6144
  ds_read_b64_tr_b16 a[72:73], v13 offset:8192
  ds_read_b64_tr_b16 a[74:75], v13 offset:10240
  ds_read_b64_tr_b16 a[76:77], v13 offset:12288
  ds_read_b64_tr_b16 a[78:79], v13 offset:14336
  ds_read_b64_tr_b16 a[80:81], v13 offset:16384
  ds_read_b64_tr_b16 a[82:83], v13 offset:18432
  ds_read_b64_tr_b16 a[84:85], v13 offset:20480
  ds_read_b64_tr_b16 a[86:87], v13 offset:22528
  ds_read_b64_tr_b16 a[88:89], v13 offset:24576
  ds_read_b64_tr_b16 a[90:91], v13 offset:26624
  ds_read_b64_tr_b16 a[92:93], v13 offset:28672
  ds_read_b64_tr_b16 a[94:95], v13 offset:30720
  ds_read_b64_tr_b16 a[96:97], v13 offset:32768
  ds_read_b64_tr_b16 a[98:99], v13 offset:34816
  ds_read_b64_tr_b16 a[100:101], v13 offset:36864
  ds_read_b64_tr_b16 a[102:103], v13 offset:38912
  ds_read_b64_tr_b16 a[104:105], v13 offset:40960
  ds_read_b64_tr_b16 a[106:107], v13 offset:43008
  ds_read_b64_tr_b16 a[108:109], v13 offset:45056
  ds_read_b64_tr_b16 a[110:111], v13 offset:47104
  ds_read_b64_tr_b16 a[112:113], v13 offset:49152
  ds_read_b64_tr_b16 a[114:115], v13 offset:51200
  ds_read_b64_tr_b16 a[116:117], v13 offset:53248
  ds_read_b64_tr_b16 a[118:119], v13 offset:55296
  ds_read_b64_tr_b16 a[120:121], v13 offset:57344
  ds_read_b64_tr_b16 a[122:123], v13 offset:59392
  ds_read_b64_tr_b16 a[124:125], v13 offset:61440
  ds_read_b64_tr_b16 a[126:127], v13 offset:63488
  s_waitcnt lgkmcnt(0)
  s_barrier
  s_lshl_b32 s42, s28, 14
  s_add_u32 s42, s42, 65536
  s_add_u32 m0, s42, 0
  s_mov_b32 s43, 704512
  buffer_load_dwordx4 v11, s[16:19], s43 offen lds
  s_add_u32 m0, s42, 1024
  s_mov_b32 s43, 715520
  buffer_load_dwordx4 v11, s[16:19], s43 offen lds
  s_add_u32 m0, s42, 2048
  s_mov_b32 s43, 726528
  buffer_load_dwordx4 v11, s[16:19], s43 offen lds
  s_add_u32 m0, s42, 3072
  s_mov_b32 s43, 737536
  buffer_load_dwordx4 v11, s[16:19], s43 offen lds
  s_add_u32 m0, s42, 4096
  s_mov_b32 s43, 748544
  buffer_load_dwordx4 v11, s[16:19], s43 offen lds
  s_add_u32 m0, s42, 5120
  s_mov_b32 s43, 759552
  buffer_load_dwordx4 v11, s[16:19], s43 offen lds
  s_add_u32 m0, s42, 6144
  s_mov_b32 s43, 770560
  buffer_load_dwordx4 v11, s[16:19], s43 offen lds
  s_add_u32 m0, s42, 7168
  s_mov_b32 s43, 781568
  buffer_load_dwordx4 v11, s[16:19], s43 offen lds
  s_add_u32 m0, s42, 8192
  s_mov_b32 s43, 792576
  buffer_load_dwordx4 v11, s[16:19], s43 offen lds
  s_add_u32 m0, s42, 9216
  s_mov_b32 s43, 803584
  buffer_load_dwordx4 v11, s[16:19], s43 offen lds
  s_add_u32 m0, s42, 10240
  s_mov_b32 s43, 814592
  buffer_load_dwordx4 v11, s[16:19], s43 offen lds
  s_add_u32 m0, s42, 11264
  s_mov_b32 s43, 825600
  buffer_load_dwordx4 v11, s[16:19], s43 offen lds
  s_add_u32 m0, s42, 12288
  s_mov_b32 s43, 836608
  buffer_load_dwordx4 v11, s[16:19], s43 offen lds
  s_add_u32 m0, s42, 13312
  s_mov_b32 s43, 847616
  buffer_load_dwordx4 v11, s[16:19], s43 offen lds
  s_add_u32 m0, s42, 14336
  s_mov_b32 s43, 858624
  buffer_load_dwordx4 v11, s[16:19], s43 offen lds
  s_add_u32 m0, s42, 15360
  s_mov_b32 s43, 869632
  buffer_load_dwordx4 v11, s[16:19], s43 offen lds
  s_waitcnt vmcnt(16)
  s_barrier
  ds_read_b64_tr_b16 a[128:129], v12 offset:0
  ds_read_b64_tr_b16 a[130:131], v12 offset:2048
  ds_read_b64_tr_b16 a[132:133], v12 offset:4096
  ds_read_b64_tr_b16 a[134:135], v12 offset:6144
  ds_read_b64_tr_b16 a[136:137], v12 offset:8192
  ds_read_b64_tr_b16 a[138:139], v12 offset:10240
  ds_read_b64_tr_b16 a[140:141], v12 offset:12288
  ds_read_b64_tr_b16 a[142:143], v12 offset:14336
  ds_read_b64_tr_b16 a[144:145], v12 offset:16384
  ds_read_b64_tr_b16 a[146:147], v12 offset:18432
  ds_read_b64_tr_b16 a[148:149], v12 offset:20480
  ds_read_b64_tr_b16 a[150:151], v12 offset:22528
  ds_read_b64_tr_b16 a[152:153], v12 offset:24576
  ds_read_b64_tr_b16 a[154:155], v12 offset:26624
  ds_read_b64_tr_b16 a[156:157], v12 offset:28672
  ds_read_b64_tr_b16 a[158:159], v12 offset:30720
  ds_read_b64_tr_b16 a[160:161], v12 offset:32768
  ds_read_b64_tr_b16 a[162:163], v12 offset:34816
  ds_read_b64_tr_b16 a[164:165], v12 offset:36864
  ds_read_b64_tr_b16 a[166:167], v12 offset:38912
  ds_read_b64_tr_b16 a[168:169], v12 offset:40960
  ds_read_b64_tr_b16 a[170:171], v12 offset:43008
  ds_read_b64_tr_b16 a[172:173], v12 offset:45056
  ds_read_b64_tr_b16 a[174:175], v12 offset:47104
  ds_read_b64_tr_b16 a[176:177], v12 offset:49152
  ds_read_b64_tr_b16 a[178:179], v12 offset:51200
  ds_read_b64_tr_b16 a[180:181], v12 offset:53248
  ds_read_b64_tr_b16 a[182:183], v12 offset:55296
  ds_read_b64_tr_b16 a[184:185], v12 offset:57344
  ds_read_b64_tr_b16 a[186:187], v12 offset:59392
  ds_read_b64_tr_b16 a[188:189], v12 offset:61440
  ds_read_b64_tr_b16 a[190:191], v12 offset:63488
  s_waitcnt lgkmcnt(0)
  s_barrier
  s_waitcnt vmcnt(0)
  s_barrier
  ds_read_b64_tr_b16 a[192:193], v13 offset:0
  ds_read_b64_tr_b16 a[194:195], v13 offset:2048
  ds_read_b64_tr_b16 a[196:197], v13 offset:4096
  ds_read_b64_tr_b16 a[198:199], v13 offset:6144
  ds_read_b64_tr_b16 a[200:201], v13 offset:8192
  ds_read_b64_tr_b16 a[202:203], v13 offset:10240
  ds_read_b64_tr_b16 a[204:205], v13 offset:12288
  ds_read_b64_tr_b16 a[206:207], v13 offset:14336
  ds_read_b64_tr_b16 a[208:209], v13 offset:16384
  ds_read_b64_tr_b16 a[210:211], v13 offset:18432
  ds_read_b64_tr_b16 a[212:213], v13 offset:20480
  ds_read_b64_tr_b16 a[214:215], v13 offset:22528
  ds_read_b64_tr_b16 a[216:217], v13 offset:24576
  ds_read_b64_tr_b16 a[218:219], v13 offset:26624
  ds_read_b64_tr_b16 a[220:221], v13 offset:28672
  ds_read_b64_tr_b16 a[222:223], v13 offset:30720
  ds_read_b64_tr_b16 a[224:225], v13 offset:32768
  ds_read_b64_tr_b16 a[226:227], v13 offset:34816
  ds_read_b64_tr_b16 a[228:229], v13 offset:36864
  ds_read_b64_tr_b16 a[230:231], v13 offset:38912
  ds_read_b64_tr_b16 a[232:233], v13 offset:40960
  ds_read_b64_tr_b16 a[234:235], v13 offset:43008
  ds_read_b64_tr_b16 a[236:237], v13 offset:45056
  ds_read_b64_tr_b16 a[238:239], v13 offset:47104
  ds_read_b64_tr_b16 a[240:241], v13 offset:49152
  ds_read_b64_tr_b16 a[242:243], v13 offset:51200
  ds_read_b64_tr_b16 a[244:245], v13 offset:53248
  ds_read_b64_tr_b16 a[246:247], v13 offset:55296
  ds_read_b64_tr_b16 a[248:249], v13 offset:57344
  ds_read_b64_tr_b16 a[250:251], v13 offset:59392
  ds_read_b64_tr_b16 a[252:253], v13 offset:61440
  ds_read_b64_tr_b16 a[254:255], v13 offset:63488
  s_waitcnt lgkmcnt(0)
  s_barrier
  v_and_b32 v11, 7, v1
  v_lshlrev_b32 v11, 2, v11
  s_mov_b32 s42, 0
vf_22:
  buffer_load_dword v10, v11, s[8:11], 0 offen sc0 sc1
  s_add_u32 s42, s42, 1
  s_waitcnt vmcnt(0)
  v_readlane_b32 s43, v10, s31
  v_lshrrev_b32 v10, 22, v10
  v_cmp_ne_u32 vcc, 32, v10
  s_cbranch_vccz vk_23
  s_movk_i32 s41, 1
  s_cmp_gt_u32 s42, 262144
  s_cbranch_scc1 L_fail
  s_sleep 2
  s_branch vf_22
vk_23:
  s_and_b32 s40, s43, 0x1ff
  s_mul_i32 s40, s40, s40
  s_bfe_u32 s41, s43, 0xd0009
  s_lshl_b32 s41, s41, 5
  s_cmp_eq_u32 s40, s41
  s_cselect_b32 s47, 1, 0
  v_bfe_u32 v9, v1, 0, 4
  v_lshlrev_b32 v9, 2, v9
  s_lshl_b32 s49, s49, 2
  s_add_u32 s49, s49, s28
  s_lshl_b32 s52, s49, 2
  s_lshl_b32 s51, s49, 11
  s_add_u32 s51, s51, 52428800
  v_bfe_u32 v8, v1, 0, 4
  v_lshlrev_b32 v8, 7, v8
  s_max_i32 s40, s35, 0
  s_mul_i32 s40, s40, 98304
  s_add_u32 s40, s40, s51
  buffer_load_dword v15, v8, s[4:7], s40 offen
  s_lshl_b32 s48, s28, 10
  v_add_u32 v6, s48, v2
  v_mov_b32 v5, v2
  v_add_u32 v7, 0x10000, v2
  s_mov_b32 s38, 0
  s_add_u32 s36, s35, 1
  s_cmp_lt_u32 s36, s34
  s_cselect_b32 s36, s36, -1
  s_cmp_lt_i32 s35, 0
  s_cselect_b32 s36, -1, s36
  s_mov_b32 s58, 0
  s_mov_b32 s57, 0
  v_mov_b32 v14, 0
  s_lshl_b32 s59, s29, 7
  s_add_u32 s59, s59, 491520
L_FA_get:
  s_lshl_b32 s43, s35, 9
  s_add_u32 s43, s43, 327680
  s_mov_b32 s40, 0
poll_24:
  buffer_load_dword v10, v9, s[4:7], s43 offen sc1
  s_add_u32 s40, s40, 1
  s_waitcnt vmcnt(0)
  v_cmp_eq_u32 vcc, 0, v10
  s_cbranch_vccz pd_25
  s_movk_i32 s41, 25
  s_cmp_gt_u32 s40, 262144
  s_cbranch_scc1 L_fail
  s_sleep 1
  s_branch poll_24
pd_25:
L_FA_g2:
  s_lshl_b32 s39, s35, 15
  s_add_u32 s39, s39, 14680064
  s_xor_b32 s42, s38, 0
  s_add_u32 m0, s42, s48
  s_nop 0
  buffer_load_dwordx4 v6, s[4:7], s39 offen sc1 lds
  s_add_u32 m0, m0, 4096
  s_add_u32 s39, s39, 4096
  buffer_load_dwordx4 v6, s[4:7], s39 offen sc1 lds
  s_add_u32 m0, m0, 4096
  s_add_u32 s39, s39, 4096
  buffer_load_dwordx4 v6, s[4:7], s39 offen sc1 lds
  s_add_u32 m0, m0, 4096
  s_add_u32 s39, s39, 4096
  buffer_load_dwordx4 v6, s[4:7], s39 offen sc1 lds
  s_add_u32 m0, m0, 4096
  s_add_u32 s39, s39, 4096
  buffer_load_dwordx4 v6, s[4:7], s39 offen sc1 lds
  s_add_u32 m0, m0, 4096
  s_add_u32 s39, s39, 4096
  buffer_load_dwordx4 v6, s[4:7], s39 offen sc1 lds
  s_add_u32 m0, m0, 4096
  s_add_u32 s39, s39, 4096
  buffer_load_dwordx4 v6, s[4:7], s39 offen sc1 lds
  s_add_u32 m0, m0, 4096
  s_add_u32 s39, s39, 4096
  buffer_load_dwordx4 v6, s[4:7], s39 offen sc1 lds
  s_add_u32 m0, m0, 4096
  s_add_u32 s39, s39, 4096
  s_waitcnt vmcnt(4)
  s_barrier
  ds_read_b128 v[16:19], v5 offset:0
  ds_read_b128 v[20:23], v5 offset:1024
  ds_read_b128 v[24:27], v5 offset:2048
  ds_read_b128 v[28:31], v5 offset:3072
  ds_read_b128 v[32:35], v5 offset:4096
  ds_read_b128 v[36:39], v5 offset:5120
  s_max_i32 s43, s36, 0
  s_lshl_b32 s43, s43, 9
  s_add_u32 s43, s43, 327680
  buffer_load_dword v10, v9, s[4:7], s43 offen sc1
  s_waitcnt lgkmcnt(5)
  v_mfma_f32_32x32x16_bf16 v[64:79], a[0:3], v[16:19], 0
  v_mfma_f32_32x32x16_bf16 v[80:95], a[128:131], v[16:19], 0
  ds_read_b128 v[16:19], v5 offset:6144
  s_waitcnt lgkmcnt(5)
  v_mfma_f32_32x32x16_bf16 v[64:79], a[4:7], v[20:23], v[64:79]
  v_mfma_f32_32x32x16_bf16 v[80:95], a[132:135], v[20:23], v[80:95]
  ds_read_b128 v[20:23], v5 offset:7168
  s_waitcnt lgkmcnt(5)
  v_mfma_f32_32x32x16_bf16 v[64:79], a[8:11], v[24:27], v[64:79]
  v_mfma_f32_32x32x16_bf16 v[80:95], a[136:139], v[24:27], v[80:95]
  ds_read_b128 v[24:27], v5 offset:8192
  s_waitcnt lgkmcnt(5)
  v_mfma_f32_32x32x16_bf16 v[64:79], a[12:15], v[28:31], v[64:79]
  v_mfma_f32_32x32x16_bf16 v[80:95], a[140:143], v[28:31], v[80:95]
  ds_read_b128 v[28:31], v5 offset:9216
  s_waitcnt lgkmcnt(5)
  v_mfma_f32_32x32x16_bf16 v[64:79], a[16:19], v[32:35], v[64:79]
  v_mfma_f32_32x32x16_bf16 v[80:95], a[144:147], v[32:35], v[80:95]
  ds_read_b128 v[32:35], v5 offset:10240
  s_waitcnt lgkmcnt(5)
  v_mfma_f32_32x32x16_bf16 v[64:79], a[20:23], v[36:39], v[64:79]
  v_mfma_f32_32x32x16_bf16 v[80:95], a[148:151], v[36:39], v[80:95]
  ds_read_b128 v[36:39], v5 offset:11264
  s_waitcnt lgkmcnt(5)
  v_mfma_f32_32x32x16_bf16 v[64:79], a[24:27], v[16:19], v[64:79]
  v_mfma_f32_32x32x16_bf16 v[80:95], a[152:155], v[16:19], v[80:95]
  ds_read_b128 v[16:19], v5 offset:12288
  s_waitcnt lgkmcnt(5)
  v_mfma_f32_32x32x16_bf16 v[64:79], a[28:31], v[20:23], v[64:79]
  v_mfma_f32_32x32x16_bf16 v[80:95], a[156:159], v[20:23], v[80:95]
  ds_read_b128 v[20:23], v5 offset:13312
  s_waitcnt lgkmcnt(5)
  v_mfma_f32_32x32x16_bf16 v[64:79], a[32:35], v[24:27], v[64:79]
  v_mfma_f32_32x32x16_bf16 v[80:95], a[160:163], v[24:27], v[80:95]
  ds_read_b128 v[24:27], v5 offset:14336
  s_waitcnt lgkmcnt(5)
  v_mfma_f32_32x32x16_bf16 v[64:79], a[36:39], v[28:31], v[64:79]
  v_mfma_f32_32x32x16_bf16 v[80:95], a[164:167], v[28:31], v[80:95]
  ds_read_b128 v[28:31], v5 offset:15360
  s_waitcnt vmcnt(0)
  s_barrier
  s_mov_b32 s37, 0
  v_cmp_eq_u32 vcc, 0, v10
  s_cmp_lt_i32 s36, 0
  s_cbranch_scc1 L_FA_ny
  s_cbranch_vccnz L_FA_ny
L_FA_yy:
  s_mov_b32 s37, 1
  s_branch L_FA_ey
L_FA_ny:
  s_waitcnt lgkmcnt(5)
  v_mfma_f32_32x32x16_bf16 v[64:79], a[40:43], v[32:35], v[64:79]
  v_mfma_f32_32x32x16_bf16 v[80:95], a[168:171], v[32:35], v[80:95]
  ds_read_b128 v[32:35], v5 offset:16384
  s_waitcnt lgkmcnt(5)
  v_mfma_f32_32x32x16_bf16 v[64:79], a[44:47], v[36:39], v[64:79]
  v_mfma_f32_32x32x16_bf16 v[80:95], a[172:175], v[36:39], v[80:95]
  ds_read_b128 v[36:39], v5 offset:17408
  s_max_i32 s40, s36, 0
  s_mul_i32 s40, s40, 98304
  s_add_u32 s40, s40, s51
  buffer_load_dword v15, v8, s[4:7], s40 offen
  s_waitcnt lgkmcnt(5)
  v_mfma_f32_32x32x16_bf16 v[64:79], a[48:51], v[16:19], v[64:79]
  v_mfma_f32_32x32x16_bf16 v[80:95], a[176:179], v[16:19], v[80:95]
  ds_read_b128 v[16:19], v5 offset:18432
  s_waitcnt lgkmcnt(5)
  v_mfma_f32_32x32x16_bf16 v[64:79], a[52:55], v[20:23], v[64:79]
  v_mfma_f32_32x32x16_bf16 v[80:95], a[180:183], v[20:23], v[80:95]
  ds_read_b128 v[20:23], v5 offset:19456
  s_waitcnt lgkmcnt(5)
  v_mfma_f32_32x32x16_bf16 v[64:79], a[56:59], v[24:27], v[64:79]
  v_mfma_f32_32x32x16_bf16 v[80:95], a[184:187], v[24:27], v[80:95]
  ds_read_b128 v[24:27], v5 offset:20480
  s_waitcnt lgkmcnt(5)
  v_mfma_f32_32x32x16_bf16 v[64:79], a[60:63], v[28:31], v[64:79]
  v_mfma_f32_32x32x16_bf16 v[80:95], a[188:191], v[28:31], v[80:95]
  ds_read_b128 v[28:31], v5 offset:21504
  s_waitcnt lgkmcnt(5)
  v_mfma_f32_32x32x16_bf16 v[64:79], a[64:67], v[32:35], v[64:79]
  v_mfma_f32_32x32x16_bf16 v[80:95], a[192:195], v[32:35], v[80:95]
  ds_read_b128 v[32:35], v5 offset:22528
  s_waitcnt lgkmcnt(5)
  v_mfma_f32_32x32x16_bf16 v[64:79], a[68:71], v[36:39], v[64:79]
  v_mfma_f32_32x32x16_bf16 v[80:95], a[196:199], v[36:39], v[80:95]
  ds_read_b128 v[36:39], v5 offset:23552
  s_waitcnt lgkmcnt(5)
  v_mfma_f32_32x32x16_bf16 v[64:79], a[72:75], v[16:19], v[64:79]
  v_mfma_f32_32x32x16_bf16 v[80:95], a[200:203], v[16:19], v[80:95]
  ds_read_b128 v[16:19], v5 offset:24576
  s_waitcnt lgkmcnt(5)
  v_mfma_f32_32x32x16_bf16 v[64:79], a[76:79], v[20:23], v[64:79]
  v_mfma_f32_32x32x16_bf16 v[80:95], a[204:207], v[20:23], v[80:95]
  ds_read_b128 v[20:23], v5 offset:25600
  s_waitcnt lgkmcnt(5)
  v_mfma_f32_32x32x16_bf16 v[64:79], a[80:83], v[24:27], v[64:79]
  v_mfma_f32_32x32x16_bf16 v[80:95], a[208:211], v[24:27], v[80:95]
  ds_read_b128 v[24:27], v5 offset:26624
  s_waitcnt lgkmcnt(5)
  v_mfma_f32_32x32x16_bf16 v[64:79], a[84:87], v[28:31], v[64:79]
  v_mfma_f32_32x32x16_bf16 v[80:95], a[212:215], v[28:31], v[80:95]
  ds_read_b128 v[28:31], v5 offset:27648
  s_max_i32 s43, s36, 0
  s_lshl_b32 s43, s43, 9
  s_add_u32 s43, s43, 327680
  buffer_load_dword v10, v9, s[4:7], s43 offen sc1
  s_waitcnt lgkmcnt(5)
  v_mfma_f32_32x32x16_bf16 v[64:79], a[88:91], v[32:35], v[64:79]
  v_mfma_f32_32x32x16_bf16 v[80:95], a[216:219], v[32:35], v[80:95]
  ds_read_b128 v[32:35], v5 offset:28672
  s_waitcnt lgkmcnt(5)
  v_mfma_f32_32x32x16_bf16 v[64:79], a[92:95], v[36:39], v[64:79]
  v_mfma_f32_32x32x16_bf16 v[80:95], a[220:223], v[36:39], v[80:95]
  ds_read_b128 v[36:39], v5 offset:29696
  s_waitcnt lgkmcnt(5)
  v_mfma_f32_32x32x16_bf16 v[64:79], a[96:99], v[16:19], v[64:79]
  v_mfma_f32_32x32x16_bf16 v[80:95], a[224:227], v[16:19], v[80:95]
  ds_read_b128 v[16:19], v5 offset:30720
  s_waitcnt lgkmcnt(5)
  v_mfma_f32_32x32x16_bf16 v[64:79], a[100:103], v[20:23], v[64:79]
  v_mfma_f32_32x32x16_bf16 v[80:95], a[228:231], v[20:23], v[80:95]
  ds_read_b128 v[20:23], v5 offset:31744
  s_waitcnt lgkmcnt(5)
  v_mfma_f32_32x32x16_bf16 v[64:79], a[104:107], v[24:27], v[64:79]
  v_mfma_f32_32x32x16_bf16 v[80:95], a[232:235], v[24:27], v[80:95]
  s_waitcnt lgkmcnt(4)
  v_mfma_f32_32x32x16_bf16 v[64:79], a[108:111], v[28:31], v[64:79]
  v_mfma_f32_32x32x16_bf16 v[80:95], a[236:239], v[28:31], v[80:95]
  s_add_u32 s56, s36, 1
  s_cmp_lt_u32 s56, s34
  s_cselect_b32 s56, s56, -1
  s_cmp_lt_i32 s36, 0
  s_cselect_b32 s56, -1, s56
  s_max_i32 s43, s56, 0
  s_lshl_b32 s43, s43, 9
  s_add_u32 s43, s43, 327680
  buffer_load_dword v14, v9, s[4:7], s43 offen sc1
  s_waitcnt lgkmcnt(3)
  v_mfma_f32_32x32x16_bf16 v[64:79], a[112:115], v[32:35], v[64:79]
  v_mfma_f32_32x32x16_bf16 v[80:95], a[240:243], v[32:35], v[80:95]
  s_waitcnt lgkmcnt(2)
  v_mfma_f32_32x32x16_bf16 v[64:79], a[116:119], v[36:39], v[64:79]
  v_mfma_f32_32x32x16_bf16 v[80:95], a[244:247], v[36:39], v[80:95]
  s_waitcnt lgkmcnt(1)
  v_mfma_f32_32x32x16_bf16 v[64:79], a[120:123], v[16:19], v[64:79]
  v_mfma_f32_32x32x16_bf16 v[80:95], a[248:251], v[16:19], v[80:95]
  s_waitcnt lgkmcnt(0)
  v_mfma_f32_32x32x16_bf16 v[64:79], a[124:127], v[20:23], v[64:79]
  v_mfma_f32_32x32x16_bf16 v[80:95], a[252:255], v[20:23], v[80:95]
  s_branch L_FA_epi
L_FA_ey:
  s_lshl_b32 s39, s36, 15
  s_add_u32 s39, s39, 14680064
  s_xor_b32 s42, s38, 32768
  s_add_u32 m0, s42, s48
  s_nop 0
  s_waitcnt lgkmcnt(5)
  v_mfma_f32_32x32x16_bf16 v[64:79], a[40:43], v[32:35], v[64:79]
  v_mfma_f32_32x32x16_bf16 v[80:95], a[168:171], v[32:35], v[80:95]
  ds_read_b128 v[32:35], v5 offset:16384
  buffer_load_dwordx4 v6, s[4:7], s39 offen sc1 lds
  s_add_u32 m0, m0, 4096
  s_add_u32 s39, s39, 4096
  s_waitcnt lgkmcnt(5)
  v_mfma_f32_32x32x16_bf16 v[64:79], a[44:47], v[36:39], v[64:79]
  v_mfma_f32_32x32x16_bf16 v[80:95], a[172:175], v[36:39], v[80:95]
  ds_read_b128 v[36:39], v5 offset:17408
  s_max_i32 s40, s36, 0
  s_mul_i32 s40, s40, 98304
  s_add_u32 s40, s40, s51
  buffer_load_dword v15, v8, s[4:7], s40 offen
  s_waitcnt lgkmcnt(5)
  v_mfma_f32_32x32x16_bf16 v[64:79], a[48:51], v[16:19], v[64:79]
  v_mfma_f32_32x32x16_bf16 v[80:95], a[176:179], v[16:19], v[80:95]
  ds_read_b128 v[16:19], v5 offset:18432
  buffer_load_dwordx4 v6, s[4:7], s39 offen sc1 lds
  s_add_u32 m0, m0, 4096
  s_add_u32 s39, s39, 4096
  s_waitcnt lgkmcnt(5)
  v_mfma_f32_32x32x16_bf16 v[64:79], a[52:55], v[20:23], v[64:79]
  v_mfma_f32_32x32x16_bf16 v[80:95], a[180:183], v[20:23], v[80:95]
  ds_read_b128 v[20:23], v5 offset:19456
  s_waitcnt lgkmcnt(5)
  v_mfma_f32_32x32x16_bf16 v[64:79], a[56:59], v[24:27], v[64:79]
  v_mfma_f32_32x32x16_bf16 v[80:95], a[184:187], v[24:27], v[80:95]
  ds_read_b128 v[24:27], v5 offset:20480
  buffer_load_dwordx4 v6, s[4:7], s39 offen sc1 lds
  s_add_u32 m0, m0, 4096
  s_add_u32 s39, s39, 4096
  s_waitcnt lgkmcnt(5)
  v_mfma_f32_32x32x16_bf16 v[64:79], a[60:63], v[28:31], v[64:79]
  v_mfma_f32_32x32x16_bf16 v[80:95], a[188:191], v[28:31], v[80:95]
  ds_read_b128 v[28:31], v5 offset:21504
  s_waitcnt lgkmcnt(5)
  v_mfma_f32_32x32x16_bf16 v[64:79], a[64:67], v[32:35], v[64:79]
  v_mfma_f32_32x32x16_bf16 v[80:95], a[192:195], v[32:35], v[80:95]
  ds_read_b128 v[32:35], v5 offset:22528
  buffer_load_dwordx4 v6, s[4:7], s39 offen sc1 lds
  s_add_u32 m0, m0, 4096
  s_add_u32 s39, s39, 4096
  s_waitcnt lgkmcnt(5)
  v_mfma_f32_32x32x16_bf16 v[64:79], a[68:71], v[36:39], v[64:79]
  v_mfma_f32_32x32x16_bf16 v[80:95], a[196:199], v[36:39], v[80:95]
  ds_read_b128 v[36:39], v5 offset:23552
  s_waitcnt lgkmcnt(5)
  v_mfma_f32_32x32x16_bf16 v[64:79], a[72:75], v[16:19], v[64:79]
  v_mfma_f32_32x32x16_bf16 v[80:95], a[200:203], v[16:19], v[80:95]
  ds_read_b128 v[16:19], v5 offset:24576
  buffer_load_dwordx4 v6, s[4:7], s39 offen sc1 lds
  s_add_u32 m0, m0, 4096
  s_add_u32 s39, s39, 4096
  s_waitcnt lgkmcnt(5)
  v_mfma_f32_32x32x16_bf16 v[64:79], a[76:79], v[20:23], v[64:79]
  v_mfma_f32_32x32x16_bf16 v[80:95], a[204:207], v[20:23], v[80:95]
  ds_read_b128 v[20:23], v5 offset:25600
  s_waitcnt lgkmcnt(5)
  v_mfma_f32_32x32x16_bf16 v[64:79], a[80:83], v[24:27], v[64:79]
  v_mfma_f32_32x32x16_bf16 v[80:95], a[208:211], v[24:27], v[80:95]
  ds_read_b128 v[24:27], v5 offset:26624
  buffer_load_dwordx4 v6, s[4:7], s39 offen sc1 lds
  s_add_u32 m0, m0, 4096
  s_add_u32 s39, s39, 4096
  s_waitcnt lgkmcnt(5)
  v_mfma_f32_32x32x16_bf16 v[64:79], a[84:87], v[28:31], v[64:79]
  v_mfma_f32_32x32x16_bf16 v[80:95], a[212:215], v[28:31], v[80:95]
  ds_read_b128 v[28:31], v5 offset:27648
  s_waitcnt lgkmcnt(5)
  v_mfma_f32_32x32x16_bf16 v[64:79], a[88:91], v[32:35], v[64:79]
  v_mfma_f32_32x32x16_bf16 v[80:95], a[216:219], v[32:35], v[80:95]
  ds_read_b128 v[32:35], v5 offset:28672
  buffer_load_dwordx4 v6, s[4:7], s39 offen sc1 lds
  s_add_u32 m0, m0, 4096
  s_add_u32 s39, s39, 4096
  s_waitcnt lgkmcnt(5)
  v_mfma_f32_32x32x16_bf16 v[64:79], a[92:95], v[36:39], v[64:79]
  v_mfma_f32_32x32x16_bf16 v[80:95], a[220:223], v[36:39], v[80:95]
  ds_read_b128 v[36:39], v5 offset:29696
  s_waitcnt lgkmcnt(5)
  v_mfma_f32_32x32x16_bf16 v[64:79], a[96:99], v[16:19], v[64:79]
  v_mfma_f32_32x32x16_bf16 v[80:95], a[224:227], v[16:19], v[80:95]
  ds_read_b128 v[16:19], v5 offset:30720
  buffer_load_dwordx4 v6, s[4:7], s39 offen sc1 lds
  s_add_u32 m0, m0, 4096
  s_add_u32 s39, s39, 4096
  s_waitcnt lgkmcnt(5)
  v_mfma_f32_32x32x16_bf16 v[64:79], a[100:103], v[20:23], v[64:79]
  v_mfma_f32_32x32x16_bf16 v[80:95], a[228:231], v[20:23], v[80:95]
  ds_read_b128 v[20:23], v5 offset:31744
  s_waitcnt lgkmcnt(5)
  v_mfma_f32_32x32x16_bf16 v[64:79], a[104:107], v[24:27], v[64:79]
  v_mfma_f32_32x32x16_bf16 v[80:95], a[232:235], v[24:27], v[80:95]
  s_waitcnt lgkmcnt(4)
  v_mfma_f32_32x32x16_bf16 v[64:79], a[108:111], v[28:31], v[64:79]
  v_mfma_f32_32x32x16_bf16 v[80:95], a[236:239], v[28:31], v[80:95]
  s_add_u32 s56, s36, 1
  s_cmp_lt_u32 s56, s34
  s_cselect_b32 s56, s56, -1
  s_cmp_lt_i32 s36, 0
  s_cselect_b32 s56, -1, s56
  s_max_i32 s43, s56, 0
  s_lshl_b32 s43, s43, 9
  s_add_u32 s43, s43, 327680
  buffer_load_dword v14, v9, s[4:7], s43 offen sc1
  s_waitcnt lgkmcnt(3)
  v_mfma_f32_32x32x16_bf16 v[64:79], a[112:115], v[32:35], v[64:79]
  v_mfma_f32_32x32x16_bf16 v[80:95], a[240:243], v[32:35], v[80:95]
  s_waitcnt lgkmcnt(2)
  v_mfma_f32_32x32x16_bf16 v[64:79], a[116:119], v[36:39], v[64:79]
  v_mfma_f32_32x32x16_bf16 v[80:95], a[244:247], v[36:39], v[80:95]
  s_waitcnt lgkmcnt(1)
  v_mfma_f32_32x32x16_bf16 v[64:79], a[120:123], v[16:19], v[64:79]
  v_mfma_f32_32x32x16_bf16 v[80:95], a[248:251], v[16:19], v[80:95]
  s_waitcnt lgkmcnt(0)
  v_mfma_f32_32x32x16_bf16 v[64:79], a[124:127], v[20:23], v[64:79]
  v_mfma_f32_32x32x16_bf16 v[80:95], a[252:255], v[20:23], v[80:95]
  s_branch L_FA_epi
L_FA_top:
  s_barrier
  ds_read_b128 v[16:19], v5 offset:0
  ds_read_b128 v[20:23], v5 offset:1024
  ds_read_b128 v[24:27], v5 offset:2048
  ds_read_b128 v[28:31], v5 offset:3072
  ds_read_b128 v[32:35], v5 offset:4096
  ds_read_b128 v[36:39], v5 offset:5120
  s_mov_b32 s37, 0
  v_cmp_eq_u32 vcc, 0, v14
  s_cmp_lt_i32 s36, 0
  s_cbranch_scc1 L_FA_nx
  s_cbranch_vccnz L_FA_nx
L_FA_yx:
  s_mov_b32 s37, 1
  s_branch L_FA_ex
L_FA_nx:
  s_waitcnt lgkmcnt(5)
  v_mfma_f32_32x32x16_bf16 v[64:79], a[0:3], v[16:19], 0
  v_mfma_f32_32x32x16_bf16 v[80:95], a[128:131], v[16:19], 0
  ds_read_b128 v[16:19], v5 offset:6144
  s_waitcnt lgkmcnt(5)
  v_mfma_f32_32x32x16_bf16 v[64:79], a[4:7], v[20:23], v[64:79]
  v_mfma_f32_32x32x16_bf16 v[80:95], a[132:135], v[20:23], v[80:95]
  ds_read_b128 v[20:23], v5 offset:7168
  s_waitcnt lgkmcnt(5)
  v_mfma_f32_32x32x16_bf16 v[64:79], a[8:11], v[24:27], v[64:79]
  v_mfma_f32_32x32x16_bf16 v[80:95], a[136:139], v[24:27], v[80:95]
  ds_read_b128 v[24:27], v5 offset:8192
  s_waitcnt lgkmcnt(5)
  v_mfma_f32_32x32x16_bf16 v[64:79], a[12:15], v[28:31], v[64:79]
  v_mfma_f32_32x32x16_bf16 v[80:95], a[140:143], v[28:31], v[80:95]
  ds_read_b128 v[28:31], v5 offset:9216
  s_waitcnt lgkmcnt(5)
  v_mfma_f32_32x32x16_bf16 v[64:79], a[16:19], v[32:35], v[64:79]
  v_mfma_f32_32x32x16_bf16 v[80:95], a[144:147], v[32:35], v[80:95]
  ds_read_b128 v[32:35], v5 offset:10240
  s_waitcnt lgkmcnt(5)
  v_mfma_f32_32x32x16_bf16 v[64:79], a[20:23], v[36:39], v[64:79]
  v_mfma_f32_32x32x16_bf16 v[80:95], a[148:151], v[36:39], v[80:95]
  ds_read_b128 v[36:39], v5 offset:11264
  s_waitcnt lgkmcnt(5)
  v_mfma_f32_32x32x16_bf16 v[64:79], a[24:27], v[16:19], v[64:79]
  v_mfma_f32_32x32x16_bf16 v[80:95], a[152:155], v[16:19], v[80:95]
  ds_read_b128 v[16:19], v5 offset:12288
  s_waitcnt lgkmcnt(5)
  v_mfma_f32_32x32x16_bf16 v[64:79], a[28:31], v[20:23], v[64:79]
  v_mfma_f32_32x32x16_bf16 v[80:95], a[156:159], v[20:23], v[80:95]
  ds_read_b128 v[20:23], v5 offset:13312
  s_waitcnt lgkmcnt(5)
  v_mfma_f32_32x32x16_bf16 v[64:79], a[32:35], v[24:27], v[64:79]
  v_mfma_f32_32x32x16_bf16 v[80:95], a[160:163], v[24:27], v[80:95]
  ds_read_b128 v[24:27], v5 offset:14336
  s_waitcnt lgkmcnt(5)
  v_mfma_f32_32x32x16_bf16 v[64:79], a[36:39], v[28:31], v[64:79]
  v_mfma_f32_32x32x16_bf16 v[80:95], a[164:167], v[28:31], v[80:95]
  ds_read_b128 v[28:31], v5 offset:15360
  s_barrier
  s_waitcnt lgkmcnt(5)
  v_mfma_f32_32x32x16_bf16 v[64:79], a[40:43], v[32:35], v[64:79]
  v_mfma_f32_32x32x16_bf16 v[80:95], a[168:171], v[32:35], v[80:95]
  ds_read_b128 v[32:35], v5 offset:16384
  s_waitcnt lgkmcnt(5)
  v_mfma_f32_32x32x16_bf16 v[64:79], a[44:47], v[36:39], v[64:79]
  v_mfma_f32_32x32x16_bf16 v[80:95], a[172:175], v[36:39], v[80:95]
  ds_read_b128 v[36:39], v5 offset:17408
  s_max_i32 s40, s36, 0
  s_mul_i32 s40, s40, 98304
  s_add_u32 s40, s40, s51
  buffer_load_dword v15, v8, s[4:7], s40 offen
  s_waitcnt lgkmcnt(5)
  v_mfma_f32_32x32x16_bf16 v[64:79], a[48:51], v[16:19], v[64:79]
  v_mfma_f32_32x32x16_bf16 v[80:95], a[176:179], v[16:19], v[80:95]
  ds_read_b128 v[16:19], v5 offset:18432
  s_waitcnt lgkmcnt(5)
  v_mfma_f32_32x32x16_bf16 v[64:79], a[52:55], v[20:23], v[64:79]
  v_mfma_f32_32x32x16_bf16 v[80:95], a[180:183], v[20:23], v[80:95]
  ds_read_b128 v[20:23], v5 offset:19456
  s_waitcnt lgkmcnt(5)
  v_mfma_f32_32x32x16_bf16 v[64:79], a[56:59], v[24:27], v[64:79]
  v_mfma_f32_32x32x16_bf16 v[80:95], a[184:187], v[24:27], v[80:95]
  ds_read_b128 v[24:27], v5 offset:20480
  s_waitcnt lgkmcnt(5)
  v_mfma_f32_32x32x16_bf16 v[64:79], a[60:63], v[28:31], v[64:79]
  v_mfma_f32_32x32x16_bf16 v[80:95], a[188:191], v[28:31], v[80:95]
  ds_read_b128 v[28:31], v5 offset:21504
  s_waitcnt lgkmcnt(5)
  v_mfma_f32_32x32x16_bf16 v[64:79], a[64:67], v[32:35], v[64:79]
  v_mfma_f32_32x32x16_bf16 v[80:95], a[192:195], v[32:35], v[80:95]
  ds_read_b128 v[32:35], v5 offset:22528
  s_waitcnt lgkmcnt(5)
  v_mfma_f32_32x32x16_bf16 v[64:79], a[68:71], v[36:39], v[64:79]
  v_mfma_f32_32x32x16_bf16 v[80:95], a[196:199], v[36:39], v[80:95]
  ds_read_b128 v[36:39], v5 offset:23552
  s_waitcnt lgkmcnt(5)
  v_mfma_f32_32x32x16_bf16 v[64:79], a[72:75], v[16:19], v[64:79]
  v_mfma_f32_32x32x16_bf16 v[80:95], a[200:203], v[16:19], v[80:95]
  ds_read_b128 v[16:19], v5 offset:24576
  s_waitcnt lgkmcnt(5)
  v_mfma_f32_32x32x16_bf16 v[64:79], a[76:79], v[20:23], v[64:79]
  v_mfma_f32_32x32x16_bf16 v[80:95], a[204:207], v[20:23], v[80:95]
  ds_read_b128 v[20:23], v5 offset:25600
  s_waitcnt lgkmcnt(5)
  v_mfma_f32_32x32x16_bf16 v[64:79], a[80:83], v[24:27], v[64:79]
  v_mfma_f32_32x32x16_bf16 v[80:95], a[208:211], v[24:27], v[80:95]
  ds_read_b128 v[24:27], v5 offset:26624
  s_waitcnt lgkmcnt(5)
  v_mfma_f32_32x32x16_bf16 v[64:79], a[84:87], v[28:31], v[64:79]
  v_mfma_f32_32x32x16_bf16 v[80:95], a[212:215], v[28:31], v[80:95]
  ds_read_b128 v[28:31], v5 offset:27648
  s_max_i32 s43, s36, 0
  s_lshl_b32 s43, s43, 9
  s_add_u32 s43, s43, 327680
  buffer_load_dword v10, v9, s[4:7], s43 offen sc1
  s_waitcnt lgkmcnt(5)
  v_mfma_f32_32x32x16_bf16 v[64:79], a[88:91], v[32:35], v[64:79]
  v_mfma_f32_32x32x16_bf16 v[80:95], a[216:219], v[32:35], v[80:95]
  ds_read_b128 v[32:35], v5 offset:28672
  s_waitcnt lgkmcnt(5)
  v_mfma_f32_32x32x16_bf16 v[64:79], a[92:95], v[36:39], v[64:79]
  v_mfma_f32_32x32x16_bf16 v[80:95], a[220:223], v[36:39], v[80:95]
  ds_read_b128 v[36:39], v5 offset:29696
  s_waitcnt lgkmcnt(5)
  v_mfma_f32_32x32x16_bf16 v[64:79], a[96:99], v[16:19], v[64:79]
  v_mfma_f32_32x32x16_bf16 v[80:95], a[224:227], v[16:19], v[80:95]
  ds_read_b128 v[16:19], v5 offset:30720
  s_waitcnt lgkmcnt(5)
  v_mfma_f32_32x32x16_bf16 v[64:79], a[100:103], v[20:23], v[64:79]
  v_mfma_f32_32x32x16_bf16 v[80:95], a[228:231], v[20:23], v[80:95]
  ds_read_b128 v[20:23], v5 offset:31744
  s_waitcnt lgkmcnt(5)
  v_mfma_f32_32x32x16_bf16 v[64:79], a[104:107], v[24:27], v[64:79]
  v_mfma_f32_32x32x16_bf16 v[80:95], a[232:235], v[24:27], v[80:95]
  s_waitcnt lgkmcnt(4)
  v_mfma_f32_32x32x16_bf16 v[64:79], a[108:111], v[28:31], v[64:79]
  v_mfma_f32_32x32x16_bf16 v[80:95], a[236:239], v[28:31], v[80:95]
  s_add_u32 s56, s36, 1
  s_cmp_lt_u32 s56, s34
  s_cselect_b32 s56, s56, -1
  s_cmp_lt_i32 s36, 0
  s_cselect_b32 s56, -1, s56
  s_max_i32 s43, s56, 0
  s_lshl_b32 s43, s43, 9
  s_add_u32 s43, s43, 327680
  buffer_load_dword v14, v9, s[4:7], s43 offen sc1
  s_waitcnt lgkmcnt(3)
  v_mfma_f32_32x32x16_bf16 v[64:79], a[112:115], v[32:35], v[64:79]
  v_mfma_f32_32x32x16_bf16 v[80:95], a[240:243], v[32:35], v[80:95]
  s_waitcnt lgkmcnt(2)
  v_mfma_f32_32x32x16_bf16 v[64:79], a[116:119], v[36:39], v[64:79]
  v_mfma_f32_32x32x16_bf16 v[80:95], a[244:247], v[36:39], v[80:95]
  s_waitcnt lgkmcnt(1)
  v_mfma_f32_32x32x16_bf16 v[64:79], a[120:123], v[16:19], v[64:79]
  v_mfma_f32_32x32x16_bf16 v[80:95], a[248:251], v[16:19], v[80:95]
  s_waitcnt lgkmcnt(0)
  v_mfma_f32_32x32x16_bf16 v[64:79], a[124:127], v[20:23], v[64:79]
  v_mfma_f32_32x32x16_bf16 v[80:95], a[252:255], v[20:23], v[80:95]
  s_branch L_FA_epi
L_FA_ex:
  s_lshl_b32 s39, s36, 15
  s_add_u32 s39, s39, 14680064
  s_xor_b32 s42, s38, 32768
  s_add_u32 m0, s42, s48
  s_nop 0
  s_waitcnt lgkmcnt(5)
  v_mfma_f32_32x32x16_bf16 v[64:79], a[0:3], v[16:19], 0
  v_mfma_f32_32x32x16_bf16 v[80:95], a[128:131], v[16:19], 0
  ds_read_b128 v[16:19], v5 offset:6144
  buffer_load_dwordx4 v6, s[4:7], s39 offen sc1 lds
  s_add_u32 m0, m0, 4096
  s_add_u32 s39, s39, 4096
  s_waitcnt lgkmcnt(5)
  v_mfma_f32_32x32x16_bf16 v[64:79], a[4:7], v[20:23], v[64:79]
  v_mfma_f32_32x32x16_bf16 v[80:95], a[132:135], v[20:23], v[80:95]
  ds_read_b128 v[20:23], v5 offset:7168
  s_waitcnt lgkmcnt(5)
  v_mfma_f32_32x32x16_bf16 v[64:79], a[8:11], v[24:27], v[64:79]
  v_mfma_f32_32x32x16_bf16 v[80:95], a[136:139], v[24:27], v[80:95]
  ds_read_b128 v[24:27], v5 offset:8192
  s_waitcnt lgkmcnt(5)
  v_mfma_f32_32x32x16_bf16 v[64:79], a[12:15], v[28:31], v[64:79]
  v_mfma_f32_32x32x16_bf16 v[80:95], a[140:143], v[28:31], v[80:95]
  ds_read_b128 v[28:31], v5 offset:9216
  buffer_load_dwordx4 v6, s[4:7], s39 offen sc1 lds
  s_add_u32 m0, m0, 4096
  s_add_u32 s39, s39, 4096
  s_waitcnt lgkmcnt(5)
  v_mfma_f32_32x32x16_bf16 v[64:79], a[16:19], v[32:35], v[64:79]
  v_mfma_f32_32x32x16_bf16 v[80:95], a[144:147], v[32:35], v[80:95]
  ds_read_b128 v[32:35], v5 offset:10240
  s_waitcnt lgkmcnt(5)
  v_mfma_f32_32x32x16_bf16 v[64:79], a[20:23], v[36:39], v[64:79]
  v_mfma_f32_32x32x16_bf16 v[80:95], a[148:151], v[36:39], v[80:95]
  ds_read_b128 v[36:39], v5 offset:11264
  s_waitcnt lgkmcnt(5)
  v_mfma_f32_32x32x16_bf16 v[64:79], a[24:27], v[16:19], v[64:79]
  v_mfma_f32_32x32x16_bf16 v[80:95], a[152:155], v[16:19], v[80:95]
  ds_read_b128 v[16:19], v5 offset:12288
  buffer_load_dwordx4 v6, s[4:7], s39 offen sc1 lds
  s_add_u32 m0, m0, 4096
  s_add_u32 s39, s39, 4096
  s_waitcnt lgkmcnt(5)
  v_mfma_f32_32x32x16_bf16 v[64:79], a[28:31], v[20:23], v[64:79]
  v_mfma_f32_32x32x16_bf16 v[80:95], a[156:159], v[20:23], v[80:95]
  ds_read_b128 v[20:23], v5 offset:13312
  s_waitcnt lgkmcnt(5)
  v_mfma_f32_32x32x16_bf16 v[64:79], a[32:35], v[24:27], v[64:79]
  v_mfma_f32_32x32x16_bf16 v[80:95], a[160:163], v[24:27], v[80:95]
  ds_read_b128 v[24:27], v5 offset:14336
  s_waitcnt lgkmcnt(5)
  v_mfma_f32_32x32x16_bf16 v[64:79], a[36:39], v[28:31], v[64:79]
  v_mfma_f32_32x32x16_bf16 v[80:95], a[164:167], v[28:31], v[80:95]
  ds_read_b128 v[28:31], v5 offset:15360
  buffer_load_dwordx4 v6, s[4:7], s39 offen sc1 lds
  s_add_u32 m0, m0, 4096
  s_add_u32 s39, s39, 4096
  s_barrier
  s_waitcnt lgkmcnt(5)
  v_mfma_f32_32x32x16_bf16 v[64:79], a[40:43], v[32:35], v[64:79]
  v_mfma_f32_32x32x16_bf16 v[80:95], a[168:171], v[32:35], v[80:95]
  ds_read_b128 v[32:35], v5 offset:16384
  s_waitcnt lgkmcnt(5)
  v_mfma_f32_32x32x16_bf16 v[64:79], a[44:47], v[36:39], v[64:79]
  v_mfma_f32_32x32x16_bf16 v[80:95], a[172:175], v[36:39], v[80:95]
  ds_read_b128 v[36:39], v5 offset:17408
  s_max_i32 s40, s36, 0
  s_mul_i32 s40, s40, 98304
  s_add_u32 s40, s40, s51
  buffer_load_dword v15, v8, s[4:7], s40 offen
  s_waitcnt lgkmcnt(5)
  v_mfma_f32_32x32x16_bf16 v[64:79], a[48:51], v[16:19], v[64:79]
  v_mfma_f32_32x32x16_bf16 v[80:95], a[176:179], v[16:19], v[80:95]
  ds_read_b128 v[16:19], v5 offset:18432
  buffer_load_dwordx4 v6, s[4:7], s39 offen sc1 lds
  s_add_u32 m0, m0, 4096
  s_add_u32 s39, s39, 4096
  s_waitcnt lgkmcnt(5)
  v_mfma_f32_32x32x16_bf16 v[64:79], a[52:55], v[20:23], v[64:79]
  v_mfma_f32_32x32x16_bf16 v[80:95], a[180:183], v[20:23], v[80:95]
  ds_read_b128 v[20:23], v5 offset:19456
  s_waitcnt lgkmcnt(5)
  v_mfma_f32_32x32x16_bf16 v[64:79], a[56:59], v[24:27], v[64:79]
  v_mfma_f32_32x32x16_bf16 v[80:95], a[184:187], v[24:27], v[80:95]
  ds_read_b128 v[24:27], v5 offset:20480
  s_waitcnt lgkmcnt(5)
  v_mfma_f32_32x32x16_bf16 v[64:79], a[60:63], v[28:31], v[64:79]
  v_mfma_f32_32x32x16_bf16 v[80:95], a[188:191], v[28:31], v[80:95]
  ds_read_b128 v[28:31], v5 offset:21504
  buffer_load_dwordx4 v6, s[4:7], s39 offen sc1 lds
  s_add_u32 m0, m0, 4096
  s_add_u32 s39, s39, 4096
  s_waitcnt lgkmcnt(5)
  v_mfma_f32_32x32x16_bf16 v[64:79], a[64:67], v[32:35], v[64:79]
  v_mfma_f32_32x32x16_bf16 v[80:95], a[192:195], v[32:35], v[80:95]
  ds_read_b128 v[32:35], v5 offset:22528
  s_waitcnt lgkmcnt(5)
  v_mfma_f32_32x32x16_bf16 v[64:79], a[68:71], v[36:39], v[64:79]
  v_mfma_f32_32x32x16_bf16 v[80:95], a[196:199], v[36:39], v[80:95]
  ds_read_b128 v[36:39], v5 offset:23552
  s_waitcnt lgkmcnt(5)
  v_mfma_f32_32x32x16_bf16 v[64:79], a[72:75], v[16:19], v[64:79]
  v_mfma_f32_32x32x16_bf16 v[80:95], a[200:203], v[16:19], v[80:95]
  ds_read_b128 v[16:19], v5 offset:24576
  buffer_load_dwordx4 v6, s[4:7], s39 offen sc1 lds
  s_add_u32 m0, m0, 4096
  s_add_u32 s39, s39, 4096
  s_waitcnt lgkmcnt(5)
  v_mfma_f32_32x32x16_bf16 v[64:79], a[76:79], v[20:23], v[64:79]
  v_mfma_f32_32x32x16_bf16 v[80:95], a[204:207], v[20:23], v[80:95]
  ds_read_b128 v[20:23], v5 offset:25600
  s_waitcnt lgkmcnt(5)
  v_mfma_f32_32x32x16_bf16 v[64:79], a[80:83], v[24:27], v[64:79]
  v_mfma_f32_32x32x16_bf16 v[80:95], a[208:211], v[24:27], v[80:95]
  ds_read_b128 v[24:27], v5 offset:26624
  s_waitcnt lgkmcnt(5)
  v_mfma_f32_32x32x16_bf16 v[64:79], a[84:87], v[28:31], v[64:79]
  v_mfma_f32_32x32x16_bf16 v[80:95], a[212:215], v[28:31], v[80:95]
  ds_read_b128 v[28:31], v5 offset:27648
  buffer_load_dwordx4 v6, s[4:7], s39 offen sc1 lds
  s_add_u32 m0, m0, 4096
  s_add_u32 s39, s39, 4096
  s_waitcnt lgkmcnt(5)
  v_mfma_f32_32x32x16_bf16 v[64:79], a[88:91], v[32:35], v[64:79]
  v_mfma_f32_32x32x16_bf16 v[80:95], a[216:219], v[32:35], v[80:95]
  ds_read_b128 v[32:35], v5 offset:28672
  s_waitcnt lgkmcnt(5)
  v_mfma_f32_32x32x16_bf16 v[64:79], a[92:95], v[36:39], v[64:79]
  v_mfma_f32_32x32x16_bf16 v[80:95], a[220:223], v[36:39], v[80:95]
  ds_read_b128 v[36:39], v5 offset:29696
  s_waitcnt lgkmcnt(5)
  v_mfma_f32_32x32x16_bf16 v[64:79], a[96:99], v[16:19], v[64:79]
  v_mfma_f32_32x32x16_bf16 v[80:95], a[224:227], v[16:19], v[80:95]
  ds_read_b128 v[16:19], v5 offset:30720
  s_waitcnt lgkmcnt(5)
  v_mfma_f32_32x32x16_bf16 v[64:79], a[100:103], v[20:23], v[64:79]
  v_mfma_f32_32x32x16_bf16 v[80:95], a[228:231], v[20:23], v[80:95]
  ds_read_b128 v[20:23], v5 offset:31744
  s_waitcnt lgkmcnt(5)
  v_mfma_f32_32x32x16_bf16 v[64:79], a[104:107], v[24:27], v[64:79]
  v_mfma_f32_32x32x16_bf16 v[80:95], a[232:235], v[24:27], v[80:95]
  s_waitcnt lgkmcnt(4)
  v_mfma_f32_32x32x16_bf16 v[64:79], a[108:111], v[28:31], v[64:79]
  v_mfma_f32_32x32x16_bf16 v[80:95], a[236:239], v[28:31], v[80:95]
  s_add_u32 s56, s36, 1
  s_cmp_lt_u32 s56, s34
  s_cselect_b32 s56, s56, -1
  s_cmp_lt_i32 s36, 0
  s_cselect_b32 s56, -1, s56
  s_max_i32 s43, s56, 0
  s_lshl_b32 s43, s43, 9
  s_add_u32 s43, s43, 327680
  buffer_load_dword v14, v9, s[4:7], s43 offen sc1
  s_waitcnt lgkmcnt(3)
  v_mfma_f32_32x32x16_bf16 v[64:79], a[112:115], v[32:35], v[64:79]
  v_mfma_f32_32x32x16_bf16 v[80:95], a[240:243], v[32:35], v[80:95]
  s_waitcnt lgkmcnt(2)
  v_mfma_f32_32x32x16_bf16 v[64:79], a[116:119], v[36:39], v[64:79]
  v_mfma_f32_32x32x16_bf16 v[80:95], a[244:247], v[36:39], v[80:95]
  s_waitcnt lgkmcnt(1)
  v_mfma_f32_32x32x16_bf16 v[64:79], a[120:123], v[16:19], v[64:79]
  v_mfma_f32_32x32x16_bf16 v[80:95], a[248:251], v[16:19], v[80:95]
  s_waitcnt lgkmcnt(0)
  v_mfma_f32_32x32x16_bf16 v[64:79], a[124:127], v[20:23], v[64:79]
  v_mfma_f32_32x32x16_bf16 v[80:95], a[252:255], v[20:23], v[80:95]
L_FA_epi:
  s_cmp_eq_u32 s49, 43
  s_cbranch_scc1 L_FA_sk
  s_nop 8
  v_cvt_pk_bf16_f32 v48, v64, v65
  v_cvt_pk_bf16_f32 v49, v66, v67
  v_cvt_pk_bf16_f32 v50, v68, v69
  v_cvt_pk_bf16_f32 v51, v70, v71
  v_cvt_pk_bf16_f32 v52, v72, v73
  v_cvt_pk_bf16_f32 v53, v74, v75
  v_cvt_pk_bf16_f32 v54, v76, v77
  v_cvt_pk_bf16_f32 v55, v78, v79
  v_cvt_pk_bf16_f32 v56, v80, v81
  v_cvt_pk_bf16_f32 v57, v82, v83
  v_cvt_pk_bf16_f32 v58, v84, v85
  v_cvt_pk_bf16_f32 v59, v86, v87
  v_cvt_pk_bf16_f32 v60, v88, v89
  v_cvt_pk_bf16_f32 v61, v90, v91
  v_cvt_pk_bf16_f32 v62, v92, v93
  v_cvt_pk_bf16_f32 v63, v94, v95
  v_lshlrev_b32 v64, 16, v48
  v_and_b32 v65, s45, v48
  v_lshlrev_b32 v66, 16, v56
  v_and_b32 v67, s45, v56
  v_pk_mul_f32 v[64:65], v[64:65], v[66:67]
  v_cvt_pk_bf16_f32 v48, v64, v65
  v_lshlrev_b32 v68, 16, v49
  v_and_b32 v69, s45, v49
  v_lshlrev_b32 v70, 16, v57
  v_and_b32 v71, s45, v57
  v_pk_mul_f32 v[68:69], v[68:69], v[70:71]
  v_cvt_pk_bf16_f32 v49, v68, v69
  v_lshlrev_b32 v72, 16, v50
  v_and_b32 v73, s45, v50
  v_lshlrev_b32 v74, 16, v58
  v_and_b32 v75, s45, v58
  v_pk_mul_f32 v[72:73], v[72:73], v[74:75]
  v_cvt_pk_bf16_f32 v50, v72, v73
  v_lshlrev_b32 v76, 16, v51
  v_and_b32 v77, s45, v51
  v_lshlrev_b32 v78, 16, v59
  v_and_b32 v79, s45, v59
  v_pk_mul_f32 v[76:77], v[76:77], v[78:79]
  v_cvt_pk_bf16_f32 v51, v76, v77
  v_lshlrev_b32 v80, 16, v52
  v_and_b32 v81, s45, v52
  v_lshlrev_b32 v82, 16, v60
  v_and_b32 v83, s45, v60
  v_pk_mul_f32 v[80:81], v[80:81], v[82:83]
  v_cvt_pk_bf16_f32 v52, v80, v81
  v_lshlrev_b32 v84, 16, v53
  v_and_b32 v85, s45, v53
  v_lshlrev_b32 v86, 16, v61
  v_and_b32 v87, s45, v61
  v_pk_mul_f32 v[84:85], v[84:85], v[86:87]
  v_cvt_pk_bf16_f32 v53, v84, v85
  v_lshlrev_b32 v88, 16, v54
  v_and_b32 v89, s45, v54
  v_lshlrev_b32 v90, 16, v62
  v_and_b32 v91, s45, v62
  v_pk_mul_f32 v[88:89], v[88:89], v[90:91]
  v_cvt_pk_bf16_f32 v54, v88, v89
  v_lshlrev_b32 v92, 16, v55
  v_and_b32 v93, s45, v55
  v_lshlrev_b32 v94, 16, v63
  v_and_b32 v95, s45, v63
  v_pk_mul_f32 v[92:93], v[92:93], v[94:95]
  v_cvt_pk_bf16_f32 v55, v92, v93
  s_mul_i32 s39, s35, 98304
  s_add_u32 s39, s39, s51
  s_cmp_eq_u32 s47, 0
  s_cbranch_scc1 sf_26
  buffer_store_dwordx4 v[48:51], v2, s[4:7], s39 offen offset:0
  buffer_store_dwordx4 v[52:55], v2, s[4:7], s39 offen offset:1024
  s_waitcnt vmcnt(0)
  s_lshl_b32 s40, s35, 9
  s_add_u32 s40, s40, 393216
  s_add_u32 s40, s40, s52
  s_mov_b64 exec, 1
  buffer_store_dword v4, v3, s[4:7], s40 offen
  s_mov_b64 exec, -1
  s_branch se_27
sf_26:
  buffer_store_dwordx4 v[48:51], v2, s[4:7], s39 offen offset:0 sc1
  buffer_store_dwordx4 v[52:55], v2, s[4:7], s39 offen offset:1024 sc1
  s_waitcnt vmcnt(0)
  s_lshl_b32 s40, s35, 9
  s_add_u32 s40, s40, 393216
  s_add_u32 s40, s40, s52
  s_mov_b64 exec, 1
  buffer_store_dword v4, v3, s[4:7], s40 offen sc1
  s_mov_b64 exec, -1
se_27:
L_FA_sk:
  s_mov_b32 s54, s35
  s_mov_b32 s35, s36
  s_mov_b32 s36, s56
  s_mov_b32 s57, 0
  s_xor_b32 s38, s38, 32768
  v_xor_b32 v5, 32768, v5
  s_waitcnt vmcnt(0)
  s_cmp_eq_u32 s37, 1
  s_cbranch_scc1 L_FA_top
  s_cmp_lt_i32 s35, 0
  s_cbranch_scc1 L_FA_w
  v_cmp_eq_u32 vcc, 0, v10
  s_cbranch_vccz L_FA_g2
L_FA_w:
  s_cmp_lt_i32 s35, 0
  s_cbranch_scc0 L_FA_get
  s_endpgm
J_FB:
  s_load_dwordx2 s[12:13], s[0:1], 80
  s_mov_b32 s14, 1409024
  s_mov_b32 s15, 0x20000
  s_load_dwordx2 s[16:17], s[0:1], 88
  s_mov_b32 s18, 2097152
  s_mov_b32 s19, 0x20000
  s_sub_u32 s40, s46, 19
  s_lshr_b32 s49, s35, 6
  s_bfe_u32 s41, s40, 0x10002
  s_add_u32 s35, s35, s41
  s_and_b32 s50, s40, 3
  s_lshl_b32 s41, s50, 8
  s_lshl_b32 s40, s28, 6
  v_lshrrev_b32 v11, 4, v1
  v_add_u32 v11, s40, v11
  s_mov_b32 s40, 1024
  v_mul_lo_u32 v11, v11, s40
  v_and_b32 v10, 15, v1
  v_lshl_add_u32 v11, v10, 4, v11
  v_add_u32 v11, s41, v11
  s_lshl_b32 s40, s28, 6
  v_bfe_u32 v12, v1, 5, 1
  v_lshlrev_b32 v12, 10, v12
  v_bfe_u32 v10, v1, 2, 2
  v_lshl_add_u32 v12, v10, 8, v12
  v_bfe_u32 v10, v1, 4, 1
  v_lshl_add_u32 v12, v10, 5, v12
  v_bfe_u32 v10, v1, 0, 2
  v_lshl_add_u32 v12, v10, 3, v12
  v_add_u32 v12, s40, v12
  v_add_u32 v13, 0x10000, v12
  s_waitcnt lgkmcnt(0)
  s_lshl_b32 s42, s28, 14
  s_add_u32 s42, s42, 0
  s_add_u32 m0, s42, 0
  s_mov_b32 s43, 0
  buffer_load_dwordx4 v11, s[12:15], s43 offen lds
  s_add_u32 m0, s42, 1024
  s_mov_b32 s43, 4096
  buffer_load_dwordx4 v11, s[12:15], s43 offen lds
  s_add_u32 m0, s42, 2048
  s_mov_b32 s43, 8192
  buffer_load_dwordx4 v11, s[12:15], s43 offen lds
  s_add_u32 m0, s42, 3072
  s_mov_b32 s43, 12288
  buffer_load_dwordx4 v11, s[12:15], s43 offen lds
  s_add_u32 m0, s42, 4096
  s_mov_b32 s43, 16384
  buffer_load_dwordx4 v11, s[12:15], s43 offen lds
  s_add_u32 m0, s42, 5120
  s_mov_b32 s43, 20480
  buffer_load_dwordx4 v11, s[12:15], s43 offen lds
  s_add_u32 m0, s42, 6144
  s_mov_b32 s43, 24576
  buffer_load_dwordx4 v11, s[12:15], s43 offen lds
  s_add_u32 m0, s42, 7168
  s_mov_b32 s43, 28672
  buffer_load_dwordx4 v11, s[12:15], s43 offen lds
  s_add_u32 m0, s42, 8192
  s_mov_b32 s43, 32768
  buffer_load_dwordx4 v11, s[12:15], s43 offen lds
  s_add_u32 m0, s42, 9216
  s_mov_b32 s43, 36864
  buffer_load_dwordx4 v11, s[12:15], s43 offen lds
  s_add_u32 m0, s42, 10240
  s_mov_b32 s43, 40960
  buffer_load_dwordx4 v11, s[12:15], s43 offen lds
  s_add_u32 m0, s42, 11264
  s_mov_b32 s43, 45056
  buffer_load_dwordx4 v11, s[12:15], s43 offen lds
  s_add_u32 m0, s42, 12288
  s_mov_b32 s43, 49152
  buffer_load_dwordx4 v11, s[12:15], s43 offen lds
  s_add_u32 m0, s42, 13312
  s_mov_b32 s43, 53248
  buffer_load_dwordx4 v11, s[12:15], s43 offen lds
  s_add_u32 m0, s42, 14336
  s_mov_b32 s43, 57344
  buffer_load_dwordx4 v11, s[12:15], s43 offen lds
  s_add_u32 m0, s42, 15360
  s_mov_b32 s43, 61440
  buffer_load_dwordx4 v11, s[12:15], s43 offen lds
  s_lshl_b32 s42, s28, 14
  s_add_u32 s42, s42, 65536
  s_add_u32 m0, s42, 0
  s_mov_b32 s43, 262144
  buffer_load_dwordx4 v11, s[12:15], s43 offen lds
  s_add_u32 m0, s42, 1024
  s_mov_b32 s43, 266240
  buffer_load_dwordx4 v11, s[12:15], s43 offen lds
  s_add_u32 m0, s42, 2048
  s_mov_b32 s43, 270336
  buffer_load_dwordx4 v11, s[12:15], s43 offen lds
  s_add_u32 m0, s42, 3072
  s_mov_b32 s43, 274432
  buffer_load_dwordx4 v11, s[12:15], s43 offen lds
  s_add_u32 m0, s42, 4096
  s_mov_b32 s43, 278528
  buffer_load_dwordx4 v11, s[12:15], s43 offen lds
  s_add_u32 m0, s42, 5120
  s_mov_b32 s43, 282624
  buffer_load_dwordx4 v11, s[12:15], s43 offen lds
  s_add_u32 m0, s42, 6144
  s_mov_b32 s43, 286720
  buffer_load_dwordx4 v11, s[12:15], s43 offen lds
  s_add_u32 m0, s42, 7168
  s_mov_b32 s43, 290816
  buffer_load_dwordx4 v11, s[12:15], s43 offen lds
  s_add_u32 m0, s42, 8192
  s_mov_b32 s43, 294912
  buffer_load_dwordx4 v11, s[12:15], s43 offen lds
  s_add_u32 m0, s42, 9216
  s_mov_b32 s43, 299008
  buffer_load_dwordx4 v11, s[12:15], s43 offen lds
  s_add_u32 m0, s42, 10240
  s_mov_b32 s43, 303104
  buffer_load_dwordx4 v11, s[12:15], s43 offen lds
  s_add_u32 m0, s42, 11264
  s_mov_b32 s43, 307200
  buffer_load_dwordx4 v11, s[12:15], s43 offen lds
  s_add_u32 m0, s42, 12288
  s_mov_b32 s43, 311296
  buffer_load_dwordx4 v11, s[12:15], s43 offen lds
  s_add_u32 m0, s42, 13312
  s_mov_b32 s43, 315392
  buffer_load_dwordx4 v11, s[12:15], s43 offen lds
  s_add_u32 m0, s42, 14336
  s_mov_b32 s43, 319488
  buffer_load_dwordx4 v11, s[12:15], s43 offen lds
  s_add_u32 m0, s42, 15360
  s_mov_b32 s43, 323584
  buffer_load_dwordx4 v11, s[12:15], s43 offen lds
  s_waitcnt vmcnt(32)
  s_barrier
  s_lshl_b32 s40, s31, 2
  s_cmp_lg_u32 s28, 0
  s_cbranch_scc1 ar_28
  s_mov_b64 exec, 1
  buffer_atomic_add v9, v3, s[8:11], s40 offen sc1
  s_mov_b64 exec, -1
ar_28:
  s_waitcnt vmcnt(16)
  s_barrier
  ds_read_b64_tr_b16 a[0:1], v12 offset:0
  ds_read_b64_tr_b16 a[2:3], v12 offset:2048
  ds_read_b64_tr_b16 a[4:5], v12 offset:4096
  ds_read_b64_tr_b16 a[6:7], v12 offset:6144
  ds_read_b64_tr_b16 a[8:9], v12 offset:8192
  ds_read_b64_tr_b16 a[10:11], v12 offset:10240
  ds_read_b64_tr_b16 a[12:13], v12 offset:12288
  ds_read_b64_tr_b16 a[14:15], v12 offset:14336
  ds_read_b64_tr_b16 a[16:17], v12 offset:16384
  ds_read_b64_tr_b16 a[18:19], v12 offset:18432
  ds_read_b64_tr_b16 a[20:21], v12 offset:20480
  ds_read_b64_tr_b16 a[22:23], v12 offset:22528
  ds_read_b64_tr_b16 a[24:25], v12 offset:24576
  ds_read_b64_tr_b16 a[26:27], v12 offset:26624
  ds_read_b64_tr_b16 a[28:29], v12 offset:28672
  ds_read_b64_tr_b16 a[30:31], v12 offset:30720
  ds_read_b64_tr_b16 a[32:33], v12 offset:32768
  ds_read_b64_tr_b16 a[34:35], v12 offset:34816
  ds_read_b64_tr_b16 a[36:37], v12 offset:36864
  ds_read_b64_tr_b16 a[38:39], v12 offset:38912
  ds_read_b64_tr_b16 a[40:41], v12 offset:40960
  ds_read_b64_tr_b16 a[42:43], v12 offset:43008
  ds_read_b64_tr_b16 a[44:45], v12 offset:45056
  ds_read_b64_tr_b16 a[46:47], v12 offset:47104
  ds_read_b64_tr_b16 a[48:49], v12 offset:49152
  ds_read_b64_tr_b16 a[50:51], v12 offset:51200
  ds_read_b64_tr_b16 a[52:53], v12 offset:53248
  ds_read_b64_tr_b16 a[54:55], v12 offset:55296
  ds_read_b64_tr_b16 a[56:57], v12 offset:57344
  ds_read_b64_tr_b16 a[58:59], v12 offset:59392
  ds_read_b64_tr_b16 a[60:61], v12 offset:61440
  ds_read_b64_tr_b16 a[62:63], v12 offset:63488
  s_waitcnt lgkmcnt(0)
  s_barrier
  s_lshl_b32 s42, s28, 14
  s_add_u32 s42, s42, 0
  s_add_u32 m0, s42, 0
  s_mov_b32 s43, 524288
  buffer_load_dwordx4 v11, s[12:15], s43 offen lds
  s_add_u32 m0, s42, 1024
  s_mov_b32 s43, 528384
  buffer_load_dwordx4 v11, s[12:15], s43 offen lds
  s_add_u32 m0, s42, 2048
  s_mov_b32 s43, 532480
  buffer_load_dwordx4 v11, s[12:15], s43 offen lds
  s_add_u32 m0, s42, 3072
  s_mov_b32 s43, 536576
  buffer_load_dwordx4 v11, s[12:15], s43 offen lds
  s_add_u32 m0, s42, 4096
  s_mov_b32 s43, 540672
  buffer_load_dwordx4 v11, s[12:15], s43 offen lds
  s_add_u32 m0, s42, 5120
  s_mov_b32 s43, 544768
  buffer_load_dwordx4 v11, s[12:15], s43 offen lds
  s_add_u32 m0, s42, 6144
  s_mov_b32 s43, 548864
  buffer_load_dwordx4 v11, s[12:15], s43 offen lds
  s_add_u32 m0, s42, 7168
  s_mov_b32 s43, 552960
  buffer_load_dwordx4 v11, s[12:15], s43 offen lds
  s_add_u32 m0, s42, 8192
  s_mov_b32 s43, 557056
  buffer_load_dwordx4 v11, s[12:15], s43 offen lds
  s_add_u32 m0, s42, 9216
  s_mov_b32 s43, 561152
  buffer_load_dwordx4 v11, s[12:15], s43 offen lds
  s_add_u32 m0, s42, 10240
  s_mov_b32 s43, 565248
  buffer_load_dwordx4 v11, s[12:15], s43 offen lds
  s_add_u32 m0, s42, 11264
  s_mov_b32 s43, 569344
  buffer_load_dwordx4 v11, s[12:15], s43 offen lds
  s_add_u32 m0, s42, 12288
  s_mov_b32 s43, 573440
  buffer_load_dwordx4 v11, s[12:15], s43 offen lds
  s_add_u32 m0, s42, 13312
  s_mov_b32 s43, 577536
  buffer_load_dwordx4 v11, s[12:15], s43 offen lds
  s_add_u32 m0, s42, 14336
  s_mov_b32 s43, 581632
  buffer_load_dwordx4 v11, s[12:15], s43 offen lds
  s_add_u32 m0, s42, 15360
  s_mov_b32 s43, 585728
  buffer_load_dwordx4 v11, s[12:15], s43 offen lds
  s_waitcnt vmcnt(16)
  s_barrier
  ds_read_b64_tr_b16 a[64:65], v13 offset:0
  ds_read_b64_tr_b16 a[66:67], v13 offset:2048
  ds_read_b64_tr_b16 a[68:69], v13 offset:4096
  ds_read_b64_tr_b16 a[70:71], v13 offset:6144
  ds_read_b64_tr_b16 a[72:73], v13 offset:8192
  ds_read_b64_tr_b16 a[74:75], v13 offset:10240
  ds_read_b64_tr_b16 a[76:77], v13 offset:12288
  ds_read_b64_tr_b16 a[78:79], v13 offset:14336
  ds_read_b64_tr_b16 a[80:81], v13 offset:16384
  ds_read_b64_tr_b16 a[82:83], v13 offset:18432
  ds_read_b64_tr_b16 a[84:85], v13 offset:20480
  ds_read_b64_tr_b16 a[86:87], v13 offset:22528
  ds_read_b64_tr_b16 a[88:89], v13 offset:24576
  ds_read_b64_tr_b16 a[90:91], v13 offset:26624
  ds_read_b64_tr_b16 a[92:93], v13 offset:28672
  ds_read_b64_tr_b16 a[94:95], v13 offset:30720
  ds_read_b64_tr_b16 a[96:97], v13 offset:32768
  ds_read_b64_tr_b16 a[98:99], v13 offset:34816
  ds_read_b64_tr_b16 a[100:101], v13 offset:36864
  ds_read_b64_tr_b16 a[102:103], v13 offset:38912
  ds_read_b64_tr_b16 a[104:105], v13 offset:40960
  ds_read_b64_tr_b16 a[106:107], v13 offset:43008
  ds_read_b64_tr_b16 a[108:109], v13 offset:45056
  ds_read_b64_tr_b16 a[110:111], v13 offset:47104
  ds_read_b64_tr_b16 a[112:113], v13 offset:49152
  ds_read_b64_tr_b16 a[114:115], v13 offset:51200
  ds_read_b64_tr_b16 a[116:117], v13 offset:53248
  ds_read_b64_tr_b16 a[118:119], v13 offset:55296
  ds_read_b64_tr_b16 a[120:121], v13 offset:57344
  ds_read_b64_tr_b16 a[122:123], v13 offset:59392
  ds_read_b64_tr_b16 a[124:125], v13 offset:61440
  ds_read_b64_tr_b16 a[126:127], v13 offset:63488
  s_waitcnt lgkmcnt(0)
  s_barrier
  s_lshl_b32 s42, s28, 14
  s_add_u32 s42, s42, 65536
  s_add_u32 m0, s42, 0
  s_mov_b32 s43, 786432
  buffer_load_dwordx4 v11, s[12:15], s43 offen lds
  s_add_u32 m0, s42, 1024
  s_mov_b32 s43, 790528
  buffer_load_dwordx4 v11, s[12:15], s43 offen lds
  s_add_u32 m0, s42, 2048
  s_mov_b32 s43, 794624
  buffer_load_dwordx4 v11, s[12:15], s43 offen lds
  s_add_u32 m0, s42, 3072
  s_mov_b32 s43, 798720
  buffer_load_dwordx4 v11, s[12:15], s43 offen lds
  s_add_u32 m0, s42, 4096
  s_mov_b32 s43, 802816
  buffer_load_dwordx4 v11, s[12:15], s43 offen lds
  s_add_u32 m0, s42, 5120
  s_mov_b32 s43, 806912
  buffer_load_dwordx4 v11, s[12:15], s43 offen lds
  s_add_u32 m0, s42, 6144
  s_mov_b32 s43, 811008
  buffer_load_dwordx4 v11, s[12:15], s43 offen lds
  s_add_u32 m0, s42, 7168
  s_mov_b32 s43, 815104
  buffer_load_dwordx4 v11, s[12:15], s43 offen lds
  s_add_u32 m0, s42, 8192
  s_mov_b32 s43, 819200
  buffer_load_dwordx4 v11, s[12:15], s43 offen lds
  s_add_u32 m0, s42, 9216
  s_mov_b32 s43, 823296
  buffer_load_dwordx4 v11, s[12:15], s43 offen lds
  s_add_u32 m0, s42, 10240
  s_mov_b32 s43, 827392
  buffer_load_dwordx4 v11, s[12:15], s43 offen lds
  s_add_u32 m0, s42, 11264
  s_mov_b32 s43, 831488
  buffer_load_dwordx4 v11, s[12:15], s43 offen lds
  s_add_u32 m0, s42, 12288
  s_mov_b32 s43, 835584
  buffer_load_dwordx4 v11, s[12:15], s43 offen lds
  s_add_u32 m0, s42, 13312
  s_mov_b32 s43, 839680
  buffer_load_dwordx4 v11, s[12:15], s43 offen lds
  s_add_u32 m0, s42, 14336
  s_mov_b32 s43, 843776
  buffer_load_dwordx4 v11, s[12:15], s43 offen lds
  s_add_u32 m0, s42, 15360
  s_mov_b32 s43, 847872
  buffer_load_dwordx4 v11, s[12:15], s43 offen lds
  s_waitcnt vmcnt(16)
  s_barrier
  ds_read_b64_tr_b16 a[128:129], v12 offset:0
  ds_read_b64_tr_b16 a[130:131], v12 offset:2048
  ds_read_b64_tr_b16 a[132:133], v12 offset:4096
  ds_read_b64_tr_b16 a[134:135], v12 offset:6144
  ds_read_b64_tr_b16 a[136:137], v12 offset:8192
  ds_read_b64_tr_b16 a[138:139], v12 offset:10240
  ds_read_b64_tr_b16 a[140:141], v12 offset:12288
  ds_read_b64_tr_b16 a[142:143], v12 offset:14336
  ds_read_b64_tr_b16 a[144:145], v12 offset:16384
  ds_read_b64_tr_b16 a[146:147], v12 offset:18432
  ds_read_b64_tr_b16 a[148:149], v12 offset:20480
  ds_read_b64_tr_b16 a[150:151], v12 offset:22528
  ds_read_b64_tr_b16 a[152:153], v12 offset:24576
  ds_read_b64_tr_b16 a[154:155], v12 offset:26624
  ds_read_b64_tr_b16 a[156:157], v12 offset:28672
  ds_read_b64_tr_b16 a[158:159], v12 offset:30720
  ds_read_b64_tr_b16 a[160:161], v12 offset:32768
  ds_read_b64_tr_b16 a[162:163], v12 offset:34816
  ds_read_b64_tr_b16 a[164:165], v12 offset:36864
  ds_read_b64_tr_b16 a[166:167], v12 offset:38912
  ds_read_b64_tr_b16 a[168:169], v12 offset:40960
  ds_read_b64_tr_b16 a[170:171], v12 offset:43008
  ds_read_b64_tr_b16 a[172:173], v12 offset:45056
  ds_read_b64_tr_b16 a[174:175], v12 offset:47104
  ds_read_b64_tr_b16 a[176:177], v12 offset:49152
  ds_read_b64_tr_b16 a[178:179], v12 offset:51200
  ds_read_b64_tr_b16 a[180:181], v12 offset:53248
  ds_read_b64_tr_b16 a[182:183], v12 offset:55296
  ds_read_b64_tr_b16 a[184:185], v12 offset:57344
  ds_read_b64_tr_b16 a[186:187], v12 offset:59392
  ds_read_b64_tr_b16 a[188:189], v12 offset:61440
  ds_read_b64_tr_b16 a[190:191], v12 offset:63488
  s_waitcnt lgkmcnt(0)
  s_barrier
  s_lshl_b32 s42, s28, 14
  s_add_u32 s42, s42, 0
  s_add_u32 m0, s42, 0
  s_mov_b32 s43, 1048576
  buffer_load_dwordx4 v11, s[12:15], s43 offen lds
  s_add_u32 m0, s42, 1024
  s_mov_b32 s43, 1052672
  buffer_load_dwordx4 v11, s[12:15], s43 offen lds
  s_add_u32 m0, s42, 2048
  s_mov_b32 s43, 1056768
  buffer_load_dwordx4 v11, s[12:15], s43 offen lds
  s_add_u32 m0, s42, 3072
  s_mov_b32 s43, 1060864
  buffer_load_dwordx4 v11, s[12:15], s43 offen lds
  s_add_u32 m0, s42, 4096
  s_mov_b32 s43, 1064960
  buffer_load_dwordx4 v11, s[12:15], s43 offen lds
  s_add_u32 m0, s42, 5120
  s_mov_b32 s43, 1069056
  buffer_load_dwordx4 v11, s[12:15], s43 offen lds
  s_add_u32 m0, s42, 6144
  s_mov_b32 s43, 1073152
  buffer_load_dwordx4 v11, s[12:15], s43 offen lds
  s_add_u32 m0, s42, 7168
  s_mov_b32 s43, 1077248
  buffer_load_dwordx4 v11, s[12:15], s43 offen lds
  s_add_u32 m0, s42, 8192
  s_mov_b32 s43, 1081344
  buffer_load_dwordx4 v11, s[12:15], s43 offen lds
  s_add_u32 m0, s42, 9216
  s_mov_b32 s43, 1085440
  buffer_load_dwordx4 v11, s[12:15], s43 offen lds
  s_add_u32 m0, s42, 10240
  s_mov_b32 s43, 1089536
  buffer_load_dwordx4 v11, s[12:15], s43 offen lds
  s_add_u32 m0, s42, 11264
  s_mov_b32 s43, 1093632
  buffer_load_dwordx4 v11, s[12:15], s43 offen lds
  s_add_u32 m0, s42, 12288
  s_mov_b32 s43, 1097728
  buffer_load_dwordx4 v11, s[12:15], s43 offen lds
  s_add_u32 m0, s42, 13312
  s_mov_b32 s43, 1101824
  buffer_load_dwordx4 v11, s[12:15], s43 offen lds
  s_add_u32 m0, s42, 14336
  s_mov_b32 s43, 1105920
  buffer_load_dwordx4 v11, s[12:15], s43 offen lds
  s_add_u32 m0, s42, 15360
  s_mov_b32 s43, 1110016
  buffer_load_dwordx4 v11, s[12:15], s43 offen lds
  s_waitcnt vmcnt(16)
  s_barrier
  ds_read_b64_tr_b16 a[192:193], v13 offset:0
  ds_read_b64_tr_b16 a[194:195], v13 offset:2048
  ds_read_b64_tr_b16 a[196:197], v13 offset:4096
  ds_read_b64_tr_b16 a[198:199], v13 offset:6144
  ds_read_b64_tr_b16 a[200:201], v13 offset:8192
  ds_read_b64_tr_b16 a[202:203], v13 offset:10240
  ds_read_b64_tr_b16 a[204:205], v13 offset:12288
  ds_read_b64_tr_b16 a[206:207], v13 offset:14336
  ds_read_b64_tr_b16 a[208:209], v13 offset:16384
  ds_read_b64_tr_b16 a[210:211], v13 offset:18432
  ds_read_b64_tr_b16 a[212:213], v13 offset:20480
  ds_read_b64_tr_b16 a[214:215], v13 offset:22528
  ds_read_b64_tr_b16 a[216:217], v13 offset:24576
  ds_read_b64_tr_b16 a[218:219], v13 offset:26624
  ds_read_b64_tr_b16 a[220:221], v13 offset:28672
  ds_read_b64_tr_b16 a[222:223], v13 offset:30720
  ds_read_b64_tr_b16 a[224:225], v13 offset:32768
  ds_read_b64_tr_b16 a[226:227], v13 offset:34816
  ds_read_b64_tr_b16 a[228:229], v13 offset:36864
  ds_read_b64_tr_b16 a[230:231], v13 offset:38912
  ds_read_b64_tr_b16 a[232:233], v13 offset:40960
  ds_read_b64_tr_b16 a[234:235], v13 offset:43008
  ds_read_b64_tr_b16 a[236:237], v13 offset:45056
  ds_read_b64_tr_b16 a[238:239], v13 offset:47104
  ds_read_b64_tr_b16 a[240:241], v13 offset:49152
  ds_read_b64_tr_b16 a[242:243], v13 offset:51200
  ds_read_b64_tr_b16 a[244:245], v13 offset:53248
  ds_read_b64_tr_b16 a[246:247], v13 offset:55296
  ds_read_b64_tr_b16 a[248:249], v13 offset:57344
  ds_read_b64_tr_b16 a[250:251], v13 offset:59392
  ds_read_b64_tr_b16 a[252:253], v13 offset:61440
  ds_read_b64_tr_b16 a[254:255], v13 offset:63488
  s_waitcnt lgkmcnt(0)
  s_barrier
  s_lshl_b32 s42, s28, 14
  s_add_u32 s42, s42, 65536
  s_add_u32 m0, s42, 0
  s_mov_b32 s43, 1146880
  buffer_load_dwordx4 v11, s[12:15], s43 offen lds
  s_add_u32 m0, s42, 1024
  s_mov_b32 s43, 1150976
  buffer_load_dwordx4 v11, s[12:15], s43 offen lds
  s_add_u32 m0, s42, 2048
  s_mov_b32 s43, 1155072
  buffer_load_dwordx4 v11, s[12:15], s43 offen lds
  s_add_u32 m0, s42, 3072
  s_mov_b32 s43, 1159168
  buffer_load_dwordx4 v11, s[12:15], s43 offen lds
  s_add_u32 m0, s42, 4096
  s_mov_b32 s43, 1163264
  buffer_load_dwordx4 v11, s[12:15], s43 offen lds
  s_add_u32 m0, s42, 5120
  s_mov_b32 s43, 1167360
  buffer_load_dwordx4 v11, s[12:15], s43 offen lds
  s_add_u32 m0, s42, 6144
  s_mov_b32 s43, 1171456
  buffer_load_dwordx4 v11, s[12:15], s43 offen lds
  s_add_u32 m0, s42, 7168
  s_mov_b32 s43, 1175552
  buffer_load_dwordx4 v11, s[12:15], s43 offen lds
  s_add_u32 m0, s42, 8192
  s_mov_b32 s43, 1179648
  buffer_load_dwordx4 v11, s[12:15], s43 offen lds
  s_add_u32 m0, s42, 9216
  s_mov_b32 s43, 1183744
  buffer_load_dwordx4 v11, s[12:15], s43 offen lds
  s_add_u32 m0, s42, 10240
  s_mov_b32 s43, 1187840
  buffer_load_dwordx4 v11, s[12:15], s43 offen lds
  s_add_u32 m0, s42, 11264
  s_mov_b32 s43, 1191936
  buffer_load_dwordx4 v11, s[12:15], s43 offen lds
  s_add_u32 m0, s42, 12288
  s_mov_b32 s43, 1196032
  buffer_load_dwordx4 v11, s[12:15], s43 offen lds
  s_add_u32 m0, s42, 13312
  s_mov_b32 s43, 1200128
  buffer_load_dwordx4 v11, s[12:15], s43 offen lds
  s_add_u32 m0, s42, 14336
  s_mov_b32 s43, 1204224
  buffer_load_dwordx4 v11, s[12:15], s43 offen lds
  s_add_u32 m0, s42, 15360
  s_mov_b32 s43, 1208320
  buffer_load_dwordx4 v11, s[12:15], s43 offen lds
  s_waitcnt vmcnt(16)
  s_barrier
  ds_read_b64_tr_b16 v[128:129], v12 offset:0
  ds_read_b64_tr_b16 v[130:131], v12 offset:2048
  ds_read_b64_tr_b16 v[132:133], v12 offset:4096
  ds_read_b64_tr_b16 v[134:135], v12 offset:6144
  ds_read_b64_tr_b16 v[136:137], v12 offset:8192
  ds_read_b64_tr_b16 v[138:139], v12 offset:10240
  ds_read_b64_tr_b16 v[140:141], v12 offset:12288
  ds_read_b64_tr_b16 v[142:143], v12 offset:14336
  ds_read_b64_tr_b16 v[144:145], v12 offset:16384
  ds_read_b64_tr_b16 v[146:147], v12 offset:18432
  ds_read_b64_tr_b16 v[148:149], v12 offset:20480
  ds_read_b64_tr_b16 v[150:151], v12 offset:22528
  ds_read_b64_tr_b16 v[152:153], v12 offset:24576
  ds_read_b64_tr_b16 v[154:155], v12 offset:26624
  ds_read_b64_tr_b16 v[156:157], v12 offset:28672
  ds_read_b64_tr_b16 v[158:159], v12 offset:30720
  ds_read_b64_tr_b16 v[160:161], v12 offset:32768
  ds_read_b64_tr_b16 v[162:163], v12 offset:34816
  ds_read_b64_tr_b16 v[164:165], v12 offset:36864
  ds_read_b64_tr_b16 v[166:167], v12 offset:38912
  ds_read_b64_tr_b16 v[168:169], v12 offset:40960
  ds_read_b64_tr_b16 v[170:171], v12 offset:43008
  ds_read_b64_tr_b16 v[172:173], v12 offset:45056
  ds_read_b64_tr_b16 v[174:175], v12 offset:47104
  ds_read_b64_tr_b16 v[176:177], v12 offset:49152
  ds_read_b64_tr_b16 v[178:179], v12 offset:51200
  ds_read_b64_tr_b16 v[180:181], v12 offset:53248
  ds_read_b64_tr_b16 v[182:183], v12 offset:55296
  ds_read_b64_tr_b16 v[184:185], v12 offset:57344
  ds_read_b64_tr_b16 v[186:187], v12 offset:59392
  ds_read_b64_tr_b16 v[188:189], v12 offset:61440
  ds_read_b64_tr_b16 v[190:191], v12 offset:63488
  s_waitcnt lgkmcnt(0)
  s_barrier
  s_waitcnt vmcnt(0)
  s_barrier
  ds_read_b64_tr_b16 v[192:193], v13 offset:40960
  ds_read_b64_tr_b16 v[194:195], v13 offset:43008
  ds_read_b64_tr_b16 v[196:197], v13 offset:45056
  ds_read_b64_tr_b16 v[198:199], v13 offset:47104
  ds_read_b64_tr_b16 v[200:201], v13 offset:49152
  ds_read_b64_tr_b16 v[202:203], v13 offset:51200
  ds_read_b64_tr_b16 v[204:205], v13 offset:53248
  ds_read_b64_tr_b16 v[206:207], v13 offset:55296
  ds_read_b64_tr_b16 v[208:209], v13 offset:57344
  ds_read_b64_tr_b16 v[210:211], v13 offset:59392
  ds_read_b64_tr_b16 v[212:213], v13 offset:61440
  ds_read_b64_tr_b16 v[214:215], v13 offset:63488
  s_waitcnt lgkmcnt(0)
  s_barrier
  v_and_b32 v11, 7, v1
  v_lshlrev_b32 v11, 2, v11
  s_mov_b32 s42, 0
vf_29:
  buffer_load_dword v10, v11, s[8:11], 0 offen sc0 sc1
  s_add_u32 s42, s42, 1
  s_waitcnt vmcnt(0)
  v_readlane_b32 s43, v10, s31
  v_lshrrev_b32 v10, 22, v10
  v_cmp_ne_u32 vcc, 32, v10
  s_cbranch_vccz vk_30
  s_movk_i32 s41, 1
  s_cmp_gt_u32 s42, 262144
  s_cbranch_scc1 L_fail
  s_sleep 2
  s_branch vf_29
vk_30:
  s_and_b32 s40, s43, 0x1ff
  s_mul_i32 s40, s40, s40
  s_bfe_u32 s41, s43, 0xd0009
  s_lshl_b32 s41, s41, 5
  s_cmp_eq_u32 s40, s41
  s_cselect_b32 s47, 1, 0
  v_min_u32 v9, 42, v1
  v_lshlrev_b32 v9, 2, v9
  s_lshl_b32 s52, s50, 2
  s_add_u32 s52, s52, s28
  s_lshl_b32 s51, s52, 11
  s_lshl_b32 s40, s52, 6
  s_lshl_b32 s52, s52, 2
  v_bfe_u32 v8, v1, 0, 5
  v_lshlrev_b32 v8, 10, v8
  v_bfe_u32 v10, v1, 5, 1
  v_lshl_add_u32 v8, v10, 4, v8
  v_add_u32 v8, s40, v8
  v_bfe_u32 v11, v1, 0, 4
  v_lshlrev_b32 v11, 7, v11
  s_max_i32 s40, s35, 0
  s_lshl_b32 s40, s40, 15
  s_add_u32 s40, s40, s51
  s_add_u32 s40, s40, 199229440
  buffer_load_dword v15, v11, s[4:7], s40 offen
  s_lshl_b32 s48, s28, 10
  v_add_u32 v6, s48, v2
  v_mov_b32 v5, v2
  v_add_u32 v7, 0x10000, v2
  s_mov_b32 s38, 0
  s_add_u32 s36, s35, 2
  s_cmp_lt_u32 s36, s34
  s_cselect_b32 s36, s36, -1
  s_cmp_lt_i32 s35, 0
  s_cselect_b32 s36, -1, s36
  s_mov_b32 s58, 0
  s_mov_b32 s57, 0
  v_mov_b32 v14, 0
  s_lshl_b32 s59, s29, 7
  s_add_u32 s59, s59, 491520
L_FB_get:
  s_lshl_b32 s43, s35, 9
  s_add_u32 s43, s43, 393216
  s_mov_b32 s40, 0
poll_31:
  buffer_load_dword v10, v9, s[4:7], s43 offen sc1
  s_add_u32 s40, s40, 1
  s_waitcnt vmcnt(0)
  v_cmp_eq_u32 vcc, 0, v10
  s_cbranch_vccz pd_32
  s_movk_i32 s41, 26
  s_cmp_gt_u32 s40, 262144
  s_cbranch_scc1 L_fail
  s_sleep 1
  s_branch poll_31
pd_32:
L_FB_g2:
  s_mul_i32 s39, s35, 98304
  s_add_u32 s39, s39, 52428800
  s_xor_b32 s42, s38, 0
  s_add_u32 m0, s42, s48
  s_nop 0
  buffer_load_dwordx4 v6, s[4:7], s39 offen sc1 lds
  s_add_u32 m0, m0, 4096
  s_add_u32 s39, s39, 4096
  buffer_load_dwordx4 v6, s[4:7], s39 offen sc1 lds
  s_add_u32 m0, m0, 4096
  s_add_u32 s39, s39, 4096
  buffer_load_dwordx4 v6, s[4:7], s39 offen sc1 lds
  s_add_u32 m0, m0, 4096
  s_add_u32 s39, s39, 4096
  buffer_load_dwordx4 v6, s[4:7], s39 offen sc1 lds
  s_add_u32 m0, m0, 4096
  s_add_u32 s39, s39, 4096
  buffer_load_dwordx4 v6, s[4:7], s39 offen sc1 lds
  s_add_u32 m0, m0, 4096
  s_add_u32 s39, s39, 4096
  buffer_load_dwordx4 v6, s[4:7], s39 offen sc1 lds
  s_add_u32 m0, m0, 4096
  s_add_u32 s39, s39, 4096
  buffer_load_dwordx4 v6, s[4:7], s39 offen sc1 lds
  s_add_u32 m0, m0, 4096
  s_add_u32 s39, s39, 4096
  buffer_load_dwordx4 v6, s[4:7], s39 offen sc1 lds
  s_add_u32 m0, m0, 4096
  s_add_u32 s39, s39, 4096
  s_lshl_b32 s53, s35, 15
  s_add_u32 s53, s53, s51
  s_add_u32 s40, s53, 10485760
  buffer_load_dwordx4 v[96:99], v2, s[4:7], s40 offen offset:0 sc1
  buffer_load_dwordx4 v[100:103], v2, s[4:7], s40 offen offset:1024 sc1
  s_max_i32 s40, s36, 0
  s_lshl_b32 s40, s40, 15
  s_add_u32 s40, s40, s51
  s_add_u32 s40, s40, 199229440
  buffer_load_dword v15, v11, s[4:7], s40 offen
  s_waitcnt vmcnt(7)
  s_barrier
  ds_read_b128 v[16:19], v5 offset:0
  ds_read_b128 v[20:23], v5 offset:1024
  ds_read_b128 v[24:27], v5 offset:2048
  ds_read_b128 v[28:31], v5 offset:3072
  ds_read_b128 v[32:35], v5 offset:4096
  ds_read_b128 v[36:39], v5 offset:5120
  ds_read_b128 v[40:43], v5 offset:6144
  ds_read_b128 v[44:47], v5 offset:7168
  s_waitcnt lgkmcnt(7)
  v_mfma_f32_32x32x16_bf16 v[64:79], a[0:3], v[16:19], 0
  ds_read_b128 v[16:19], v5 offset:8192
  buffer_load_dwordx4 v6, s[4:7], s39 offen sc1 lds
  s_add_u32 m0, m0, 4096
  s_add_u32 s39, s39, 4096
  s_waitcnt lgkmcnt(7)
  v_mfma_f32_32x32x16_bf16 v[80:95], a[4:7], v[20:23], 0
  ds_read_b128 v[20:23], v5 offset:9216
  s_waitcnt lgkmcnt(7)
  v_mfma_f32_32x32x16_bf16 v[64:79], a[8:11], v[24:27], v[64:79]
  ds_read_b128 v[24:27], v5 offset:10240
  buffer_load_dwordx4 v6, s[4:7], s39 offen sc1 lds
  s_add_u32 m0, m0, 4096
  s_add_u32 s39, s39, 4096
  s_waitcnt lgkmcnt(7)
  v_mfma_f32_32x32x16_bf16 v[80:95], a[12:15], v[28:31], v[80:95]
  ds_read_b128 v[28:31], v5 offset:11264
  s_waitcnt lgkmcnt(7)
  v_mfma_f32_32x32x16_bf16 v[64:79], a[16:19], v[32:35], v[64:79]
  ds_read_b128 v[32:35], v5 offset:12288
  buffer_load_dwordx4 v6, s[4:7], s39 offen sc1 lds
  s_add_u32 m0, m0, 4096
  s_add_u32 s39, s39, 4096
  s_waitcnt lgkmcnt(7)
  v_mfma_f32_32x32x16_bf16 v[80:95], a[20:23], v[36:39], v[80:95]
  ds_read_b128 v[36:39], v5 offset:13312
  s_waitcnt lgkmcnt(7)
  v_mfma_f32_32x32x16_bf16 v[64:79], a[24:27], v[40:43], v[64:79]
  ds_read_b128 v[40:43], v5 offset:14336
  buffer_load_dwordx4 v6, s[4:7], s39 offen sc1 lds
  s_add_u32 m0, m0, 4096
  s_add_u32 s39, s39, 4096
  s_waitcnt lgkmcnt(7)
  v_mfma_f32_32x32x16_bf16 v[80:95], a[28:31], v[44:47], v[80:95]
  ds_read_b128 v[44:47], v5 offset:15360
  s_waitcnt vmcnt(7)
  s_barrier
  s_waitcnt lgkmcnt(7)
  v_mfma_f32_32x32x16_bf16 v[64:79], a[32:35], v[16:19], v[64:79]
  ds_read_b128 v[16:19], v5 offset:16384
  buffer_load_dwordx4 v6, s[4:7], s39 offen sc1 lds
  s_add_u32 m0, m0, 4096
  s_add_u32 s39, s39, 4096
  s_waitcnt lgkmcnt(7)
  v_mfma_f32_32x32x16_bf16 v[80:95], a[36:39], v[20:23], v[80:95]
  ds_read_b128 v[20:23], v5 offset:17408
  s_waitcnt lgkmcnt(7)
  v_mfma_f32_32x32x16_bf16 v[64:79], a[40:43], v[24:27], v[64:79]
  ds_read_b128 v[24:27], v5 offset:18432
  buffer_load_dwordx4 v6, s[4:7], s39 offen sc1 lds
  s_add_u32 m0, m0, 4096
  s_add_u32 s39, s39, 4096
  s_waitcnt lgkmcnt(7)
  v_mfma_f32_32x32x16_bf16 v[80:95], a[44:47], v[28:31], v[80:95]
  ds_read_b128 v[28:31], v5 offset:19456
  s_waitcnt lgkmcnt(7)
  v_mfma_f32_32x32x16_bf16 v[64:79], a[48:51], v[32:35], v[64:79]
  ds_read_b128 v[32:35], v5 offset:20480
  buffer_load_dwordx4 v6, s[4:7], s39 offen sc1 lds
  s_add_u32 m0, m0, 4096
  s_add_u32 s39, s39, 4096
  s_waitcnt lgkmcnt(7)
  v_mfma_f32_32x32x16_bf16 v[80:95], a[52:55], v[36:39], v[80:95]
  ds_read_b128 v[36:39], v5 offset:21504
  s_waitcnt lgkmcnt(7)
  v_mfma_f32_32x32x16_bf16 v[64:79], a[56:59], v[40:43], v[64:79]
  ds_read_b128 v[40:43], v5 offset:22528
  buffer_load_dwordx4 v6, s[4:7], s39 offen sc1 lds
  s_add_u32 m0, m0, 4096
  s_add_u32 s39, s39, 4096
  s_waitcnt lgkmcnt(7)
  v_mfma_f32_32x32x16_bf16 v[80:95], a[60:63], v[44:47], v[80:95]
  ds_read_b128 v[44:47], v5 offset:23552
  s_waitcnt lgkmcnt(7)
  v_mfma_f32_32x32x16_bf16 v[64:79], a[64:67], v[16:19], v[64:79]
  ds_read_b128 v[16:19], v5 offset:24576
  buffer_load_dwordx4 v6, s[4:7], s39 offen sc1 lds
  s_add_u32 m0, m0, 4096
  s_add_u32 s39, s39, 4096
  s_waitcnt lgkmcnt(7)
  v_mfma_f32_32x32x16_bf16 v[80:95], a[68:71], v[20:23], v[80:95]
  ds_read_b128 v[20:23], v5 offset:25600
  s_waitcnt lgkmcnt(7)
  v_mfma_f32_32x32x16_bf16 v[64:79], a[72:75], v[24:27], v[64:79]
  ds_read_b128 v[24:27], v5 offset:26624
  buffer_load_dwordx4 v6, s[4:7], s39 offen sc1 lds
  s_add_u32 m0, m0, 4096
  s_add_u32 s39, s39, 4096
  s_waitcnt lgkmcnt(7)
  v_mfma_f32_32x32x16_bf16 v[80:95], a[76:79], v[28:31], v[80:95]
  ds_read_b128 v[28:31], v5 offset:27648
  s_waitcnt lgkmcnt(7)
  v_mfma_f32_32x32x16_bf16 v[64:79], a[80:83], v[32:35], v[64:79]
  ds_read_b128 v[32:35], v5 offset:28672
  buffer_load_dwordx4 v6, s[4:7], s39 offen sc1 lds
  s_add_u32 m0, m0, 4096
  s_add_u32 s39, s39, 4096
  s_waitcnt lgkmcnt(7)
  v_mfma_f32_32x32x16_bf16 v[80:95], a[84:87], v[36:39], v[80:95]
  ds_read_b128 v[36:39], v5 offset:29696
  s_waitcnt lgkmcnt(7)
  v_mfma_f32_32x32x16_bf16 v[64:79], a[88:91], v[40:43], v[64:79]
  ds_read_b128 v[40:43], v5 offset:30720
  buffer_load_dwordx4 v6, s[4:7], s39 offen sc1 lds
  s_add_u32 m0, m0, 4096
  s_add_u32 s39, s39, 4096
  s_waitcnt lgkmcnt(7)
  v_mfma_f32_32x32x16_bf16 v[80:95], a[92:95], v[44:47], v[80:95]
  ds_read_b128 v[44:47], v5 offset:31744
  s_waitcnt vmcnt(8)
  s_barrier
  s_waitcnt lgkmcnt(7)
  v_mfma_f32_32x32x16_bf16 v[64:79], a[96:99], v[16:19], v[64:79]
  ds_read_b128 v[16:19], v5 offset:32768
  buffer_load_dwordx4 v6, s[4:7], s39 offen sc1 lds
  s_add_u32 m0, m0, 4096
  s_add_u32 s39, s39, 4096
  s_waitcnt lgkmcnt(7)
  v_mfma_f32_32x32x16_bf16 v[80:95], a[100:103], v[20:23], v[80:95]
  ds_read_b128 v[20:23], v5 offset:33792
  s_waitcnt lgkmcnt(7)
  v_mfma_f32_32x32x16_bf16 v[64:79], a[104:107], v[24:27], v[64:79]
  ds_read_b128 v[24:27], v5 offset:34816
  buffer_load_dwordx4 v6, s[4:7], s39 offen sc1 lds
  s_add_u32 m0, m0, 4096
  s_add_u32 s39, s39, 4096
  s_waitcnt lgkmcnt(7)
  v_mfma_f32_32x32x16_bf16 v[80:95], a[108:111], v[28:31], v[80:95]
  ds_read_b128 v[28:31], v5 offset:35840
  s_waitcnt lgkmcnt(7)
  v_mfma_f32_32x32x16_bf16 v[64:79], a[112:115], v[32:35], v[64:79]
  ds_read_b128 v[32:35], v5 offset:36864
  s_waitcnt lgkmcnt(7)
  v_mfma_f32_32x32x16_bf16 v[80:95], a[116:119], v[36:39], v[80:95]
  ds_read_b128 v[36:39], v5 offset:37888
  s_waitcnt lgkmcnt(7)
  v_mfma_f32_32x32x16_bf16 v[64:79], a[120:123], v[40:43], v[64:79]
  ds_read_b128 v[40:43], v5 offset:38912
  s_waitcnt lgkmcnt(7)
  v_mfma_f32_32x32x16_bf16 v[80:95], a[124:127], v[44:47], v[80:95]
  ds_read_b128 v[44:47], v5 offset:39936
  s_waitcnt lgkmcnt(7)
  v_mfma_f32_32x32x16_bf16 v[64:79], a[128:131], v[16:19], v[64:79]
  ds_read_b128 v[16:19], v5 offset:40960
  s_waitcnt lgkmcnt(7)
  v_mfma_f32_32x32x16_bf16 v[80:95], a[132:135], v[20:23], v[80:95]
  ds_read_b128 v[20:23], v5 offset:41984
  s_waitcnt lgkmcnt(7)
  v_mfma_f32_32x32x16_bf16 v[64:79], a[136:139], v[24:27], v[64:79]
  ds_read_b128 v[24:27], v5 offset:43008
  s_waitcnt lgkmcnt(7)
  v_mfma_f32_32x32x16_bf16 v[80:95], a[140:143], v[28:31], v[80:95]
  ds_read_b128 v[28:31], v5 offset:44032
  s_waitcnt lgkmcnt(7)
  v_mfma_f32_32x32x16_bf16 v[64:79], a[144:147], v[32:35], v[64:79]
  ds_read_b128 v[32:35], v5 offset:45056
  s_waitcnt lgkmcnt(7)
  v_mfma_f32_32x32x16_bf16 v[80:95], a[148:151], v[36:39], v[80:95]
  ds_read_b128 v[36:39], v5 offset:46080
  s_waitcnt lgkmcnt(7)
  v_mfma_f32_32x32x16_bf16 v[64:79], a[152:155], v[40:43], v[64:79]
  ds_read_b128 v[40:43], v5 offset:47104
  s_waitcnt lgkmcnt(7)
  v_mfma_f32_32x32x16_bf16 v[80:95], a[156:159], v[44:47], v[80:95]
  ds_read_b128 v[44:47], v5 offset:48128
  s_waitcnt vmcnt(6)
  s_barrier
  s_waitcnt lgkmcnt(7)
  v_mfma_f32_32x32x16_bf16 v[64:79], a[160:163], v[16:19], v[64:79]
  ds_read_b128 v[16:19], v5 offset:49152
  s_waitcnt lgkmcnt(7)
  v_mfma_f32_32x32x16_bf16 v[80:95], a[164:167], v[20:23], v[80:95]
  ds_read_b128 v[20:23], v5 offset:50176
  s_waitcnt lgkmcnt(7)
  v_mfma_f32_32x32x16_bf16 v[64:79], a[168:171], v[24:27], v[64:79]
  ds_read_b128 v[24:27], v5 offset:51200
  s_waitcnt lgkmcnt(7)
  v_mfma_f32_32x32x16_bf16 v[80:95], a[172:175], v[28:31], v[80:95]
  ds_read_b128 v[28:31], v5 offset:52224
  s_waitcnt lgkmcnt(7)
  v_mfma_f32_32x32x16_bf16 v[64:79], a[176:179], v[32:35], v[64:79]
  ds_read_b128 v[32:35], v5 offset:53248
  s_waitcnt lgkmcnt(7)
  v_mfma_f32_32x32x16_bf16 v[80:95], a[180:183], v[36:39], v[80:95]
  ds_read_b128 v[36:39], v5 offset:54272
  s_waitcnt lgkmcnt(7)
  v_mfma_f32_32x32x16_bf16 v[64:79], a[184:187], v[40:43], v[64:79]
  ds_read_b128 v[40:43], v5 offset:55296
  s_waitcnt lgkmcnt(7)
  v_mfma_f32_32x32x16_bf16 v[80:95], a[188:191], v[44:47], v[80:95]
  ds_read_b128 v[44:47], v5 offset:56320
  s_waitcnt lgkmcnt(7)
  v_mfma_f32_32x32x16_bf16 v[64:79], a[192:195], v[16:19], v[64:79]
  ds_read_b128 v[16:19], v5 offset:57344
  s_waitcnt lgkmcnt(7)
  v_mfma_f32_32x32x16_bf16 v[80:95], a[196:199], v[20:23], v[80:95]
  ds_read_b128 v[20:23], v5 offset:58368
  s_waitcnt lgkmcnt(7)
  v_mfma_f32_32x32x16_bf16 v[64:79], a[200:203], v[24:27], v[64:79]
  ds_read_b128 v[24:27], v5 offset:59392
  s_waitcnt lgkmcnt(7)
  v_mfma_f32_32x32x16_bf16 v[80:95], a[204:207], v[28:31], v[80:95]
  ds_read_b128 v[28:31], v5 offset:60416
  s_waitcnt lgkmcnt(7)
  v_mfma_f32_32x32x16_bf16 v[64:79], a[208:211], v[32:35], v[64:79]
  ds_read_b128 v[32:35], v5 offset:61440
  s_waitcnt lgkmcnt(7)
  v_mfma_f32_32x32x16_bf16 v[80:95], a[212:215], v[36:39], v[80:95]
  ds_read_b128 v[36:39], v5 offset:62464
  s_waitcnt lgkmcnt(7)
  v_mfma_f32_32x32x16_bf16 v[64:79], a[216:219], v[40:43], v[64:79]
  ds_read_b128 v[40:43], v5 offset:63488
  s_waitcnt lgkmcnt(7)
  v_mfma_f32_32x32x16_bf16 v[80:95], a[220:223], v[44:47], v[80:95]
  ds_read_b128 v[44:47], v5 offset:64512
  s_waitcnt vmcnt(2)
  s_barrier
  s_waitcnt lgkmcnt(7)
  v_mfma_f32_32x32x16_bf16 v[64:79], a[224:227], v[16:19], v[64:79]
  ds_read_b128 v[16:19], v7 offset:0
  s_waitcnt lgkmcnt(7)
  v_mfma_f32_32x32x16_bf16 v[80:95], a[228:231], v[20:23], v[80:95]
  ds_read_b128 v[20:23], v7 offset:1024
  s_waitcnt lgkmcnt(7)
  v_mfma_f32_32x32x16_bf16 v[64:79], a[232:235], v[24:27], v[64:79]
  ds_read_b128 v[24:27], v7 offset:2048
  s_waitcnt lgkmcnt(7)
  v_mfma_f32_32x32x16_bf16 v[80:95], a[236:239], v[28:31], v[80:95]
  ds_read_b128 v[28:31], v7 offset:3072
  s_waitcnt lgkmcnt(7)
  v_mfma_f32_32x32x16_bf16 v[64:79], a[240:243], v[32:35], v[64:79]
  ds_read_b128 v[32:35], v7 offset:4096
  s_waitcnt lgkmcnt(7)
  v_mfma_f32_32x32x16_bf16 v[80:95], a[244:247], v[36:39], v[80:95]
  ds_read_b128 v[36:39], v7 offset:5120
  s_waitcnt lgkmcnt(7)
  v_mfma_f32_32x32x16_bf16 v[64:79], a[248:251], v[40:43], v[64:79]
  ds_read_b128 v[40:43], v7 offset:6144
  s_waitcnt lgkmcnt(7)
  v_mfma_f32_32x32x16_bf16 v[80:95], a[252:255], v[44:47], v[80:95]
  ds_read_b128 v[44:47], v7 offset:7168
  s_waitcnt lgkmcnt(7)
  v_mfma_f32_32x32x16_bf16 v[64:79], v[128:131], v[16:19], v[64:79]
  ds_read_b128 v[16:19], v7 offset:8192
  s_waitcnt lgkmcnt(7)
  v_mfma_f32_32x32x16_bf16 v[80:95], v[132:135], v[20:23], v[80:95]
  ds_read_b128 v[20:23], v7 offset:9216
  s_waitcnt lgkmcnt(7)
  v_mfma_f32_32x32x16_bf16 v[64:79], v[136:139], v[24:27], v[64:79]
  ds_read_b128 v[24:27], v7 offset:10240
  s_waitcnt lgkmcnt(7)
  v_mfma_f32_32x32x16_bf16 v[80:95], v[140:143], v[28:31], v[80:95]
  ds_read_b128 v[28:31], v7 offset:11264
  s_waitcnt lgkmcnt(7)
  v_mfma_f32_32x32x16_bf16 v[64:79], v[144:147], v[32:35], v[64:79]
  ds_read_b128 v[32:35], v7 offset:12288
  s_waitcnt lgkmcnt(7)
  v_mfma_f32_32x32x16_bf16 v[80:95], v[148:151], v[36:39], v[80:95]
  ds_read_b128 v[36:39], v7 offset:13312
  s_waitcnt lgkmcnt(7)
  v_mfma_f32_32x32x16_bf16 v[64:79], v[152:155], v[40:43], v[64:79]
  ds_read_b128 v[40:43], v7 offset:14336
  s_waitcnt lgkmcnt(7)
  v_mfma_f32_32x32x16_bf16 v[80:95], v[156:159], v[44:47], v[80:95]
  ds_read_b128 v[44:47], v7 offset:15360
  s_waitcnt vmcnt(0)
  s_barrier
  s_waitcnt lgkmcnt(7)
  v_mfma_f32_32x32x16_bf16 v[64:79], v[160:163], v[16:19], v[64:79]
  ds_read_b128 v[16:19], v7 offset:16384
  s_waitcnt lgkmcnt(7)
  v_mfma_f32_32x32x16_bf16 v[80:95], v[164:167], v[20:23], v[80:95]
  ds_read_b128 v[20:23], v7 offset:17408
  s_waitcnt lgkmcnt(7)
  v_mfma_f32_32x32x16_bf16 v[64:79], v[168:171], v[24:27], v[64:79]
  ds_read_b128 v[24:27], v7 offset:18432
  s_waitcnt lgkmcnt(7)
  v_mfma_f32_32x32x16_bf16 v[80:95], v[172:175], v[28:31], v[80:95]
  ds_read_b128 v[28:31], v7 offset:19456
  s_waitcnt lgkmcnt(7)
  v_mfma_f32_32x32x16_bf16 v[64:79], v[176:179], v[32:35], v[64:79]
  ds_read_b128 v[32:35], v7 offset:20480
  s_waitcnt lgkmcnt(7)
  v_mfma_f32_32x32x16_bf16 v[80:95], v[180:183], v[36:39], v[80:95]
  ds_read_b128 v[36:39], v7 offset:21504
  s_waitcnt lgkmcnt(7)
  v_mfma_f32_32x32x16_bf16 v[64:79], v[184:187], v[40:43], v[64:79]
  s_waitcnt lgkmcnt(6)
  v_mfma_f32_32x32x16_bf16 v[80:95], v[188:191], v[44:47], v[80:95]
  s_waitcnt lgkmcnt(5)
  v_mfma_f32_32x32x16_bf16 v[64:79], v[192:195], v[16:19], v[64:79]
  s_waitcnt lgkmcnt(4)
  v_mfma_f32_32x32x16_bf16 v[80:95], v[196:199], v[20:23], v[80:95]
  s_add_u32 s56, s36, 2
  s_cmp_lt_u32 s56, s34
  s_cselect_b32 s56, s56, -1
  s_cmp_lt_i32 s36, 0
  s_cselect_b32 s56, -1, s56
  s_waitcnt lgkmcnt(3)
  v_mfma_f32_32x32x16_bf16 v[64:79], v[200:203], v[24:27], v[64:79]
  s_waitcnt lgkmcnt(2)
  v_mfma_f32_32x32x16_bf16 v[80:95], v[204:207], v[28:31], v[80:95]
  s_waitcnt lgkmcnt(1)
  v_mfma_f32_32x32x16_bf16 v[64:79], v[208:211], v[32:35], v[64:79]
  s_waitcnt lgkmcnt(0)
  v_mfma_f32_32x32x16_bf16 v[80:95], v[212:215], v[36:39], v[80:95]
  s_nop 11
  v_pk_add_f32 v[64:65], v[64:65], v[80:81]
  v_pk_add_f32 v[66:67], v[66:67], v[82:83]
  v_pk_add_f32 v[68:69], v[68:69], v[84:85]
  v_pk_add_f32 v[70:71], v[70:71], v[86:87]
  v_pk_add_f32 v[72:73], v[72:73], v[88:89]
  v_pk_add_f32 v[74:75], v[74:75], v[90:91]
  v_pk_add_f32 v[76:77], v[76:77], v[92:93]
  v_pk_add_f32 v[78:79], v[78:79], v[94:95]
  v_cvt_pk_bf16_f32 v48, v64, v65
  v_cvt_pk_bf16_f32 v49, v66, v67
  v_cvt_pk_bf16_f32 v50, v68, v69
  v_cvt_pk_bf16_f32 v51, v70, v71
  v_cvt_pk_bf16_f32 v52, v72, v73
  v_cvt_pk_bf16_f32 v53, v74, v75
  v_cvt_pk_bf16_f32 v54, v76, v77
  v_cvt_pk_bf16_f32 v55, v78, v79
  s_waitcnt vmcnt(0)
  v_lshlrev_b32 v64, 16, v48
  v_and_b32 v65, s45, v48
  v_lshlrev_b32 v66, 16, v96
  v_and_b32 v67, s45, v96
  v_pk_add_f32 v[64:65], v[64:65], v[66:67]
  v_cvt_pk_bf16_f32 v48, v64, v65
  v_lshlrev_b32 v68, 16, v49
  v_and_b32 v69, s45, v49
  v_lshlrev_b32 v70, 16, v97
  v_and_b32 v71, s45, v97
  v_pk_add_f32 v[68:69], v[68:69], v[70:71]
  v_cvt_pk_bf16_f32 v49, v68, v69
  v_lshlrev_b32 v72, 16, v50
  v_and_b32 v73, s45, v50
  v_lshlrev_b32 v74, 16, v98
  v_and_b32 v75, s45, v98
  v_pk_add_f32 v[72:73], v[72:73], v[74:75]
  v_cvt_pk_bf16_f32 v50, v72, v73
  v_lshlrev_b32 v76, 16, v51
  v_and_b32 v77, s45, v51
  v_lshlrev_b32 v78, 16, v99
  v_and_b32 v79, s45, v99
  v_pk_add_f32 v[76:77], v[76:77], v[78:79]
  v_cvt_pk_bf16_f32 v51, v76, v77
  v_lshlrev_b32 v80, 16, v52
  v_and_b32 v81, s45, v52
  v_lshlrev_b32 v82, 16, v100
  v_and_b32 v83, s45, v100
  v_pk_add_f32 v[80:81], v[80:81], v[82:83]
  v_cvt_pk_bf16_f32 v52, v80, v81
  v_lshlrev_b32 v84, 16, v53
  v_and_b32 v85, s45, v53
  v_lshlrev_b32 v86, 16, v101
  v_and_b32 v87, s45, v101
  v_pk_add_f32 v[84:85], v[84:85], v[86:87]
  v_cvt_pk_bf16_f32 v53, v84, v85
  v_lshlrev_b32 v88, 16, v54
  v_and_b32 v89, s45, v54
  v_lshlrev_b32 v90, 16, v102
  v_and_b32 v91, s45, v102
  v_pk_add_f32 v[88:89], v[88:89], v[90:91]
  v_cvt_pk_bf16_f32 v54, v88, v89
  v_lshlrev_b32 v92, 16, v55
  v_and_b32 v93, s45, v55
  v_lshlrev_b32 v94, 16, v103
  v_and_b32 v95, s45, v103
  v_pk_add_f32 v[92:93], v[92:93], v[94:95]
  v_cvt_pk_bf16_f32 v55, v92, v93
  s_cmp_eq_u32 s49, 1
  s_cbranch_scc1 L_FB_out
  s_add_u32 s39, s53, 199229440
  s_cmp_eq_u32 s47, 0
  s_cbranch_scc1 sf_33
  buffer_store_dwordx4 v[48:51], v2, s[4:7], s39 offen offset:0
  buffer_store_dwordx4 v[52:55], v2, s[4:7], s39 offen offset:1024
  s_waitcnt vmcnt(0)
  s_lshl_b32 s40, s35, 9
  s_add_u32 s40, s40, 458752
  s_add_u32 s40, s40, s52
  s_mov_b64 exec, 1
  buffer_store_dword v4, v3, s[4:7], s40 offen
  s_mov_b64 exec, -1
  s_branch se_34
sf_33:
  buffer_store_dwordx4 v[48:51], v2, s[4:7], s39 offen offset:0 sc1
  buffer_store_dwordx4 v[52:55], v2, s[4:7], s39 offen offset:1024 sc1
  s_waitcnt vmcnt(0)
  s_lshl_b32 s40, s35, 9
  s_add_u32 s40, s40, 458752
  s_add_u32 s40, s40, s52
  s_mov_b64 exec, 1
  buffer_store_dword v4, v3, s[4:7], s40 offen sc1
  s_mov_b64 exec, -1
se_34:
  s_branch L_FB_e
L_FB_out:
  s_nop 1
  v_permlane32_swap_b32 v48, v50
  v_permlane32_swap_b32 v49, v51
  v_permlane32_swap_b32 v52, v54
  v_permlane32_swap_b32 v53, v55
  s_sub_u32 s40, s35, 64
  s_lshl_b32 s40, s40, 15
  buffer_store_dwordx4 v[48:51], v8, s[16:19], s40 offen offset:0
  buffer_store_dwordx4 v[52:55], v8, s[16:19], s40 offen offset:32
L_FB_e:
  s_mov_b32 s54, s35
  s_mov_b32 s35, s36
  s_mov_b32 s36, s56
  s_mov_b32 s57, 0
  s_barrier
  s_cmp_lt_i32 s35, 0
  s_cbranch_scc0 L_FB_get
  s_endpgm
J_A:
  s_lshl_b32 s49, s30, 3
  s_add_u32 s49, s49, s46
  s_sub_u32 s49, s49, 16
  s_mul_i32 s49, s49, 3
  s_lshl_b32 s40, s28, 8
  v_bfe_u32 v11, v1, 0, 3
  v_lshlrev_b32 v11, 10, v11
  v_bfe_u32 v10, v1, 4, 2
  v_lshl_add_u32 v11, v10, 5, v11
  v_bfe_u32 v10, v1, 3, 1
  v_lshl_add_u32 v11, v10, 3, v11
  v_add_u32 v11, s40, v11
  s_lshl_b32 s40, s49, 14
  buffer_load_dwordx2 v[128:129], v11, s[12:15], s40 offen offset:0
  buffer_load_dwordx2 v[130:131], v11, s[12:15], s40 offen offset:16
  buffer_load_dwordx2 v[132:133], v11, s[12:15], s40 offen offset:128
  buffer_load_dwordx2 v[134:135], v11, s[12:15], s40 offen offset:144
  s_add_u32 s40, s40, 0x2000
  buffer_load_dwordx2 v[136:137], v11, s[12:15], s40 offen offset:0
  buffer_load_dwordx2 v[138:139], v11, s[12:15], s40 offen offset:16
  buffer_load_dwordx2 v[140:141], v11, s[12:15], s40 offen offset:128
  buffer_load_dwordx2 v[142:143], v11, s[12:15], s40 offen offset:144
  s_add_u32 s40, s40, 0x2000
  buffer_load_dwordx2 v[144:145], v11, s[12:15], s40 offen offset:0
  buffer_load_dwordx2 v[146:147], v11, s[12:15], s40 offen offset:16
  buffer_load_dwordx2 v[148:149], v11, s[12:15], s40 offen offset:128
  buffer_load_dwordx2 v[150:151], v11, s[12:15], s40 offen offset:144
  s_add_u32 s40, s40, 0x2000
  buffer_load_dwordx2 v[152:153], v11, s[12:15], s40 offen offset:0
  buffer_load_dwordx2 v[154:155], v11, s[12:15], s40 offen offset:16
  buffer_load_dwordx2 v[156:157], v11, s[12:15], s40 offen offset:128
  buffer_load_dwordx2 v[158:159], v11, s[12:15], s40 offen offset:144
  s_add_u32 s40, s40, 0x2000
  buffer_load_dwordx2 v[160:161], v11, s[12:15], s40 offen offset:0
  buffer_load_dwordx2 v[162:163], v11, s[12:15], s40 offen offset:16
  buffer_load_dwordx2 v[164:165], v11, s[12:15], s40 offen offset:128
  buffer_load_dwordx2 v[166:167], v11, s[12:15], s40 offen offset:144
  s_add_u32 s40, s40, 0x2000
  buffer_load_dwordx2 v[168:169], v11, s[12:15], s40 offen offset:0
  buffer_load_dwordx2 v[170:171], v11, s[12:15], s40 offen offset:16
  buffer_load_dwordx2 v[172:173], v11, s[12:15], s40 offen offset:128
  buffer_load_dwordx2 v[174:175], v11, s[12:15], s40 offen offset:144
  s_add_u32 s40, s40, 0x2000
  s_lshl_b32 s40, s28, 13
  v_bfe_u32 v5, v1, 3, 3
  v_lshlrev_b32 v5, 9, v5
  v_bfe_u32 v10, v1, 0, 3
  v_lshl_add_u32 v5, v10, 4, v5
  v_add_u32 v5, s40, v5
  v_bfe_u32 v7, v1, 0, 3
  v_lshlrev_b32 v7, 4, v7
  v_add_u32 v7, 131072, v7
  s_lshl_b32 s40, s28, 2
  v_add_u32 v6, s40, v7
  v_add_u32 v8, 4096, v5
  s_add_u32 s40, s49, 0
  s_lshr_b32 s36, s40, 1
  s_lshl_b32 s36, s36, 15
  s_and_b32 s40, s40, 1
  s_lshl_b32 s40, s40, 8
  s_add_u32 s36, s36, s40
  s_add_u32 s36, s36, 2097152
  s_waitcnt vmcnt(16)
  v_lshlrev_b32 v32, 16, v128
  v_and_b32 v33, s45, v128
  v_lshlrev_b32 v34, 16, v129
  v_and_b32 v35, s45, v129
  v_lshlrev_b32 v36, 16, v130
  v_and_b32 v37, s45, v130
  v_lshlrev_b32 v38, 16, v131
  v_and_b32 v39, s45, v131
  v_lshlrev_b32 v40, 16, v132
  v_and_b32 v41, s45, v132
  v_lshlrev_b32 v42, 16, v133
  v_and_b32 v43, s45, v133
  v_lshlrev_b32 v44, 16, v134
  v_and_b32 v45, s45, v134
  v_lshlrev_b32 v46, 16, v135
  v_and_b32 v47, s45, v135
  v_lshlrev_b32 v48, 16, v136
  v_and_b32 v49, s45, v136
  v_lshlrev_b32 v50, 16, v137
  v_and_b32 v51, s45, v137
  v_lshlrev_b32 v52, 16, v138
  v_and_b32 v53, s45, v138
  v_lshlrev_b32 v54, 16, v139
  v_and_b32 v55, s45, v139
  v_lshlrev_b32 v56, 16, v140
  v_and_b32 v57, s45, v140
  v_lshlrev_b32 v58, 16, v141
  v_and_b32 v59, s45, v141
  v_lshlrev_b32 v60, 16, v142
  v_and_b32 v61, s45, v142
  v_lshlrev_b32 v62, 16, v143
  v_and_b32 v63, s45, v143
  v_pk_add_f32 v[64:65], v[32:33], v[34:35]
  v_pk_add_f32 v[66:67], v[36:37], v[38:39]
  v_pk_add_f32 v[64:65], v[64:65], v[40:41]
  v_pk_add_f32 v[66:67], v[66:67], v[42:43]
  v_pk_add_f32 v[64:65], v[64:65], v[44:45]
  v_pk_add_f32 v[66:67], v[66:67], v[46:47]
  v_pk_add_f32 v[64:65], v[64:65], v[66:67]
  v_add_f32 v64, v64, v65
  s_nop 1
  v_add_f32_dpp v64, v64, v64 row_ror:8 row_mask:0xf bank_mask:0xf
  v_mov_b32 v65, v64
  s_nop 1
  v_permlane16_swap_b32 v64, v65
  v_add_f32 v64, v64, v65
  v_mov_b32 v65, v64
  s_nop 1
  v_permlane32_swap_b32 v64, v65
  v_add_f32 v64, v64, v65
  ds_write_b32 v6, v64 offset:0
  v_pk_add_f32 v[72:73], v[48:49], v[50:51]
  v_pk_add_f32 v[74:75], v[52:53], v[54:55]
  v_pk_add_f32 v[72:73], v[72:73], v[56:57]
  v_pk_add_f32 v[74:75], v[74:75], v[58:59]
  v_pk_add_f32 v[72:73], v[72:73], v[60:61]
  v_pk_add_f32 v[74:75], v[74:75], v[62:63]
  v_pk_add_f32 v[72:73], v[72:73], v[74:75]
  v_add_f32 v72, v72, v73
  s_nop 1
  v_add_f32_dpp v72, v72, v72 row_ror:8 row_mask:0xf bank_mask:0xf
  v_mov_b32 v73, v72
  s_nop 1
  v_permlane16_swap_b32 v72, v73
  v_add_f32 v72, v72, v73
  v_mov_b32 v73, v72
  s_nop 1
  v_permlane32_swap_b32 v72, v73
  v_add_f32 v72, v72, v73
  ds_write_b32 v6, v72 offset:128
  s_waitcnt lgkmcnt(0)
  s_barrier
  ds_read_b128 v[64:67], v7 offset:0
  ds_read_b128 v[72:75], v7 offset:128
  s_waitcnt lgkmcnt(0)
  v_add_f32 v64, v64, v65
  v_add_f32 v66, v66, v67
  v_add_f32 v64, v64, v66
  v_mul_f32 v69, 0x3b000000, v64
  v_add_f32 v72, v72, v73
  v_add_f32 v74, v74, v75
  v_add_f32 v72, v72, v74
  v_mul_f32 v77, 0x3b000000, v72
  v_pk_add_f32 v[66:67], v[32:33], v[68:69] op_sel:[0,1] op_sel_hi:[1,1] neg_lo:[0,1] neg_hi:[0,1]
  v_pk_mul_f32 v[64:65], v[66:67], v[66:67]
  v_pk_add_f32 v[66:67], v[34:35], v[68:69] op_sel:[0,1] op_sel_hi:[1,1] neg_lo:[0,1] neg_hi:[0,1]
  v_pk_fma_f32 v[64:65], v[66:67], v[66:67], v[64:65]
  v_pk_add_f32 v[66:67], v[36:37], v[68:69] op_sel:[0,1] op_sel_hi:[1,1] neg_lo:[0,1] neg_hi:[0,1]
  v_pk_fma_f32 v[64:65], v[66:67], v[66:67], v[64:65]
  v_pk_add_f32 v[66:67], v[38:39], v[68:69] op_sel:[0,1] op_sel_hi:[1,1] neg_lo:[0,1] neg_hi:[0,1]
  v_pk_fma_f32 v[64:65], v[66:67], v[66:67], v[64:65]
  v_pk_add_f32 v[66:67], v[40:41], v[68:69] op_sel:[0,1] op_sel_hi:[1,1] neg_lo:[0,1] neg_hi:[0,1]
  v_pk_fma_f32 v[64:65], v[66:67], v[66:67], v[64:65]
  v_pk_add_f32 v[66:67], v[42:43], v[68:69] op_sel:[0,1] op_sel_hi:[1,1] neg_lo:[0,1] neg_hi:[0,1]
  v_pk_fma_f32 v[64:65], v[66:67], v[66:67], v[64:65]
  v_pk_add_f32 v[66:67], v[44:45], v[68:69] op_sel:[0,1] op_sel_hi:[1,1] neg_lo:[0,1] neg_hi:[0,1]
  v_pk_fma_f32 v[64:65], v[66:67], v[66:67], v[64:65]
  v_pk_add_f32 v[66:67], v[46:47], v[68:69] op_sel:[0,1] op_sel_hi:[1,1] neg_lo:[0,1] neg_hi:[0,1]
  v_pk_fma_f32 v[64:65], v[66:67], v[66:67], v[64:65]
  v_add_f32 v64, v64, v65
  s_nop 1
  v_add_f32_dpp v64, v64, v64 row_ror:8 row_mask:0xf bank_mask:0xf
  v_mov_b32 v65, v64
  s_nop 1
  v_permlane16_swap_b32 v64, v65
  v_add_f32 v64, v64, v65
  v_mov_b32 v65, v64
  s_nop 1
  v_permlane32_swap_b32 v64, v65
  v_add_f32 v64, v64, v65
  ds_write_b32 v6, v64 offset:256
  v_pk_add_f32 v[74:75], v[48:49], v[76:77] op_sel:[0,1] op_sel_hi:[1,1] neg_lo:[0,1] neg_hi:[0,1]
  v_pk_mul_f32 v[72:73], v[74:75], v[74:75]
  v_pk_add_f32 v[74:75], v[50:51], v[76:77] op_sel:[0,1] op_sel_hi:[1,1] neg_lo:[0,1] neg_hi:[0,1]
  v_pk_fma_f32 v[72:73], v[74:75], v[74:75], v[72:73]
  v_pk_add_f32 v[74:75], v[52:53], v[76:77] op_sel:[0,1] op_sel_hi:[1,1] neg_lo:[0,1] neg_hi:[0,1]
  v_pk_fma_f32 v[72:73], v[74:75], v[74:75], v[72:73]
  v_pk_add_f32 v[74:75], v[54:55], v[76:77] op_sel:[0,1] op_sel_hi:[1,1] neg_lo:[0,1] neg_hi:[0,1]
  v_pk_fma_f32 v[72:73], v[74:75], v[74:75], v[72:73]
  v_pk_add_f32 v[74:75], v[56:57], v[76:77] op_sel:[0,1] op_sel_hi:[1,1] neg_lo:[0,1] neg_hi:[0,1]
  v_pk_fma_f32 v[72:73], v[74:75], v[74:75], v[72:73]
  v_pk_add_f32 v[74:75], v[58:59], v[76:77] op_sel:[0,1] op_sel_hi:[1,1] neg_lo:[0,1] neg_hi:[0,1]
  v_pk_fma_f32 v[72:73], v[74:75], v[74:75], v[72:73]
  v_pk_add_f32 v[74:75], v[60:61], v[76:77] op_sel:[0,1] op_sel_hi:[1,1] neg_lo:[0,1] neg_hi:[0,1]
  v_pk_fma_f32 v[72:73], v[74:75], v[74:75], v[72:73]
  v_pk_add_f32 v[74:75], v[62:63], v[76:77] op_sel:[0,1] op_sel_hi:[1,1] neg_lo:[0,1] neg_hi:[0,1]
  v_pk_fma_f32 v[72:73], v[74:75], v[74:75], v[72:73]
  v_add_f32 v72, v72, v73
  s_nop 1
  v_add_f32_dpp v72, v72, v72 row_ror:8 row_mask:0xf bank_mask:0xf
  v_mov_b32 v73, v72
  s_nop 1
  v_permlane16_swap_b32 v72, v73
  v_add_f32 v72, v72, v73
  v_mov_b32 v73, v72
  s_nop 1
  v_permlane32_swap_b32 v72, v73
  v_add_f32 v72, v72, v73
  ds_write_b32 v6, v72 offset:384
  s_waitcnt lgkmcnt(0)
  s_barrier
  ds_read_b128 v[64:67], v7 offset:256
  ds_read_b128 v[72:75], v7 offset:384
  s_waitcnt lgkmcnt(0)
  v_add_f32 v64, v64, v65
  v_add_f32 v66, v66, v67
  v_add_f32 v64, v64, v66
  v_mul_f32 v68, 0x3b000000, v64
  v_add_f32 v72, v72, v73
  v_add_f32 v74, v74, v75
  v_add_f32 v72, v72, v74
  v_mul_f32 v76, 0x3b000000, v72
  v_cvt_pk_bf16_f32 v64, v68, v69
  v_and_b32 v69, s45, v64
  v_lshlrev_b32 v64, 16, v64
  v_add_f32 v64, 0x3727c5ac, v64
  v_cvt_pk_bf16_f32 v64, v64, v64
  v_and_b32 v64, s45, v64
  v_sqrt_f32 v64, v64
  s_nop 0
  v_cvt_pk_bf16_f32 v64, v64, v64
  v_and_b32 v64, s45, v64
  v_rcp_f32 v64, v64
  v_pk_add_f32 v[32:33], v[32:33], v[68:69] op_sel:[0,1] op_sel_hi:[1,1] neg_lo:[0,1] neg_hi:[0,1]
  v_cvt_pk_bf16_f32 v65, v32, v33
  v_lshlrev_b32 v66, 16, v65
  v_and_b32 v67, s45, v65
  v_pk_mul_f32 v[66:67], v[66:67], v[64:65] op_sel_hi:[1,0]
  v_cvt_pk_bf16_f32 v80, v66, v67
  v_pk_add_f32 v[34:35], v[34:35], v[68:69] op_sel:[0,1] op_sel_hi:[1,1] neg_lo:[0,1] neg_hi:[0,1]
  v_cvt_pk_bf16_f32 v65, v34, v35
  v_lshlrev_b32 v66, 16, v65
  v_and_b32 v67, s45, v65
  v_pk_mul_f32 v[66:67], v[66:67], v[64:65] op_sel_hi:[1,0]
  v_cvt_pk_bf16_f32 v81, v66, v67
  v_pk_add_f32 v[36:37], v[36:37], v[68:69] op_sel:[0,1] op_sel_hi:[1,1] neg_lo:[0,1] neg_hi:[0,1]
  v_cvt_pk_bf16_f32 v65, v36, v37
  v_lshlrev_b32 v66, 16, v65
  v_and_b32 v67, s45, v65
  v_pk_mul_f32 v[66:67], v[66:67], v[64:65] op_sel_hi:[1,0]
  v_cvt_pk_bf16_f32 v82, v66, v67
  v_pk_add_f32 v[38:39], v[38:39], v[68:69] op_sel:[0,1] op_sel_hi:[1,1] neg_lo:[0,1] neg_hi:[0,1]
  v_cvt_pk_bf16_f32 v65, v38, v39
  v_lshlrev_b32 v66, 16, v65
  v_and_b32 v67, s45, v65
  v_pk_mul_f32 v[66:67], v[66:67], v[64:65] op_sel_hi:[1,0]
  v_cvt_pk_bf16_f32 v83, v66, v67
  v_pk_add_f32 v[40:41], v[40:41], v[68:69] op_sel:[0,1] op_sel_hi:[1,1] neg_lo:[0,1] neg_hi:[0,1]
  v_cvt_pk_bf16_f32 v65, v40, v41
  v_lshlrev_b32 v66, 16, v65
  v_and_b32 v67, s45, v65
  v_pk_mul_f32 v[66:67], v[66:67], v[64:65] op_sel_hi:[1,0]
  v_cvt_pk_bf16_f32 v84, v66, v67
  v_pk_add_f32 v[42:43], v[42:43], v[68:69] op_sel:[0,1] op_sel_hi:[1,1] neg_lo:[0,1] neg_hi:[0,1]
  v_cvt_pk_bf16_f32 v65, v42, v43
  v_lshlrev_b32 v66, 16, v65
  v_and_b32 v67, s45, v65
  v_pk_mul_f32 v[66:67], v[66:67], v[64:65] op_sel_hi:[1,0]
  v_cvt_pk_bf16_f32 v85, v66, v67
  v_pk_add_f32 v[44:45], v[44:45], v[68:69] op_sel:[0,1] op_sel_hi:[1,1] neg_lo:[0,1] neg_hi:[0,1]
  v_cvt_pk_bf16_f32 v65, v44, v45
  v_lshlrev_b32 v66, 16, v65
  v_and_b32 v67, s45, v65
  v_pk_mul_f32 v[66:67], v[66:67], v[64:65] op_sel_hi:[1,0]
  v_cvt_pk_bf16_f32 v86, v66, v67
  v_pk_add_f32 v[46:47], v[46:47], v[68:69] op_sel:[0,1] op_sel_hi:[1,1] neg_lo:[0,1] neg_hi:[0,1]
  v_cvt_pk_bf16_f32 v65, v46, v47
  v_lshlrev_b32 v66, 16, v65
  v_and_b32 v67, s45, v65
  v_pk_mul_f32 v[66:67], v[66:67], v[64:65] op_sel_hi:[1,0]
  v_cvt_pk_bf16_f32 v87, v66, v67
  v_cvt_pk_bf16_f32 v72, v76, v77
  v_and_b32 v77, s45, v72
  v_lshlrev_b32 v72, 16, v72
  v_add_f32 v72, 0x3727c5ac, v72
  v_cvt_pk_bf16_f32 v72, v72, v72
  v_and_b32 v72, s45, v72
  v_sqrt_f32 v72, v72
  s_nop 0
  v_cvt_pk_bf16_f32 v72, v72, v72
  v_and_b32 v72, s45, v72
  v_rcp_f32 v72, v72
  v_pk_add_f32 v[48:49], v[48:49], v[76:77] op_sel:[0,1] op_sel_hi:[1,1] neg_lo:[0,1] neg_hi:[0,1]
  v_cvt_pk_bf16_f32 v73, v48, v49
  v_lshlrev_b32 v74, 16, v73
  v_and_b32 v75, s45, v73
  v_pk_mul_f32 v[74:75], v[74:75], v[72:73] op_sel_hi:[1,0]
  v_cvt_pk_bf16_f32 v88, v74, v75
  v_pk_add_f32 v[50:51], v[50:51], v[76:77] op_sel:[0,1] op_sel_hi:[1,1] neg_lo:[0,1] neg_hi:[0,1]
  v_cvt_pk_bf16_f32 v73, v50, v51
  v_lshlrev_b32 v74, 16, v73
  v_and_b32 v75, s45, v73
  v_pk_mul_f32 v[74:75], v[74:75], v[72:73] op_sel_hi:[1,0]
  v_cvt_pk_bf16_f32 v89, v74, v75
  v_pk_add_f32 v[52:53], v[52:53], v[76:77] op_sel:[0,1] op_sel_hi:[1,1] neg_lo:[0,1] neg_hi:[0,1]
  v_cvt_pk_bf16_f32 v73, v52, v53
  v_lshlrev_b32 v74, 16, v73
  v_and_b32 v75, s45, v73
  v_pk_mul_f32 v[74:75], v[74:75], v[72:73] op_sel_hi:[1,0]
  v_cvt_pk_bf16_f32 v90, v74, v75
  v_pk_add_f32 v[54:55], v[54:55], v[76:77] op_sel:[0,1] op_sel_hi:[1,1] neg_lo:[0,1] neg_hi:[0,1]
  v_cvt_pk_bf16_f32 v73, v54, v55
  v_lshlrev_b32 v74, 16, v73
  v_and_b32 v75, s45, v73
  v_pk_mul_f32 v[74:75], v[74:75], v[72:73] op_sel_hi:[1,0]
  v_cvt_pk_bf16_f32 v91, v74, v75
  v_pk_add_f32 v[56:57], v[56:57], v[76:77] op_sel:[0,1] op_sel_hi:[1,1] neg_lo:[0,1] neg_hi:[0,1]
  v_cvt_pk_bf16_f32 v73, v56, v57
  v_lshlrev_b32 v74, 16, v73
  v_and_b32 v75, s45, v73
  v_pk_mul_f32 v[74:75], v[74:75], v[72:73] op_sel_hi:[1,0]
  v_cvt_pk_bf16_f32 v92, v74, v75
  v_pk_add_f32 v[58:59], v[58:59], v[76:77] op_sel:[0,1] op_sel_hi:[1,1] neg_lo:[0,1] neg_hi:[0,1]
  v_cvt_pk_bf16_f32 v73, v58, v59
  v_lshlrev_b32 v74, 16, v73
  v_and_b32 v75, s45, v73
  v_pk_mul_f32 v[74:75], v[74:75], v[72:73] op_sel_hi:[1,0]
  v_cvt_pk_bf16_f32 v93, v74, v75
  v_pk_add_f32 v[60:61], v[60:61], v[76:77] op_sel:[0,1] op_sel_hi:[1,1] neg_lo:[0,1] neg_hi:[0,1]
  v_cvt_pk_bf16_f32 v73, v60, v61
  v_lshlrev_b32 v74, 16, v73
  v_and_b32 v75, s45, v73
  v_pk_mul_f32 v[74:75], v[74:75], v[72:73] op_sel_hi:[1,0]
  v_cvt_pk_bf16_f32 v94, v74, v75
  v_pk_add_f32 v[62:63], v[62:63], v[76:77] op_sel:[0,1] op_sel_hi:[1,1] neg_lo:[0,1] neg_hi:[0,1]
  v_cvt_pk_bf16_f32 v73, v62, v63
  v_lshlrev_b32 v74, 16, v73
  v_and_b32 v75, s45, v73
  v_pk_mul_f32 v[74:75], v[74:75], v[72:73] op_sel_hi:[1,0]
  v_cvt_pk_bf16_f32 v95, v74, v75
  buffer_store_dwordx4 v[80:83], v5, s[4:7], s36 offen offset:0 sc1
  buffer_store_dwordx4 v[84:87], v8, s[4:7], s36 offen offset:0 sc1
  buffer_store_dwordx4 v[88:91], v5, s[4:7], s36 offen offset:128 sc1
  buffer_store_dwordx4 v[92:95], v8, s[4:7], s36 offen offset:128 sc1
  s_add_u32 s40, s49, 1
  s_lshr_b32 s36, s40, 1
  s_lshl_b32 s36, s36, 15
  s_and_b32 s40, s40, 1
  s_lshl_b32 s40, s40, 8
  s_add_u32 s36, s36, s40
  s_add_u32 s36, s36, 2097152
  s_waitcnt vmcnt(12)
  v_lshlrev_b32 v32, 16, v144
  v_and_b32 v33, s45, v144
  v_lshlrev_b32 v34, 16, v145
  v_and_b32 v35, s45, v145
  v_lshlrev_b32 v36, 16, v146
  v_and_b32 v37, s45, v146
  v_lshlrev_b32 v38, 16, v147
  v_and_b32 v39, s45, v147
  v_lshlrev_b32 v40, 16, v148
  v_and_b32 v41, s45, v148
  v_lshlrev_b32 v42, 16, v149
  v_and_b32 v43, s45, v149
  v_lshlrev_b32 v44, 16, v150
  v_and_b32 v45, s45, v150
  v_lshlrev_b32 v46, 16, v151
  v_and_b32 v47, s45, v151
  v_lshlrev_b32 v48, 16, v152
  v_and_b32 v49, s45, v152
  v_lshlrev_b32 v50, 16, v153
  v_and_b32 v51, s45, v153
  v_lshlrev_b32 v52, 16, v154
  v_and_b32 v53, s45, v154
  v_lshlrev_b32 v54, 16, v155
  v_and_b32 v55, s45, v155
  v_lshlrev_b32 v56, 16, v156
  v_and_b32 v57, s45, v156
  v_lshlrev_b32 v58, 16, v157
  v_and_b32 v59, s45, v157
  v_lshlrev_b32 v60, 16, v158
  v_and_b32 v61, s45, v158
  v_lshlrev_b32 v62, 16, v159
  v_and_b32 v63, s45, v159
  v_pk_add_f32 v[64:65], v[32:33], v[34:35]
  v_pk_add_f32 v[66:67], v[36:37], v[38:39]
  v_pk_add_f32 v[64:65], v[64:65], v[40:41]
  v_pk_add_f32 v[66:67], v[66:67], v[42:43]
  v_pk_add_f32 v[64:65], v[64:65], v[44:45]
  v_pk_add_f32 v[66:67], v[66:67], v[46:47]
  v_pk_add_f32 v[64:65], v[64:65], v[66:67]
  v_add_f32 v64, v64, v65
  s_nop 1
  v_add_f32_dpp v64, v64, v64 row_ror:8 row_mask:0xf bank_mask:0xf
  v_mov_b32 v65, v64
  s_nop 1
  v_permlane16_swap_b32 v64, v65
  v_add_f32 v64, v64, v65
  v_mov_b32 v65, v64
  s_nop 1
  v_permlane32_swap_b32 v64, v65
  v_add_f32 v64, v64, v65
  ds_write_b32 v6, v64 offset:0
  v_pk_add_f32 v[72:73], v[48:49], v[50:51]
  v_pk_add_f32 v[74:75], v[52:53], v[54:55]
  v_pk_add_f32 v[72:73], v[72:73], v[56:57]
  v_pk_add_f32 v[74:75], v[74:75], v[58:59]
  v_pk_add_f32 v[72:73], v[72:73], v[60:61]
  v_pk_add_f32 v[74:75], v[74:75], v[62:63]
  v_pk_add_f32 v[72:73], v[72:73], v[74:75]
  v_add_f32 v72, v72, v73
  s_nop 1
  v_add_f32_dpp v72, v72, v72 row_ror:8 row_mask:0xf bank_mask:0xf
  v_mov_b32 v73, v72
  s_nop 1
  v_permlane16_swap_b32 v72, v73
  v_add_f32 v72, v72, v73
  v_mov_b32 v73, v72
  s_nop 1
  v_permlane32_swap_b32 v72, v73
  v_add_f32 v72, v72, v73
  ds_write_b32 v6, v72 offset:128
  s_waitcnt lgkmcnt(0)
  s_barrier
  ds_read_b128 v[64:67], v7 offset:0
  ds_read_b128 v[72:75], v7 offset:128
  s_waitcnt lgkmcnt(0)
  v_add_f32 v64, v64, v65
  v_add_f32 v66, v66, v67
  v_add_f32 v64, v64, v66
  v_mul_f32 v69, 0x3b000000, v64
  v_add_f32 v72, v72, v73
  v_add_f32 v74, v74, v75
  v_add_f32 v72, v72, v74
  v_mul_f32 v77, 0x3b000000, v72
  v_pk_add_f32 v[66:67], v[32:33], v[68:69] op_sel:[0,1] op_sel_hi:[1,1] neg_lo:[0,1] neg_hi:[0,1]
  v_pk_mul_f32 v[64:65], v[66:67], v[66:67]
  v_pk_add_f32 v[66:67], v[34:35], v[68:69] op_sel:[0,1] op_sel_hi:[1,1] neg_lo:[0,1] neg_hi:[0,1]
  v_pk_fma_f32 v[64:65], v[66:67], v[66:67], v[64:65]
  v_pk_add_f32 v[66:67], v[36:37], v[68:69] op_sel:[0,1] op_sel_hi:[1,1] neg_lo:[0,1] neg_hi:[0,1]
  v_pk_fma_f32 v[64:65], v[66:67], v[66:67], v[64:65]
  v_pk_add_f32 v[66:67], v[38:39], v[68:69] op_sel:[0,1] op_sel_hi:[1,1] neg_lo:[0,1] neg_hi:[0,1]
  v_pk_fma_f32 v[64:65], v[66:67], v[66:67], v[64:65]
  v_pk_add_f32 v[66:67], v[40:41], v[68:69] op_sel:[0,1] op_sel_hi:[1,1] neg_lo:[0,1] neg_hi:[0,1]
  v_pk_fma_f32 v[64:65], v[66:67], v[66:67], v[64:65]
  v_pk_add_f32 v[66:67], v[42:43], v[68:69] op_sel:[0,1] op_sel_hi:[1,1] neg_lo:[0,1] neg_hi:[0,1]
  v_pk_fma_f32 v[64:65], v[66:67], v[66:67], v[64:65]
  v_pk_add_f32 v[66:67], v[44:45], v[68:69] op_sel:[0,1] op_sel_hi:[1,1] neg_lo:[0,1] neg_hi:[0,1]
  v_pk_fma_f32 v[64:65], v[66:67], v[66:67], v[64:65]
  v_pk_add_f32 v[66:67], v[46:47], v[68:69] op_sel:[0,1] op_sel_hi:[1,1] neg_lo:[0,1] neg_hi:[0,1]
  v_pk_fma_f32 v[64:65], v[66:67], v[66:67], v[64:65]
  v_add_f32 v64, v64, v65
  s_nop 1
  v_add_f32_dpp v64, v64, v64 row_ror:8 row_mask:0xf bank_mask:0xf
  v_mov_b32 v65, v64
  s_nop 1
  v_permlane16_swap_b32 v64, v65
  v_add_f32 v64, v64, v65
  v_mov_b32 v65, v64
  s_nop 1
  v_permlane32_swap_b32 v64, v65
  v_add_f32 v64, v64, v65
  ds_write_b32 v6, v64 offset:256
  v_pk_add_f32 v[74:75], v[48:49], v[76:77] op_sel:[0,1] op_sel_hi:[1,1] neg_lo:[0,1] neg_hi:[0,1]
  v_pk_mul_f32 v[72:73], v[74:75], v[74:75]
  v_pk_add_f32 v[74:75], v[50:51], v[76:77] op_sel:[0,1] op_sel_hi:[1,1] neg_lo:[0,1] neg_hi:[0,1]
  v_pk_fma_f32 v[72:73], v[74:75], v[74:75], v[72:73]
  v_pk_add_f32 v[74:75], v[52:53], v[76:77] op_sel:[0,1] op_sel_hi:[1,1] neg_lo:[0,1] neg_hi:[0,1]
  v_pk_fma_f32 v[72:73], v[74:75], v[74:75], v[72:73]
  v_pk_add_f32 v[74:75], v[54:55], v[76:77] op_sel:[0,1] op_sel_hi:[1,1] neg_lo:[0,1] neg_hi:[0,1]
  v_pk_fma_f32 v[72:73], v[74:75], v[74:75], v[72:73]
  v_pk_add_f32 v[74:75], v[56:57], v[76:77] op_sel:[0,1] op_sel_hi:[1,1] neg_lo:[0,1] neg_hi:[0,1]
  v_pk_fma_f32 v[72:73], v[74:75], v[74:75], v[72:73]
  v_pk_add_f32 v[74:75], v[58:59], v[76:77] op_sel:[0,1] op_sel_hi:[1,1] neg_lo:[0,1] neg_hi:[0,1]
  v_pk_fma_f32 v[72:73], v[74:75], v[74:75], v[72:73]
  v_pk_add_f32 v[74:75], v[60:61], v[76:77] op_sel:[0,1] op_sel_hi:[1,1] neg_lo:[0,1] neg_hi:[0,1]
  v_pk_fma_f32 v[72:73], v[74:75], v[74:75], v[72:73]
  v_pk_add_f32 v[74:75], v[62:63], v[76:77] op_sel:[0,1] op_sel_hi:[1,1] neg_lo:[0,1] neg_hi:[0,1]
  v_pk_fma_f32 v[72:73], v[74:75], v[74:75], v[72:73]
  v_add_f32 v72, v72, v73
  s_nop 1
  v_add_f32_dpp v72, v72, v72 row_ror:8 row_mask:0xf bank_mask:0xf
  v_mov_b32 v73, v72
  s_nop 1
  v_permlane16_swap_b32 v72, v73
  v_add_f32 v72, v72, v73
  v_mov_b32 v73, v72
  s_nop 1
  v_permlane32_swap_b32 v72, v73
  v_add_f32 v72, v72, v73
  ds_write_b32 v6, v72 offset:384
  s_waitcnt lgkmcnt(0)
  s_barrier
  ds_read_b128 v[64:67], v7 offset:256
  ds_read_b128 v[72:75], v7 offset:384
  s_waitcnt lgkmcnt(0)
  v_add_f32 v64, v64, v65
  v_add_f32 v66, v66, v67
  v_add_f32 v64, v64, v66
  v_mul_f32 v68, 0x3b000000, v64
  v_add_f32 v72, v72, v73
  v_add_f32 v74, v74, v75
  v_add_f32 v72, v72, v74
  v_mul_f32 v76, 0x3b000000, v72
  v_cvt_pk_bf16_f32 v64, v68, v69
  v_and_b32 v69, s45, v64
  v_lshlrev_b32 v64, 16, v64
  v_add_f32 v64, 0x3727c5ac, v64
  v_cvt_pk_bf16_f32 v64, v64, v64
  v_and_b32 v64, s45, v64
  v_sqrt_f32 v64, v64
  s_nop 0
  v_cvt_pk_bf16_f32 v64, v64, v64
  v_and_b32 v64, s45, v64
  v_rcp_f32 v64, v64
  v_pk_add_f32 v[32:33], v[32:33], v[68:69] op_sel:[0,1] op_sel_hi:[1,1] neg_lo:[0,1] neg_hi:[0,1]
  v_cvt_pk_bf16_f32 v65, v32, v33
  v_lshlrev_b32 v66, 16, v65
  v_and_b32 v67, s45, v65
  v_pk_mul_f32 v[66:67], v[66:67], v[64:65] op_sel_hi:[1,0]
  v_cvt_pk_bf16_f32 v80, v66, v67
  v_pk_add_f32 v[34:35], v[34:35], v[68:69] op_sel:[0,1] op_sel_hi:[1,1] neg_lo:[0,1] neg_hi:[0,1]
  v_cvt_pk_bf16_f32 v65, v34, v35
  v_lshlrev_b32 v66, 16, v65
  v_and_b32 v67, s45, v65
  v_pk_mul_f32 v[66:67], v[66:67], v[64:65] op_sel_hi:[1,0]
  v_cvt_pk_bf16_f32 v81, v66, v67
  v_pk_add_f32 v[36:37], v[36:37], v[68:69] op_sel:[0,1] op_sel_hi:[1,1] neg_lo:[0,1] neg_hi:[0,1]
  v_cvt_pk_bf16_f32 v65, v36, v37
  v_lshlrev_b32 v66, 16, v65
  v_and_b32 v67, s45, v65
  v_pk_mul_f32 v[66:67], v[66:67], v[64:65] op_sel_hi:[1,0]
  v_cvt_pk_bf16_f32 v82, v66, v67
  v_pk_add_f32 v[38:39], v[38:39], v[68:69] op_sel:[0,1] op_sel_hi:[1,1] neg_lo:[0,1] neg_hi:[0,1]
  v_cvt_pk_bf16_f32 v65, v38, v39
  v_lshlrev_b32 v66, 16, v65
  v_and_b32 v67, s45, v65
  v_pk_mul_f32 v[66:67], v[66:67], v[64:65] op_sel_hi:[1,0]
  v_cvt_pk_bf16_f32 v83, v66, v67
  v_pk_add_f32 v[40:41], v[40:41], v[68:69] op_sel:[0,1] op_sel_hi:[1,1] neg_lo:[0,1] neg_hi:[0,1]
  v_cvt_pk_bf16_f32 v65, v40, v41
  v_lshlrev_b32 v66, 16, v65
  v_and_b32 v67, s45, v65
  v_pk_mul_f32 v[66:67], v[66:67], v[64:65] op_sel_hi:[1,0]
  v_cvt_pk_bf16_f32 v84, v66, v67
  v_pk_add_f32 v[42:43], v[42:43], v[68:69] op_sel:[0,1] op_sel_hi:[1,1] neg_lo:[0,1] neg_hi:[0,1]
  v_cvt_pk_bf16_f32 v65, v42, v43
  v_lshlrev_b32 v66, 16, v65
  v_and_b32 v67, s45, v65
  v_pk_mul_f32 v[66:67], v[66:67], v[64:65] op_sel_hi:[1,0]
  v_cvt_pk_bf16_f32 v85, v66, v67
  v_pk_add_f32 v[44:45], v[44:45], v[68:69] op_sel:[0,1] op_sel_hi:[1,1] neg_lo:[0,1] neg_hi:[0,1]
  v_cvt_pk_bf16_f32 v65, v44, v45
  v_lshlrev_b32 v66, 16, v65
  v_and_b32 v67, s45, v65
  v_pk_mul_f32 v[66:67], v[66:67], v[64:65] op_sel_hi:[1,0]
  v_cvt_pk_bf16_f32 v86, v66, v67
  v_pk_add_f32 v[46:47], v[46:47], v[68:69] op_sel:[0,1] op_sel_hi:[1,1] neg_lo:[0,1] neg_hi:[0,1]
  v_cvt_pk_bf16_f32 v65, v46, v47
  v_lshlrev_b32 v66, 16, v65
  v_and_b32 v67, s45, v65
  v_pk_mul_f32 v[66:67], v[66:67], v[64:65] op_sel_hi:[1,0]
  v_cvt_pk_bf16_f32 v87, v66, v67
  v_cvt_pk_bf16_f32 v72, v76, v77
  v_and_b32 v77, s45, v72
  v_lshlrev_b32 v72, 16, v72
  v_add_f32 v72, 0x3727c5ac, v72
  v_cvt_pk_bf16_f32 v72, v72, v72
  v_and_b32 v72, s45, v72
  v_sqrt_f32 v72, v72
  s_nop 0
  v_cvt_pk_bf16_f32 v72, v72, v72
  v_and_b32 v72, s45, v72
  v_rcp_f32 v72, v72
  v_pk_add_f32 v[48:49], v[48:49], v[76:77] op_sel:[0,1] op_sel_hi:[1,1] neg_lo:[0,1] neg_hi:[0,1]
  v_cvt_pk_bf16_f32 v73, v48, v49
  v_lshlrev_b32 v74, 16, v73
  v_and_b32 v75, s45, v73
  v_pk_mul_f32 v[74:75], v[74:75], v[72:73] op_sel_hi:[1,0]
  v_cvt_pk_bf16_f32 v88, v74, v75
  v_pk_add_f32 v[50:51], v[50:51], v[76:77] op_sel:[0,1] op_sel_hi:[1,1] neg_lo:[0,1] neg_hi:[0,1]
  v_cvt_pk_bf16_f32 v73, v50, v51
  v_lshlrev_b32 v74, 16, v73
  v_and_b32 v75, s45, v73
  v_pk_mul_f32 v[74:75], v[74:75], v[72:73] op_sel_hi:[1,0]
  v_cvt_pk_bf16_f32 v89, v74, v75
  v_pk_add_f32 v[52:53], v[52:53], v[76:77] op_sel:[0,1] op_sel_hi:[1,1] neg_lo:[0,1] neg_hi:[0,1]
  v_cvt_pk_bf16_f32 v73, v52, v53
  v_lshlrev_b32 v74, 16, v73
  v_and_b32 v75, s45, v73
  v_pk_mul_f32 v[74:75], v[74:75], v[72:73] op_sel_hi:[1,0]
  v_cvt_pk_bf16_f32 v90, v74, v75
  v_pk_add_f32 v[54:55], v[54:55], v[76:77] op_sel:[0,1] op_sel_hi:[1,1] neg_lo:[0,1] neg_hi:[0,1]
  v_cvt_pk_bf16_f32 v73, v54, v55
  v_lshlrev_b32 v74, 16, v73
  v_and_b32 v75, s45, v73
  v_pk_mul_f32 v[74:75], v[74:75], v[72:73] op_sel_hi:[1,0]
  v_cvt_pk_bf16_f32 v91, v74, v75
  v_pk_add_f32 v[56:57], v[56:57], v[76:77] op_sel:[0,1] op_sel_hi:[1,1] neg_lo:[0,1] neg_hi:[0,1]
  v_cvt_pk_bf16_f32 v73, v56, v57
  v_lshlrev_b32 v74, 16, v73
  v_and_b32 v75, s45, v73
  v_pk_mul_f32 v[74:75], v[74:75], v[72:73] op_sel_hi:[1,0]
  v_cvt_pk_bf16_f32 v92, v74, v75
  v_pk_add_f32 v[58:59], v[58:59], v[76:77] op_sel:[0,1] op_sel_hi:[1,1] neg_lo:[0,1] neg_hi:[0,1]
  v_cvt_pk_bf16_f32 v73, v58, v59
  v_lshlrev_b32 v74, 16, v73
  v_and_b32 v75, s45, v73
  v_pk_mul_f32 v[74:75], v[74:75], v[72:73] op_sel_hi:[1,0]
  v_cvt_pk_bf16_f32 v93, v74, v75
  v_pk_add_f32 v[60:61], v[60:61], v[76:77] op_sel:[0,1] op_sel_hi:[1,1] neg_lo:[0,1] neg_hi:[0,1]
  v_cvt_pk_bf16_f32 v73, v60, v61
  v_lshlrev_b32 v74, 16, v73
  v_and_b32 v75, s45, v73
  v_pk_mul_f32 v[74:75], v[74:75], v[72:73] op_sel_hi:[1,0]
  v_cvt_pk_bf16_f32 v94, v74, v75
  v_pk_add_f32 v[62:63], v[62:63], v[76:77] op_sel:[0,1] op_sel_hi:[1,1] neg_lo:[0,1] neg_hi:[0,1]
  v_cvt_pk_bf16_f32 v73, v62, v63
  v_lshlrev_b32 v74, 16, v73
  v_and_b32 v75, s45, v73
  v_pk_mul_f32 v[74:75], v[74:75], v[72:73] op_sel_hi:[1,0]
  v_cvt_pk_bf16_f32 v95, v74, v75
  buffer_store_dwordx4 v[80:83], v5, s[4:7], s36 offen offset:0 sc1
  buffer_store_dwordx4 v[84:87], v8, s[4:7], s36 offen offset:0 sc1
  buffer_store_dwordx4 v[88:91], v5, s[4:7], s36 offen offset:128 sc1
  buffer_store_dwordx4 v[92:95], v8, s[4:7], s36 offen offset:128 sc1
  s_add_u32 s40, s49, 2
  s_lshr_b32 s36, s40, 1
  s_lshl_b32 s36, s36, 15
  s_and_b32 s40, s40, 1
  s_lshl_b32 s40, s40, 8
  s_add_u32 s36, s36, s40
  s_add_u32 s36, s36, 2097152
  s_waitcnt vmcnt(8)
  v_lshlrev_b32 v32, 16, v160
  v_and_b32 v33, s45, v160
  v_lshlrev_b32 v34, 16, v161
  v_and_b32 v35, s45, v161
  v_lshlrev_b32 v36, 16, v162
  v_and_b32 v37, s45, v162
  v_lshlrev_b32 v38, 16, v163
  v_and_b32 v39, s45, v163
  v_lshlrev_b32 v40, 16, v164
  v_and_b32 v41, s45, v164
  v_lshlrev_b32 v42, 16, v165
  v_and_b32 v43, s45, v165
  v_lshlrev_b32 v44, 16, v166
  v_and_b32 v45, s45, v166
  v_lshlrev_b32 v46, 16, v167
  v_and_b32 v47, s45, v167
  v_lshlrev_b32 v48, 16, v168
  v_and_b32 v49, s45, v168
  v_lshlrev_b32 v50, 16, v169
  v_and_b32 v51, s45, v169
  v_lshlrev_b32 v52, 16, v170
  v_and_b32 v53, s45, v170
  v_lshlrev_b32 v54, 16, v171
  v_and_b32 v55, s45, v171
  v_lshlrev_b32 v56, 16, v172
  v_and_b32 v57, s45, v172
  v_lshlrev_b32 v58, 16, v173
  v_and_b32 v59, s45, v173
  v_lshlrev_b32 v60, 16, v174
  v_and_b32 v61, s45, v174
  v_lshlrev_b32 v62, 16, v175
  v_and_b32 v63, s45, v175
  v_pk_add_f32 v[64:65], v[32:33], v[34:35]
  v_pk_add_f32 v[66:67], v[36:37], v[38:39]
  v_pk_add_f32 v[64:65], v[64:65], v[40:41]
  v_pk_add_f32 v[66:67], v[66:67], v[42:43]
  v_pk_add_f32 v[64:65], v[64:65], v[44:45]
  v_pk_add_f32 v[66:67], v[66:67], v[46:47]
  v_pk_add_f32 v[64:65], v[64:65], v[66:67]
  v_add_f32 v64, v64, v65
  s_nop 1
  v_add_f32_dpp v64, v64, v64 row_ror:8 row_mask:0xf bank_mask:0xf
  v_mov_b32 v65, v64
  s_nop 1
  v_permlane16_swap_b32 v64, v65
  v_add_f32 v64, v64, v65
  v_mov_b32 v65, v64
  s_nop 1
  v_permlane32_swap_b32 v64, v65
  v_add_f32 v64, v64, v65
  ds_write_b32 v6, v64 offset:0
  v_pk_add_f32 v[72:73], v[48:49], v[50:51]
  v_pk_add_f32 v[74:75], v[52:53], v[54:55]
  v_pk_add_f32 v[72:73], v[72:73], v[56:57]
  v_pk_add_f32 v[74:75], v[74:75], v[58:59]
  v_pk_add_f32 v[72:73], v[72:73], v[60:61]
  v_pk_add_f32 v[74:75], v[74:75], v[62:63]
  v_pk_add_f32 v[72:73], v[72:73], v[74:75]
  v_add_f32 v72, v72, v73
  s_nop 1
  v_add_f32_dpp v72, v72, v72 row_ror:8 row_mask:0xf bank_mask:0xf
  v_mov_b32 v73, v72
  s_nop 1
  v_permlane16_swap_b32 v72, v73
  v_add_f32 v72, v72, v73
  v_mov_b32 v73, v72
  s_nop 1
  v_permlane32_swap_b32 v72, v73
  v_add_f32 v72, v72, v73
  ds_write_b32 v6, v72 offset:128
  s_waitcnt lgkmcnt(0)
  s_barrier
  ds_read_b128 v[64:67], v7 offset:0
  ds_read_b128 v[72:75], v7 offset:128
  s_waitcnt lgkmcnt(0)
  v_add_f32 v64, v64, v65
  v_add_f32 v66, v66, v67
  v_add_f32 v64, v64, v66
  v_mul_f32 v69, 0x3b000000, v64
  v_add_f32 v72, v72, v73
  v_add_f32 v74, v74, v75
  v_add_f32 v72, v72, v74
  v_mul_f32 v77, 0x3b000000, v72
  v_pk_add_f32 v[66:67], v[32:33], v[68:69] op_sel:[0,1] op_sel_hi:[1,1] neg_lo:[0,1] neg_hi:[0,1]
  v_pk_mul_f32 v[64:65], v[66:67], v[66:67]
  v_pk_add_f32 v[66:67], v[34:35], v[68:69] op_sel:[0,1] op_sel_hi:[1,1] neg_lo:[0,1] neg_hi:[0,1]
  v_pk_fma_f32 v[64:65], v[66:67], v[66:67], v[64:65]
  v_pk_add_f32 v[66:67], v[36:37], v[68:69] op_sel:[0,1] op_sel_hi:[1,1] neg_lo:[0,1] neg_hi:[0,1]
  v_pk_fma_f32 v[64:65], v[66:67], v[66:67], v[64:65]
  v_pk_add_f32 v[66:67], v[38:39], v[68:69] op_sel:[0,1] op_sel_hi:[1,1] neg_lo:[0,1] neg_hi:[0,1]
  v_pk_fma_f32 v[64:65], v[66:67], v[66:67], v[64:65]
  v_pk_add_f32 v[66:67], v[40:41], v[68:69] op_sel:[0,1] op_sel_hi:[1,1] neg_lo:[0,1] neg_hi:[0,1]
  v_pk_fma_f32 v[64:65], v[66:67], v[66:67], v[64:65]
  v_pk_add_f32 v[66:67], v[42:43], v[68:69] op_sel:[0,1] op_sel_hi:[1,1] neg_lo:[0,1] neg_hi:[0,1]
  v_pk_fma_f32 v[64:65], v[66:67], v[66:67], v[64:65]
  v_pk_add_f32 v[66:67], v[44:45], v[68:69] op_sel:[0,1] op_sel_hi:[1,1] neg_lo:[0,1] neg_hi:[0,1]
  v_pk_fma_f32 v[64:65], v[66:67], v[66:67], v[64:65]
  v_pk_add_f32 v[66:67], v[46:47], v[68:69] op_sel:[0,1] op_sel_hi:[1,1] neg_lo:[0,1] neg_hi:[0,1]
  v_pk_fma_f32 v[64:65], v[66:67], v[66:67], v[64:65]
  v_add_f32 v64, v64, v65
  s_nop 1
  v_add_f32_dpp v64, v64, v64 row_ror:8 row_mask:0xf bank_mask:0xf
  v_mov_b32 v65, v64
  s_nop 1
  v_permlane16_swap_b32 v64, v65
  v_add_f32 v64, v64, v65
  v_mov_b32 v65, v64
  s_nop 1
  v_permlane32_swap_b32 v64, v65
  v_add_f32 v64, v64, v65
  ds_write_b32 v6, v64 offset:256
  v_pk_add_f32 v[74:75], v[48:49], v[76:77] op_sel:[0,1] op_sel_hi:[1,1] neg_lo:[0,1] neg_hi:[0,1]
  v_pk_mul_f32 v[72:73], v[74:75], v[74:75]
  v_pk_add_f32 v[74:75], v[50:51], v[76:77] op_sel:[0,1] op_sel_hi:[1,1] neg_lo:[0,1] neg_hi:[0,1]
  v_pk_fma_f32 v[72:73], v[74:75], v[74:75], v[72:73]
  v_pk_add_f32 v[74:75], v[52:53], v[76:77] op_sel:[0,1] op_sel_hi:[1,1] neg_lo:[0,1] neg_hi:[0,1]
  v_pk_fma_f32 v[72:73], v[74:75], v[74:75], v[72:73]
  v_pk_add_f32 v[74:75], v[54:55], v[76:77] op_sel:[0,1] op_sel_hi:[1,1] neg_lo:[0,1] neg_hi:[0,1]
  v_pk_fma_f32 v[72:73], v[74:75], v[74:75], v[72:73]
  v_pk_add_f32 v[74:75], v[56:57], v[76:77] op_sel:[0,1] op_sel_hi:[1,1] neg_lo:[0,1] neg_hi:[0,1]
  v_pk_fma_f32 v[72:73], v[74:75], v[74:75], v[72:73]
  v_pk_add_f32 v[74:75], v[58:59], v[76:77] op_sel:[0,1] op_sel_hi:[1,1] neg_lo:[0,1] neg_hi:[0,1]
  v_pk_fma_f32 v[72:73], v[74:75], v[74:75], v[72:73]
  v_pk_add_f32 v[74:75], v[60:61], v[76:77] op_sel:[0,1] op_sel_hi:[1,1] neg_lo:[0,1] neg_hi:[0,1]
  v_pk_fma_f32 v[72:73], v[74:75], v[74:75], v[72:73]
  v_pk_add_f32 v[74:75], v[62:63], v[76:77] op_sel:[0,1] op_sel_hi:[1,1] neg_lo:[0,1] neg_hi:[0,1]
  v_pk_fma_f32 v[72:73], v[74:75], v[74:75], v[72:73]
  v_add_f32 v72, v72, v73
  s_nop 1
  v_add_f32_dpp v72, v72, v72 row_ror:8 row_mask:0xf bank_mask:0xf
  v_mov_b32 v73, v72
  s_nop 1
  v_permlane16_swap_b32 v72, v73
  v_add_f32 v72, v72, v73
  v_mov_b32 v73, v72
  s_nop 1
  v_permlane32_swap_b32 v72, v73
  v_add_f32 v72, v72, v73
  ds_write_b32 v6, v72 offset:384
  s_waitcnt lgkmcnt(0)
  s_barrier
  ds_read_b128 v[64:67], v7 offset:256
  ds_read_b128 v[72:75], v7 offset:384
  s_waitcnt lgkmcnt(0)
  v_add_f32 v64, v64, v65
  v_add_f32 v66, v66, v67
  v_add_f32 v64, v64, v66
  v_mul_f32 v68, 0x3b000000, v64
  v_add_f32 v72, v72, v73
  v_add_f32 v74, v74, v75
  v_add_f32 v72, v72, v74
  v_mul_f32 v76, 0x3b000000, v72
  v_cvt_pk_bf16_f32 v64, v68, v69
  v_and_b32 v69, s45, v64
  v_lshlrev_b32 v64, 16, v64
  v_add_f32 v64, 0x3727c5ac, v64
  v_cvt_pk_bf16_f32 v64, v64, v64
  v_and_b32 v64, s45, v64
  v_sqrt_f32 v64, v64
  s_nop 0
  v_cvt_pk_bf16_f32 v64, v64, v64
  v_and_b32 v64, s45, v64
  v_rcp_f32 v64, v64
  v_pk_add_f32 v[32:33], v[32:33], v[68:69] op_sel:[0,1] op_sel_hi:[1,1] neg_lo:[0,1] neg_hi:[0,1]
  v_cvt_pk_bf16_f32 v65, v32, v33
  v_lshlrev_b32 v66, 16, v65
  v_and_b32 v67, s45, v65
  v_pk_mul_f32 v[66:67], v[66:67], v[64:65] op_sel_hi:[1,0]
  v_cvt_pk_bf16_f32 v80, v66, v67
  v_pk_add_f32 v[34:35], v[34:35], v[68:69] op_sel:[0,1] op_sel_hi:[1,1] neg_lo:[0,1] neg_hi:[0,1]
  v_cvt_pk_bf16_f32 v65, v34, v35
  v_lshlrev_b32 v66, 16, v65
  v_and_b32 v67, s45, v65
  v_pk_mul_f32 v[66:67], v[66:67], v[64:65] op_sel_hi:[1,0]
  v_cvt_pk_bf16_f32 v81, v66, v67
  v_pk_add_f32 v[36:37], v[36:37], v[68:69] op_sel:[0,1] op_sel_hi:[1,1] neg_lo:[0,1] neg_hi:[0,1]
  v_cvt_pk_bf16_f32 v65, v36, v37
  v_lshlrev_b32 v66, 16, v65
  v_and_b32 v67, s45, v65
  v_pk_mul_f32 v[66:67], v[66:67], v[64:65] op_sel_hi:[1,0]
  v_cvt_pk_bf16_f32 v82, v66, v67
  v_pk_add_f32 v[38:39], v[38:39], v[68:69] op_sel:[0,1] op_sel_hi:[1,1] neg_lo:[0,1] neg_hi:[0,1]
  v_cvt_pk_bf16_f32 v65, v38, v39
  v_lshlrev_b32 v66, 16, v65
  v_and_b32 v67, s45, v65
  v_pk_mul_f32 v[66:67], v[66:67], v[64:65] op_sel_hi:[1,0]
  v_cvt_pk_bf16_f32 v83, v66, v67
  v_pk_add_f32 v[40:41], v[40:41], v[68:69] op_sel:[0,1] op_sel_hi:[1,1] neg_lo:[0,1] neg_hi:[0,1]
  v_cvt_pk_bf16_f32 v65, v40, v41
  v_lshlrev_b32 v66, 16, v65
  v_and_b32 v67, s45, v65
  v_pk_mul_f32 v[66:67], v[66:67], v[64:65] op_sel_hi:[1,0]
  v_cvt_pk_bf16_f32 v84, v66, v67
  v_pk_add_f32 v[42:43], v[42:43], v[68:69] op_sel:[0,1] op_sel_hi:[1,1] neg_lo:[0,1] neg_hi:[0,1]
  v_cvt_pk_bf16_f32 v65, v42, v43
  v_lshlrev_b32 v66, 16, v65
  v_and_b32 v67, s45, v65
  v_pk_mul_f32 v[66:67], v[66:67], v[64:65] op_sel_hi:[1,0]
  v_cvt_pk_bf16_f32 v85, v66, v67
  v_pk_add_f32 v[44:45], v[44:45], v[68:69] op_sel:[0,1] op_sel_hi:[1,1] neg_lo:[0,1] neg_hi:[0,1]
  v_cvt_pk_bf16_f32 v65, v44, v45
  v_lshlrev_b32 v66, 16, v65
  v_and_b32 v67, s45, v65
  v_pk_mul_f32 v[66:67], v[66:67], v[64:65] op_sel_hi:[1,0]
  v_cvt_pk_bf16_f32 v86, v66, v67
  v_pk_add_f32 v[46:47], v[46:47], v[68:69] op_sel:[0,1] op_sel_hi:[1,1] neg_lo:[0,1] neg_hi:[0,1]
  v_cvt_pk_bf16_f32 v65, v46, v47
  v_lshlrev_b32 v66, 16, v65
  v_and_b32 v67, s45, v65
  v_pk_mul_f32 v[66:67], v[66:67], v[64:65] op_sel_hi:[1,0]
  v_cvt_pk_bf16_f32 v87, v66, v67
  v_cvt_pk_bf16_f32 v72, v76, v77
  v_and_b32 v77, s45, v72
  v_lshlrev_b32 v72, 16, v72
  v_add_f32 v72, 0x3727c5ac, v72
  v_cvt_pk_bf16_f32 v72, v72, v72
  v_and_b32 v72, s45, v72
  v_sqrt_f32 v72, v72
  s_nop 0
  v_cvt_pk_bf16_f32 v72, v72, v72
  v_and_b32 v72, s45, v72
  v_rcp_f32 v72, v72
  v_pk_add_f32 v[48:49], v[48:49], v[76:77] op_sel:[0,1] op_sel_hi:[1,1] neg_lo:[0,1] neg_hi:[0,1]
  v_cvt_pk_bf16_f32 v73, v48, v49
  v_lshlrev_b32 v74, 16, v73
  v_and_b32 v75, s45, v73
  v_pk_mul_f32 v[74:75], v[74:75], v[72:73] op_sel_hi:[1,0]
  v_cvt_pk_bf16_f32 v88, v74, v75
  v_pk_add_f32 v[50:51], v[50:51], v[76:77] op_sel:[0,1] op_sel_hi:[1,1] neg_lo:[0,1] neg_hi:[0,1]
  v_cvt_pk_bf16_f32 v73, v50, v51
  v_lshlrev_b32 v74, 16, v73
  v_and_b32 v75, s45, v73
  v_pk_mul_f32 v[74:75], v[74:75], v[72:73] op_sel_hi:[1,0]
  v_cvt_pk_bf16_f32 v89, v74, v75
  v_pk_add_f32 v[52:53], v[52:53], v[76:77] op_sel:[0,1] op_sel_hi:[1,1] neg_lo:[0,1] neg_hi:[0,1]
  v_cvt_pk_bf16_f32 v73, v52, v53
  v_lshlrev_b32 v74, 16, v73
  v_and_b32 v75, s45, v73
  v_pk_mul_f32 v[74:75], v[74:75], v[72:73] op_sel_hi:[1,0]
  v_cvt_pk_bf16_f32 v90, v74, v75
  v_pk_add_f32 v[54:55], v[54:55], v[76:77] op_sel:[0,1] op_sel_hi:[1,1] neg_lo:[0,1] neg_hi:[0,1]
  v_cvt_pk_bf16_f32 v73, v54, v55
  v_lshlrev_b32 v74, 16, v73
  v_and_b32 v75, s45, v73
  v_pk_mul_f32 v[74:75], v[74:75], v[72:73] op_sel_hi:[1,0]
  v_cvt_pk_bf16_f32 v91, v74, v75
  v_pk_add_f32 v[56:57], v[56:57], v[76:77] op_sel:[0,1] op_sel_hi:[1,1] neg_lo:[0,1] neg_hi:[0,1]
  v_cvt_pk_bf16_f32 v73, v56, v57
  v_lshlrev_b32 v74, 16, v73
  v_and_b32 v75, s45, v73
  v_pk_mul_f32 v[74:75], v[74:75], v[72:73] op_sel_hi:[1,0]
  v_cvt_pk_bf16_f32 v92, v74, v75
  v_pk_add_f32 v[58:59], v[58:59], v[76:77] op_sel:[0,1] op_sel_hi:[1,1] neg_lo:[0,1] neg_hi:[0,1]
  v_cvt_pk_bf16_f32 v73, v58, v59
  v_lshlrev_b32 v74, 16, v73
  v_and_b32 v75, s45, v73
  v_pk_mul_f32 v[74:75], v[74:75], v[72:73] op_sel_hi:[1,0]
  v_cvt_pk_bf16_f32 v93, v74, v75
  v_pk_add_f32 v[60:61], v[60:61], v[76:77] op_sel:[0,1] op_sel_hi:[1,1] neg_lo:[0,1] neg_hi:[0,1]
  v_cvt_pk_bf16_f32 v73, v60, v61
  v_lshlrev_b32 v74, 16, v73
  v_and_b32 v75, s45, v73
  v_pk_mul_f32 v[74:75], v[74:75], v[72:73] op_sel_hi:[1,0]
  v_cvt_pk_bf16_f32 v94, v74, v75
  v_pk_add_f32 v[62:63], v[62:63], v[76:77] op_sel:[0,1] op_sel_hi:[1,1] neg_lo:[0,1] neg_hi:[0,1]
  v_cvt_pk_bf16_f32 v73, v62, v63
  v_lshlrev_b32 v74, 16, v73
  v_and_b32 v75, s45, v73
  v_pk_mul_f32 v[74:75], v[74:75], v[72:73] op_sel_hi:[1,0]
  v_cvt_pk_bf16_f32 v95, v74, v75
  buffer_store_dwordx4 v[80:83], v5, s[4:7], s36 offen offset:0 sc1
  buffer_store_dwordx4 v[84:87], v8, s[4:7], s36 offen offset:0 sc1
  buffer_store_dwordx4 v[88:91], v5, s[4:7], s36 offen offset:128 sc1
  buffer_store_dwordx4 v[92:95], v8, s[4:7], s36 offen offset:128 sc1
  s_waitcnt vmcnt(0)
  s_barrier
  s_lshl_b32 s40, s31, 2
  s_cmp_lg_u32 s28, 0
  s_cbranch_scc1 ar_35
  s_mov_b64 exec, 1
  buffer_atomic_add v9, v3, s[8:11], s40 offen sc1
  s_mov_b64 exec, -1
ar_35:
  v_and_b32 v11, 7, v1
  v_lshlrev_b32 v11, 2, v11
  s_mov_b32 s42, 0
vf_36:
  buffer_load_dword v10, v11, s[8:11], 0 offen sc0 sc1
  s_add_u32 s42, s42, 1
  s_waitcnt vmcnt(0)
  v_readlane_b32 s43, v10, s31
  v_lshrrev_b32 v10, 22, v10
  v_cmp_ne_u32 vcc, 32, v10
  s_cbranch_vccz vk_37
  s_movk_i32 s41, 1
  s_cmp_gt_u32 s42, 262144
  s_cbranch_scc1 L_fail
  s_sleep 2
  s_branch vf_36
vk_37:
  s_and_b32 s40, s43, 0x1ff
  s_mul_i32 s40, s40, s40
  s_bfe_u32 s41, s43, 0xd0009
  s_lshl_b32 s41, s41, 5
  s_cmp_eq_u32 s40, s41
  s_cselect_b32 s47, 1, 0
  s_and_b32 s49, s46, 3
  s_lshl_b32 s49, s49, 1
  s_lshr_b32 s40, s28, 1
  s_add_u32 s49, s49, s40
  s_lshl_b32 s52, s49, 2
  s_lshl_b32 s40, s30, 7
  s_add_u32 s52, s52, s40
  s_lshl_b32 s40, s30, 3
  s_add_u32 s49, s49, s40
  s_and_b32 s40, s28, 1
  s_add_u32 s35, s35, s40
  s_lshl_b32 s40, s49, 4
  v_bfe_u32 v9, v1, 0, 2
  v_lshlrev_b32 v9, 2, v9
  v_add_u32 v9, s40, v9
  s_lshl_b32 s51, s49, 13
  s_lshl_b32 s50, s49, 11
  v_add_u32 v5, 4096, v2
  v_lshlrev_b32 v7, 3, v1
  s_mov_b32 s44, 1040356334
  v_mov_b32 v8, 0xff7fffff
  v_bfe_u32 v6, v1, 5, 1
  v_lshlrev_b32 v6, 7, v6
  v_bfe_u32 v10, v1, 0, 3
  v_lshl_add_u32 v6, v10, 4, v6
  v_and_b32 v11, 31, v1
  v_lshrrev_b32 v10, 5, v1
  v_lshlrev_b32 v10, 2, v10
  v_sub_u32 v11, v11, v10
  v_cmp_le_i32 s[56:57], 0, v11
  v_cmp_le_i32 s[58:59], 1, v11
  v_cmp_le_i32 s[60:61], 2, v11
  v_cmp_le_i32 s[62:63], 3, v11
  v_cmp_le_i32 s[64:65], 8, v11
  v_cmp_le_i32 s[66:67], 9, v11
  v_cmp_le_i32 s[68:69], 10, v11
  v_cmp_le_i32 s[70:71], 11, v11
  v_cmp_le_i32 s[72:73], 16, v11
  v_cmp_le_i32 s[74:75], 17, v11
  v_cmp_le_i32 s[76:77], 18, v11
  v_cmp_le_i32 s[78:79], 19, v11
  v_cmp_le_i32 s[80:81], 24, v11
  v_cmp_le_i32 s[82:83], 25, v11
  v_cmp_le_i32 s[84:85], 26, v11
  v_cmp_le_i32 s[86:87], 27, v11
  v_lshlrev_b32 v15, 7, v1
L_A_0:
  s_lshl_b32 s39, s35, 18
  s_add_u32 s39, s39, s51
  s_add_u32 s39, s39, 65011712
  buffer_load_dword v14, v15, s[4:7], s39 offen
  s_lshl_b32 s43, s35, 9
  s_add_u32 s43, s43, 65536
  s_mov_b32 s40, 0
poll_38:
  buffer_load_dword v10, v9, s[4:7], s43 offen sc1
  s_add_u32 s40, s40, 1
  s_waitcnt vmcnt(0)
  v_cmp_eq_u32 vcc, 0, v10
  s_cbranch_vccz pd_39
  s_movk_i32 s41, 40
  s_cmp_gt_u32 s40, 262144
  s_cbranch_scc1 L_fail
  s_sleep 1
  s_branch poll_38
pd_39:
  s_lshl_b32 s39, s35, 18
  s_add_u32 s39, s39, s51
  s_add_u32 s40, s39, 98566144
  buffer_load_dwordx4 a[0:3], v2, s[4:7], s40 offen offset:0 sc1
  buffer_load_dwordx4 a[4:7], v2, s[4:7], s40 offen offset:1024 sc1
  buffer_load_dwordx4 a[8:11], v2, s[4:7], s40 offen offset:2048 sc1
  buffer_load_dwordx4 a[12:15], v2, s[4:7], s40 offen offset:3072 sc1
  buffer_load_dwordx4 a[16:19], v5, s[4:7], s40 offen offset:0 sc1
  buffer_load_dwordx4 a[20:23], v5, s[4:7], s40 offen offset:1024 sc1
  buffer_load_dwordx4 a[24:27], v5, s[4:7], s40 offen offset:2048 sc1
  buffer_load_dwordx4 a[28:31], v5, s[4:7], s40 offen offset:3072 sc1
  s_add_u32 s40, s39, 132120576
  buffer_load_dwordx4 a[32:35], v2, s[4:7], s40 offen offset:0 sc1
  buffer_load_dwordx4 a[36:39], v2, s[4:7], s40 offen offset:1024 sc1
  buffer_load_dwordx4 a[40:43], v2, s[4:7], s40 offen offset:2048 sc1
  buffer_load_dwordx4 a[44:47], v2, s[4:7], s40 offen offset:3072 sc1
  buffer_load_dwordx4 a[48:51], v5, s[4:7], s40 offen offset:0 sc1
  buffer_load_dwordx4 a[52:55], v5, s[4:7], s40 offen offset:1024 sc1
  buffer_load_dwordx4 a[56:59], v5, s[4:7], s40 offen offset:2048 sc1
  buffer_load_dwordx4 a[60:63], v5, s[4:7], s40 offen offset:3072 sc1
  s_add_u32 s40, s39, 165675008
  buffer_load_dwordx4 a[64:67], v2, s[4:7], s40 offen offset:0 sc1
  buffer_load_dwordx4 a[68:71], v2, s[4:7], s40 offen offset:1024 sc1
  buffer_load_dwordx4 a[72:75], v2, s[4:7], s40 offen offset:2048 sc1
  buffer_load_dwordx4 a[76:79], v2, s[4:7], s40 offen offset:3072 sc1
  buffer_load_dwordx4 a[80:83], v5, s[4:7], s40 offen offset:0 sc1
  buffer_load_dwordx4 a[84:87], v5, s[4:7], s40 offen offset:1024 sc1
  buffer_load_dwordx4 a[88:91], v5, s[4:7], s40 offen offset:2048 sc1
  buffer_load_dwordx4 a[92:95], v5, s[4:7], s40 offen offset:3072 sc1
  s_waitcnt vmcnt(8)
  v_mfma_f32_32x32x16_bf16 v[16:31], a[32:35], a[0:3], 0
  v_mfma_f32_32x32x16_bf16 v[16:31], a[36:39], a[4:7], v[16:31]
  v_mfma_f32_32x32x16_bf16 v[16:31], a[40:43], a[8:11], v[16:31]
  v_mfma_f32_32x32x16_bf16 v[16:31], a[44:47], a[12:15], v[16:31]
  v_mfma_f32_32x32x16_bf16 v[16:31], a[48:51], a[16:19], v[16:31]
  v_mfma_f32_32x32x16_bf16 v[16:31], a[52:55], a[20:23], v[16:31]
  v_mfma_f32_32x32x16_bf16 v[16:31], a[56:59], a[24:27], v[16:31]
  v_mfma_f32_32x32x16_bf16 v[16:31], a[60:63], a[28:31], v[16:31]
  s_nop 11
  v_cndmask_b32 v16, v8, v16, s[56:57]
  v_cndmask_b32 v17, v8, v17, s[58:59]
  v_cndmask_b32 v18, v8, v18, s[60:61]
  v_cndmask_b32 v19, v8, v19, s[62:63]
  v_cndmask_b32 v20, v8, v20, s[64:65]
  v_cndmask_b32 v21, v8, v21, s[66:67]
  v_cndmask_b32 v22, v8, v22, s[68:69]
  v_cndmask_b32 v23, v8, v23, s[70:71]
  v_cndmask_b32 v24, v8, v24, s[72:73]
  v_cndmask_b32 v25, v8, v25, s[74:75]
  v_cndmask_b32 v26, v8, v26, s[76:77]
  v_cndmask_b32 v27, v8, v27, s[78:79]
  v_cndmask_b32 v28, v8, v28, s[80:81]
  v_cndmask_b32 v29, v8, v29, s[82:83]
  v_cndmask_b32 v30, v8, v30, s[84:85]
  v_cndmask_b32 v31, v8, v31, s[86:87]
  v_max3_f32 v12, v16, v17, v18
  v_max3_f32 v12, v12, v19, v20
  v_max3_f32 v12, v12, v21, v22
  v_max3_f32 v12, v12, v23, v24
  v_max3_f32 v12, v12, v25, v26
  v_max3_f32 v12, v12, v27, v28
  v_max3_f32 v12, v12, v29, v30
  v_max_f32 v12, v12, v31
  s_lshl_b32 s43, s35, 9
  s_add_u32 s43, s43, 131072
  s_mov_b32 s40, 0
poll_40:
  buffer_load_dword v10, v9, s[4:7], s43 offen sc1
  s_add_u32 s40, s40, 1
  s_waitcnt vmcnt(0)
  v_cmp_eq_u32 vcc, 0, v10
  s_cbranch_vccz pd_41
  s_movk_i32 s41, 41
  s_cmp_gt_u32 s40, 262144
  s_cbranch_scc1 L_fail
  s_sleep 1
  s_branch poll_40
pd_41:
  s_lshl_b32 s39, s35, 16
  s_add_u32 s39, s39, s50
  s_add_u32 s40, s39, 18874368
  s_add_u32 s39, s39, 27262976
  buffer_load_dwordx4 v[64:67], v6, s[4:7], s40 offen offset:0 sc1
  buffer_load_dwordx4 v[68:71], v6, s[4:7], s40 offen offset:256 sc1
  buffer_load_dwordx4 v[72:75], v6, s[4:7], s40 offen offset:512 sc1
  buffer_load_dwordx4 v[76:79], v6, s[4:7], s40 offen offset:768 sc1
  buffer_load_dwordx4 v[80:83], v6, s[4:7], s40 offen offset:1024 sc1
  buffer_load_dwordx4 v[84:87], v6, s[4:7], s40 offen offset:1280 sc1
  buffer_load_dwordx4 v[88:91], v6, s[4:7], s40 offen offset:1536 sc1
  buffer_load_dwordx4 v[92:95], v6, s[4:7], s40 offen offset:1792 sc1
  buffer_load_dwordx2 v[96:97], v7, s[4:7], s39 offen offset:0 sc1
  buffer_load_dwordx2 v[98:99], v7, s[4:7], s39 offen offset:512 sc1
  buffer_load_dwordx2 v[100:101], v7, s[4:7], s39 offen offset:1024 sc1
  buffer_load_dwordx2 v[102:103], v7, s[4:7], s39 offen offset:1536 sc1
  s_waitcnt vmcnt(11)
  v_mfma_f32_32x32x16_bf16 v[32:47], v[64:67], a[0:3], 0
  s_waitcnt vmcnt(10)
  v_mfma_f32_32x32x16_bf16 v[32:47], v[68:71], a[4:7], v[32:47]
  s_waitcnt vmcnt(9)
  v_mfma_f32_32x32x16_bf16 v[32:47], v[72:75], a[8:11], v[32:47]
  s_waitcnt vmcnt(8)
  v_mfma_f32_32x32x16_bf16 v[32:47], v[76:79], a[12:15], v[32:47]
  s_waitcnt vmcnt(7)
  v_mfma_f32_32x32x16_bf16 v[32:47], v[80:83], a[16:19], v[32:47]
  s_waitcnt vmcnt(6)
  v_mfma_f32_32x32x16_bf16 v[32:47], v[84:87], a[20:23], v[32:47]
  s_waitcnt vmcnt(5)
  v_mfma_f32_32x32x16_bf16 v[32:47], v[88:91], a[24:27], v[32:47]
  s_waitcnt vmcnt(4)
  v_mfma_f32_32x32x16_bf16 v[32:47], v[92:95], a[28:31], v[32:47]
  s_nop 11
  v_max3_f32 v12, v12, v32, v33
  v_max3_f32 v12, v12, v34, v35
  v_mov_b32 v13, v12
  s_nop 1
  v_permlane32_swap_b32 v12, v13
  v_max_f32 v12, v12, v13
  v_mul_f32 v12, s44, v12
  v_fma_f32 v16, v16, s44, -v12
  v_exp_f32 v16, v16
  v_fma_f32 v17, v17, s44, -v12
  v_exp_f32 v17, v17
  v_fma_f32 v18, v18, s44, -v12
  v_exp_f32 v18, v18
  v_fma_f32 v19, v19, s44, -v12
  v_exp_f32 v19, v19
  v_fma_f32 v20, v20, s44, -v12
  v_exp_f32 v20, v20
  v_fma_f32 v21, v21, s44, -v12
  v_exp_f32 v21, v21
  v_fma_f32 v22, v22, s44, -v12
  v_exp_f32 v22, v22
  v_fma_f32 v23, v23, s44, -v12
  v_exp_f32 v23, v23
  v_fma_f32 v24, v24, s44, -v12
  v_exp_f32 v24, v24
  v_fma_f32 v25, v25, s44, -v12
  v_exp_f32 v25, v25
  v_fma_f32 v26, v26, s44, -v12
  v_exp_f32 v26, v26
  v_fma_f32 v27, v27, s44, -v12
  v_exp_f32 v27, v27
  v_fma_f32 v28, v28, s44, -v12
  v_exp_f32 v28, v28
  v_fma_f32 v29, v29, s44, -v12
  v_exp_f32 v29, v29
  v_fma_f32 v30, v30, s44, -v12
  v_exp_f32 v30, v30
  v_fma_f32 v31, v31, s44, -v12
  v_exp_f32 v31, v31
  v_fma_f32 v32, v32, s44, -v12
  v_exp_f32 v32, v32
  v_fma_f32 v33, v33, s44, -v12
  v_exp_f32 v33, v33
  v_fma_f32 v34, v34, s44, -v12
  v_exp_f32 v34, v34
  v_fma_f32 v35, v35, s44, -v12
  v_exp_f32 v35, v35
  v_add_f32 v12, v16, v17
  v_add_f32 v13, v18, v19
  v_add_f32 v12, v12, v20
  v_add_f32 v13, v13, v21
  v_add_f32 v12, v12, v22
  v_add_f32 v13, v13, v23
  v_add_f32 v12, v12, v24
  v_add_f32 v13, v13, v25
  v_add_f32 v12, v12, v26
  v_add_f32 v13, v13, v27
  v_add_f32 v12, v12, v28
  v_add_f32 v13, v13, v29
  v_add_f32 v12, v12, v30
  v_add_f32 v13, v13, v31
  v_add_f32 v12, v12, v32
  v_add_f32 v13, v13, v33
  v_add_f32 v12, v12, v34
  v_add_f32 v13, v13, v35
  v_add_f32 v12, v12, v13
  v_mov_b32 v13, v12
  s_nop 1
  v_permlane32_swap_b32 v12, v13
  v_add_f32 v12, v12, v13
  v_rcp_f32 v12, v12
  s_nop 0
  v_mul_f32 v16, v16, v12
  v_mul_f32 v17, v17, v12
  v_mul_f32 v18, v18, v12
  v_mul_f32 v19, v19, v12
  v_mul_f32 v20, v20, v12
  v_mul_f32 v21, v21, v12
  v_mul_f32 v22, v22, v12
  v_mul_f32 v23, v23, v12
  v_mul_f32 v24, v24, v12
  v_mul_f32 v25, v25, v12
  v_mul_f32 v26, v26, v12
  v_mul_f32 v27, v27, v12
  v_mul_f32 v28, v28, v12
  v_mul_f32 v29, v29, v12
  v_mul_f32 v30, v30, v12
  v_mul_f32 v31, v31, v12
  v_mul_f32 v32, v32, v12
  v_mul_f32 v33, v33, v12
  v_mul_f32 v34, v34, v12
  v_mul_f32 v35, v35, v12
  v_cvt_pk_bf16_f32 v48, v16, v17
  v_cvt_pk_bf16_f32 v49, v18, v19
  v_cvt_pk_bf16_f32 v50, v20, v21
  v_cvt_pk_bf16_f32 v51, v22, v23
  v_cvt_pk_bf16_f32 v52, v24, v25
  v_cvt_pk_bf16_f32 v53, v26, v27
  v_cvt_pk_bf16_f32 v54, v28, v29
  v_cvt_pk_bf16_f32 v55, v30, v31
  v_cvt_pk_bf16_f32 v56, v32, v33
  v_cvt_pk_bf16_f32 v57, v34, v35
  s_waitcnt vmcnt(0)
  s_nop 0
  v_mfma_f32_32x32x8bf16_1k v[128:143], v[96:97], v[56:57], 0
  v_mfma_f32_32x32x8bf16_1k v[144:159], v[98:99], v[56:57], 0
  v_mfma_f32_32x32x8bf16_1k v[160:175], v[100:101], v[56:57], 0
  v_mfma_f32_32x32x8bf16_1k v[176:191], v[102:103], v[56:57], 0
  v_mfma_f32_32x32x16_bf16 v[128:143], a[64:67], v[48:51], v[128:143]
  v_mfma_f32_32x32x16_bf16 v[144:159], a[72:75], v[48:51], v[144:159]
  v_mfma_f32_32x32x16_bf16 v[160:175], a[80:83], v[48:51], v[160:175]
  v_mfma_f32_32x32x16_bf16 v[176:191], a[88:91], v[48:51], v[176:191]
  v_mfma_f32_32x32x16_bf16 v[128:143], a[68:71], v[52:55], v[128:143]
  v_mfma_f32_32x32x16_bf16 v[144:159], a[76:79], v[52:55], v[144:159]
  v_mfma_f32_32x32x16_bf16 v[160:175], a[84:87], v[52:55], v[160:175]
  v_mfma_f32_32x32x16_bf16 v[176:191], a[92:95], v[52:55], v[176:191]
  s_lshl_b32 s39, s35, 18
  s_add_u32 s39, s39, s51
  s_add_u32 s39, s39, 65011712
  s_nop 5
  v_cvt_pk_bf16_f32 v192, v128, v129
  v_cvt_pk_bf16_f32 v193, v130, v131
  v_cvt_pk_bf16_f32 v194, v132, v133
  v_cvt_pk_bf16_f32 v195, v134, v135
  v_cvt_pk_bf16_f32 v196, v136, v137
  v_cvt_pk_bf16_f32 v197, v138, v139
  v_cvt_pk_bf16_f32 v198, v140, v141
  v_cvt_pk_bf16_f32 v199, v142, v143
  v_cvt_pk_bf16_f32 v200, v144, v145
  v_cvt_pk_bf16_f32 v201, v146, v147
  v_cvt_pk_bf16_f32 v202, v148, v149
  v_cvt_pk_bf16_f32 v203, v150, v151
  v_cvt_pk_bf16_f32 v204, v152, v153
  v_cvt_pk_bf16_f32 v205, v154, v155
  v_cvt_pk_bf16_f32 v206, v156, v157
  v_cvt_pk_bf16_f32 v207, v158, v159
  v_cvt_pk_bf16_f32 v208, v160, v161
  v_cvt_pk_bf16_f32 v209, v162, v163
  v_cvt_pk_bf16_f32 v210, v164, v165
  v_cvt_pk_bf16_f32 v211, v166, v167
  v_cvt_pk_bf16_f32 v212, v168, v169
  v_cvt_pk_bf16_f32 v213, v170, v171
  v_cvt_pk_bf16_f32 v214, v172, v173
  v_cvt_pk_bf16_f32 v215, v174, v175
  v_cvt_pk_bf16_f32 v216, v176, v177
  v_cvt_pk_bf16_f32 v217, v178, v179
  v_cvt_pk_bf16_f32 v218, v180, v181
  v_cvt_pk_bf16_f32 v219, v182, v183
  v_cvt_pk_bf16_f32 v220, v184, v185
  v_cvt_pk_bf16_f32 v221, v186, v187
  v_cvt_pk_bf16_f32 v222, v188, v189
  v_cvt_pk_bf16_f32 v223, v190, v191
  s_cmp_eq_u32 s47, 0
  s_cbranch_scc1 sf_42
  buffer_store_dwordx4 v[192:195], v2, s[4:7], s39 offen offset:0
  buffer_store_dwordx4 v[196:199], v2, s[4:7], s39 offen offset:1024
  buffer_store_dwordx4 v[200:203], v2, s[4:7], s39 offen offset:2048
  buffer_store_dwordx4 v[204:207], v2, s[4:7], s39 offen offset:3072
  buffer_store_dwordx4 v[208:211], v5, s[4:7], s39 offen offset:0
  buffer_store_dwordx4 v[212:215], v5, s[4:7], s39 offen offset:1024
  buffer_store_dwordx4 v[216:219], v5, s[4:7], s39 offen offset:2048
  buffer_store_dwordx4 v[220:223], v5, s[4:7], s39 offen offset:3072
  s_waitcnt vmcnt(0)
  s_lshl_b32 s40, s35, 9
  s_add_u32 s40, s40, 196608
  s_add_u32 s40, s40, s52
  s_mov_b64 exec, 1
  buffer_store_dword v4, v3, s[4:7], s40 offen
  s_mov_b64 exec, -1
  s_branch se_43
sf_42:
  buffer_store_dwordx4 v[192:195], v2, s[4:7], s39 offen offset:0 sc1
  buffer_store_dwordx4 v[196:199], v2, s[4:7], s39 offen offset:1024 sc1
  buffer_store_dwordx4 v[200:203], v2, s[4:7], s39 offen offset:2048 sc1
  buffer_store_dwordx4 v[204:207], v2, s[4:7], s39 offen offset:3072 sc1
  buffer_store_dwordx4 v[208:211], v5, s[4:7], s39 offen offset:0 sc1
  buffer_store_dwordx4 v[212:215], v5, s[4:7], s39 offen offset:1024 sc1
  buffer_store_dwordx4 v[216:219], v5, s[4:7], s39 offen offset:2048 sc1
  buffer_store_dwordx4 v[220:223], v5, s[4:7], s39 offen offset:3072 sc1
  s_waitcnt vmcnt(0)
  s_lshl_b32 s40, s35, 9
  s_add_u32 s40, s40, 196608
  s_add_u32 s40, s40, s52
  s_mov_b64 exec, 1
  buffer_store_dword v4, v3, s[4:7], s40 offen sc1
  s_mov_b64 exec, -1
se_43:
  s_add_u32 s35, s35, 2
  s_cmp_lt_u32 s35, s34
  s_cbranch_scc1 L_A_0
  s_endpgm
J_R1:
  s_and_b32 s49, s31, 1
  s_lshl_b32 s49, s49, 3
  s_add_u32 s49, s49, s46
  s_lshl_b32 s49, s49, 1
  s_add_u32 s49, s49, 96
  s_lshl_b32 s40, s28, 8
  v_bfe_u32 v11, v1, 0, 3
  v_lshlrev_b32 v11, 10, v11
  v_bfe_u32 v10, v1, 4, 2
  v_lshl_add_u32 v11, v10, 5, v11
  v_bfe_u32 v10, v1, 3, 1
  v_lshl_add_u32 v11, v10, 3, v11
  v_add_u32 v11, s40, v11
  s_lshl_b32 s40, s49, 14
  buffer_load_dwordx2 v[128:129], v11, s[12:15], s40 offen offset:0
  buffer_load_dwordx2 v[130:131], v11, s[12:15], s40 offen offset:16
  buffer_load_dwordx2 v[132:133], v11, s[12:15], s40 offen offset:128
  buffer_load_dwordx2 v[134:135], v11, s[12:15], s40 offen offset:144
  s_add_u32 s40, s40, 0x2000
  buffer_load_dwordx2 v[136:137], v11, s[12:15], s40 offen offset:0
  buffer_load_dwordx2 v[138:139], v11, s[12:15], s40 offen offset:16
  buffer_load_dwordx2 v[140:141], v11, s[12:15], s40 offen offset:128
  buffer_load_dwordx2 v[142:143], v11, s[12:15], s40 offen offset:144
  s_add_u32 s40, s40, 0x2000
  buffer_load_dwordx2 v[144:145], v11, s[12:15], s40 offen offset:0
  buffer_load_dwordx2 v[146:147], v11, s[12:15], s40 offen offset:16
  buffer_load_dwordx2 v[148:149], v11, s[12:15], s40 offen offset:128
  buffer_load_dwordx2 v[150:151], v11, s[12:15], s40 offen offset:144
  s_add_u32 s40, s40, 0x2000
  buffer_load_dwordx2 v[152:153], v11, s[12:15], s40 offen offset:0
  buffer_load_dwordx2 v[154:155], v11, s[12:15], s40 offen offset:16
  buffer_load_dwordx2 v[156:157], v11, s[12:15], s40 offen offset:128
  buffer_load_dwordx2 v[158:159], v11, s[12:15], s40 offen offset:144
  s_add_u32 s40, s40, 0x2000
  s_lshl_b32 s40, s28, 13
  v_bfe_u32 v5, v1, 3, 3
  v_lshlrev_b32 v5, 9, v5
  v_bfe_u32 v10, v1, 0, 3
  v_lshl_add_u32 v5, v10, 4, v5
  v_add_u32 v5, s40, v5
  v_bfe_u32 v7, v1, 0, 3
  v_lshlrev_b32 v7, 4, v7
  v_add_u32 v7, 131072, v7
  s_lshl_b32 s40, s28, 2
  v_add_u32 v6, s40, v7
  v_add_u32 v8, 4096, v5
  s_add_u32 s40, s49, 0
  s_lshr_b32 s36, s40, 1
  s_lshl_b32 s36, s36, 15
  s_and_b32 s40, s40, 1
  s_lshl_b32 s40, s40, 8
  s_add_u32 s36, s36, s40
  s_add_u32 s36, s36, 2097152
  s_waitcnt vmcnt(8)
  v_lshlrev_b32 v32, 16, v128
  v_and_b32 v33, s45, v128
  v_lshlrev_b32 v34, 16, v129
  v_and_b32 v35, s45, v129
  v_lshlrev_b32 v36, 16, v130
  v_and_b32 v37, s45, v130
  v_lshlrev_b32 v38, 16, v131
  v_and_b32 v39, s45, v131
  v_lshlrev_b32 v40, 16, v132
  v_and_b32 v41, s45, v132
  v_lshlrev_b32 v42, 16, v133
  v_and_b32 v43, s45, v133
  v_lshlrev_b32 v44, 16, v134
  v_and_b32 v45, s45, v134
  v_lshlrev_b32 v46, 16, v135
  v_and_b32 v47, s45, v135
  v_lshlrev_b32 v48, 16, v136
  v_and_b32 v49, s45, v136
  v_lshlrev_b32 v50, 16, v137
  v_and_b32 v51, s45, v137
  v_lshlrev_b32 v52, 16, v138
  v_and_b32 v53, s45, v138
  v_lshlrev_b32 v54, 16, v139
  v_and_b32 v55, s45, v139
  v_lshlrev_b32 v56, 16, v140
  v_and_b32 v57, s45, v140
  v_lshlrev_b32 v58, 16, v141
  v_and_b32 v59, s45, v141
  v_lshlrev_b32 v60, 16, v142
  v_and_b32 v61, s45, v142
  v_lshlrev_b32 v62, 16, v143
  v_and_b32 v63, s45, v143
  v_pk_add_f32 v[64:65], v[32:33], v[34:35]
  v_pk_add_f32 v[66:67], v[36:37], v[38:39]
  v_pk_add_f32 v[64:65], v[64:65], v[40:41]
  v_pk_add_f32 v[66:67], v[66:67], v[42:43]
  v_pk_add_f32 v[64:65], v[64:65], v[44:45]
  v_pk_add_f32 v[66:67], v[66:67], v[46:47]
  v_pk_add_f32 v[64:65], v[64:65], v[66:67]
  v_add_f32 v64, v64, v65
  s_nop 1
  v_add_f32_dpp v64, v64, v64 row_ror:8 row_mask:0xf bank_mask:0xf
  v_mov_b32 v65, v64
  s_nop 1
  v_permlane16_swap_b32 v64, v65
  v_add_f32 v64, v64, v65
  v_mov_b32 v65, v64
  s_nop 1
  v_permlane32_swap_b32 v64, v65
  v_add_f32 v64, v64, v65
  ds_write_b32 v6, v64 offset:0
  v_pk_add_f32 v[72:73], v[48:49], v[50:51]
  v_pk_add_f32 v[74:75], v[52:53], v[54:55]
  v_pk_add_f32 v[72:73], v[72:73], v[56:57]
  v_pk_add_f32 v[74:75], v[74:75], v[58:59]
  v_pk_add_f32 v[72:73], v[72:73], v[60:61]
  v_pk_add_f32 v[74:75], v[74:75], v[62:63]
  v_pk_add_f32 v[72:73], v[72:73], v[74:75]
  v_add_f32 v72, v72, v73
  s_nop 1
  v_add_f32_dpp v72, v72, v72 row_ror:8 row_mask:0xf bank_mask:0xf
  v_mov_b32 v73, v72
  s_nop 1
  v_permlane16_swap_b32 v72, v73
  v_add_f32 v72, v72, v73
  v_mov_b32 v73, v72
  s_nop 1
  v_permlane32_swap_b32 v72, v73
  v_add_f32 v72, v72, v73
  ds_write_b32 v6, v72 offset:128
  s_waitcnt lgkmcnt(0)
  s_barrier
  ds_read_b128 v[64:67], v7 offset:0
  ds_read_b128 v[72:75], v7 offset:128
  s_waitcnt lgkmcnt(0)
  v_add_f32 v64, v64, v65
  v_add_f32 v66, v66, v67
  v_add_f32 v64, v64, v66
  v_mul_f32 v69, 0x3b000000, v64
  v_add_f32 v72, v72, v73
  v_add_f32 v74, v74, v75
  v_add_f32 v72, v72, v74
  v_mul_f32 v77, 0x3b000000, v72
  v_pk_add_f32 v[66:67], v[32:33], v[68:69] op_sel:[0,1] op_sel_hi:[1,1] neg_lo:[0,1] neg_hi:[0,1]
  v_pk_mul_f32 v[64:65], v[66:67], v[66:67]
  v_pk_add_f32 v[66:67], v[34:35], v[68:69] op_sel:[0,1] op_sel_hi:[1,1] neg_lo:[0,1] neg_hi:[0,1]
  v_pk_fma_f32 v[64:65], v[66:67], v[66:67], v[64:65]
  v_pk_add_f32 v[66:67], v[36:37], v[68:69] op_sel:[0,1] op_sel_hi:[1,1] neg_lo:[0,1] neg_hi:[0,1]
  v_pk_fma_f32 v[64:65], v[66:67], v[66:67], v[64:65]
  v_pk_add_f32 v[66:67], v[38:39], v[68:69] op_sel:[0,1] op_sel_hi:[1,1] neg_lo:[0,1] neg_hi:[0,1]
  v_pk_fma_f32 v[64:65], v[66:67], v[66:67], v[64:65]
  v_pk_add_f32 v[66:67], v[40:41], v[68:69] op_sel:[0,1] op_sel_hi:[1,1] neg_lo:[0,1] neg_hi:[0,1]
  v_pk_fma_f32 v[64:65], v[66:67], v[66:67], v[64:65]
  v_pk_add_f32 v[66:67], v[42:43], v[68:69] op_sel:[0,1] op_sel_hi:[1,1] neg_lo:[0,1] neg_hi:[0,1]
  v_pk_fma_f32 v[64:65], v[66:67], v[66:67], v[64:65]
  v_pk_add_f32 v[66:67], v[44:45], v[68:69] op_sel:[0,1] op_sel_hi:[1,1] neg_lo:[0,1] neg_hi:[0,1]
  v_pk_fma_f32 v[64:65], v[66:67], v[66:67], v[64:65]
  v_pk_add_f32 v[66:67], v[46:47], v[68:69] op_sel:[0,1] op_sel_hi:[1,1] neg_lo:[0,1] neg_hi:[0,1]
  v_pk_fma_f32 v[64:65], v[66:67], v[66:67], v[64:65]
  v_add_f32 v64, v64, v65
  s_nop 1
  v_add_f32_dpp v64, v64, v64 row_ror:8 row_mask:0xf bank_mask:0xf
  v_mov_b32 v65, v64
  s_nop 1
  v_permlane16_swap_b32 v64, v65
  v_add_f32 v64, v64, v65
  v_mov_b32 v65, v64
  s_nop 1
  v_permlane32_swap_b32 v64, v65
  v_add_f32 v64, v64, v65
  ds_write_b32 v6, v64 offset:256
  v_pk_add_f32 v[74:75], v[48:49], v[76:77] op_sel:[0,1] op_sel_hi:[1,1] neg_lo:[0,1] neg_hi:[0,1]
  v_pk_mul_f32 v[72:73], v[74:75], v[74:75]
  v_pk_add_f32 v[74:75], v[50:51], v[76:77] op_sel:[0,1] op_sel_hi:[1,1] neg_lo:[0,1] neg_hi:[0,1]
  v_pk_fma_f32 v[72:73], v[74:75], v[74:75], v[72:73]
  v_pk_add_f32 v[74:75], v[52:53], v[76:77] op_sel:[0,1] op_sel_hi:[1,1] neg_lo:[0,1] neg_hi:[0,1]
  v_pk_fma_f32 v[72:73], v[74:75], v[74:75], v[72:73]
  v_pk_add_f32 v[74:75], v[54:55], v[76:77] op_sel:[0,1] op_sel_hi:[1,1] neg_lo:[0,1] neg_hi:[0,1]
  v_pk_fma_f32 v[72:73], v[74:75], v[74:75], v[72:73]
  v_pk_add_f32 v[74:75], v[56:57], v[76:77] op_sel:[0,1] op_sel_hi:[1,1] neg_lo:[0,1] neg_hi:[0,1]
  v_pk_fma_f32 v[72:73], v[74:75], v[74:75], v[72:73]
  v_pk_add_f32 v[74:75], v[58:59], v[76:77] op_sel:[0,1] op_sel_hi:[1,1] neg_lo:[0,1] neg_hi:[0,1]
  v_pk_fma_f32 v[72:73], v[74:75], v[74:75], v[72:73]
  v_pk_add_f32 v[74:75], v[60:61], v[76:77] op_sel:[0,1] op_sel_hi:[1,1] neg_lo:[0,1] neg_hi:[0,1]
  v_pk_fma_f32 v[72:73], v[74:75], v[74:75], v[72:73]
  v_pk_add_f32 v[74:75], v[62:63], v[76:77] op_sel:[0,1] op_sel_hi:[1,1] neg_lo:[0,1] neg_hi:[0,1]
  v_pk_fma_f32 v[72:73], v[74:75], v[74:75], v[72:73]
  v_add_f32 v72, v72, v73
  s_nop 1
  v_add_f32_dpp v72, v72, v72 row_ror:8 row_mask:0xf bank_mask:0xf
  v_mov_b32 v73, v72
  s_nop 1
  v_permlane16_swap_b32 v72, v73
  v_add_f32 v72, v72, v73
  v_mov_b32 v73, v72
  s_nop 1
  v_permlane32_swap_b32 v72, v73
  v_add_f32 v72, v72, v73
  ds_write_b32 v6, v72 offset:384
  s_waitcnt lgkmcnt(0)
  s_barrier
  ds_read_b128 v[64:67], v7 offset:256
  ds_read_b128 v[72:75], v7 offset:384
  s_waitcnt lgkmcnt(0)
  v_add_f32 v64, v64, v65
  v_add_f32 v66, v66, v67
  v_add_f32 v64, v64, v66
  v_mul_f32 v68, 0x3b000000, v64
  v_add_f32 v72, v72, v73
  v_add_f32 v74, v74, v75
  v_add_f32 v72, v72, v74
  v_mul_f32 v76, 0x3b000000, v72
  v_cvt_pk_bf16_f32 v64, v68, v69
  v_and_b32 v69, s45, v64
  v_lshlrev_b32 v64, 16, v64
  v_add_f32 v64, 0x3727c5ac, v64
  v_cvt_pk_bf16_f32 v64, v64, v64
  v_and_b32 v64, s45, v64
  v_sqrt_f32 v64, v64
  s_nop 0
  v_cvt_pk_bf16_f32 v64, v64, v64
  v_and_b32 v64, s45, v64
  v_rcp_f32 v64, v64
  v_pk_add_f32 v[32:33], v[32:33], v[68:69] op_sel:[0,1] op_sel_hi:[1,1] neg_lo:[0,1] neg_hi:[0,1]
  v_cvt_pk_bf16_f32 v65, v32, v33
  v_lshlrev_b32 v66, 16, v65
  v_and_b32 v67, s45, v65
  v_pk_mul_f32 v[66:67], v[66:67], v[64:65] op_sel_hi:[1,0]
  v_cvt_pk_bf16_f32 v80, v66, v67
  v_pk_add_f32 v[34:35], v[34:35], v[68:69] op_sel:[0,1] op_sel_hi:[1,1] neg_lo:[0,1] neg_hi:[0,1]
  v_cvt_pk_bf16_f32 v65, v34, v35
  v_lshlrev_b32 v66, 16, v65
  v_and_b32 v67, s45, v65
  v_pk_mul_f32 v[66:67], v[66:67], v[64:65] op_sel_hi:[1,0]
  v_cvt_pk_bf16_f32 v81, v66, v67
  v_pk_add_f32 v[36:37], v[36:37], v[68:69] op_sel:[0,1] op_sel_hi:[1,1] neg_lo:[0,1] neg_hi:[0,1]
  v_cvt_pk_bf16_f32 v65, v36, v37
  v_lshlrev_b32 v66, 16, v65
  v_and_b32 v67, s45, v65
  v_pk_mul_f32 v[66:67], v[66:67], v[64:65] op_sel_hi:[1,0]
  v_cvt_pk_bf16_f32 v82, v66, v67
  v_pk_add_f32 v[38:39], v[38:39], v[68:69] op_sel:[0,1] op_sel_hi:[1,1] neg_lo:[0,1] neg_hi:[0,1]
  v_cvt_pk_bf16_f32 v65, v38, v39
  v_lshlrev_b32 v66, 16, v65
  v_and_b32 v67, s45, v65
  v_pk_mul_f32 v[66:67], v[66:67], v[64:65] op_sel_hi:[1,0]
  v_cvt_pk_bf16_f32 v83, v66, v67
  v_pk_add_f32 v[40:41], v[40:41], v[68:69] op_sel:[0,1] op_sel_hi:[1,1] neg_lo:[0,1] neg_hi:[0,1]
  v_cvt_pk_bf16_f32 v65, v40, v41
  v_lshlrev_b32 v66, 16, v65
  v_and_b32 v67, s45, v65
  v_pk_mul_f32 v[66:67], v[66:67], v[64:65] op_sel_hi:[1,0]
  v_cvt_pk_bf16_f32 v84, v66, v67
  v_pk_add_f32 v[42:43], v[42:43], v[68:69] op_sel:[0,1] op_sel_hi:[1,1] neg_lo:[0,1] neg_hi:[0,1]
  v_cvt_pk_bf16_f32 v65, v42, v43
  v_lshlrev_b32 v66, 16, v65
  v_and_b32 v67, s45, v65
  v_pk_mul_f32 v[66:67], v[66:67], v[64:65] op_sel_hi:[1,0]
  v_cvt_pk_bf16_f32 v85, v66, v67
  v_pk_add_f32 v[44:45], v[44:45], v[68:69] op_sel:[0,1] op_sel_hi:[1,1] neg_lo:[0,1] neg_hi:[0,1]
  v_cvt_pk_bf16_f32 v65, v44, v45
  v_lshlrev_b32 v66, 16, v65
  v_and_b32 v67, s45, v65
  v_pk_mul_f32 v[66:67], v[66:67], v[64:65] op_sel_hi:[1,0]
  v_cvt_pk_bf16_f32 v86, v66, v67
  v_pk_add_f32 v[46:47], v[46:47], v[68:69] op_sel:[0,1] op_sel_hi:[1,1] neg_lo:[0,1] neg_hi:[0,1]
  v_cvt_pk_bf16_f32 v65, v46, v47
  v_lshlrev_b32 v66, 16, v65
  v_and_b32 v67, s45, v65
  v_pk_mul_f32 v[66:67], v[66:67], v[64:65] op_sel_hi:[1,0]
  v_cvt_pk_bf16_f32 v87, v66, v67
  v_cvt_pk_bf16_f32 v72, v76, v77
  v_and_b32 v77, s45, v72
  v_lshlrev_b32 v72, 16, v72
  v_add_f32 v72, 0x3727c5ac, v72
  v_cvt_pk_bf16_f32 v72, v72, v72
  v_and_b32 v72, s45, v72
  v_sqrt_f32 v72, v72
  s_nop 0
  v_cvt_pk_bf16_f32 v72, v72, v72
  v_and_b32 v72, s45, v72
  v_rcp_f32 v72, v72
  v_pk_add_f32 v[48:49], v[48:49], v[76:77] op_sel:[0,1] op_sel_hi:[1,1] neg_lo:[0,1] neg_hi:[0,1]
  v_cvt_pk_bf16_f32 v73, v48, v49
  v_lshlrev_b32 v74, 16, v73
  v_and_b32 v75, s45, v73
  v_pk_mul_f32 v[74:75], v[74:75], v[72:73] op_sel_hi:[1,0]
  v_cvt_pk_bf16_f32 v88, v74, v75
  v_pk_add_f32 v[50:51], v[50:51], v[76:77] op_sel:[0,1] op_sel_hi:[1,1] neg_lo:[0,1] neg_hi:[0,1]
  v_cvt_pk_bf16_f32 v73, v50, v51
  v_lshlrev_b32 v74, 16, v73
  v_and_b32 v75, s45, v73
  v_pk_mul_f32 v[74:75], v[74:75], v[72:73] op_sel_hi:[1,0]
  v_cvt_pk_bf16_f32 v89, v74, v75
  v_pk_add_f32 v[52:53], v[52:53], v[76:77] op_sel:[0,1] op_sel_hi:[1,1] neg_lo:[0,1] neg_hi:[0,1]
  v_cvt_pk_bf16_f32 v73, v52, v53
  v_lshlrev_b32 v74, 16, v73
  v_and_b32 v75, s45, v73
  v_pk_mul_f32 v[74:75], v[74:75], v[72:73] op_sel_hi:[1,0]
  v_cvt_pk_bf16_f32 v90, v74, v75
  v_pk_add_f32 v[54:55], v[54:55], v[76:77] op_sel:[0,1] op_sel_hi:[1,1] neg_lo:[0,1] neg_hi:[0,1]
  v_cvt_pk_bf16_f32 v73, v54, v55
  v_lshlrev_b32 v74, 16, v73
  v_and_b32 v75, s45, v73
  v_pk_mul_f32 v[74:75], v[74:75], v[72:73] op_sel_hi:[1,0]
  v_cvt_pk_bf16_f32 v91, v74, v75
  v_pk_add_f32 v[56:57], v[56:57], v[76:77] op_sel:[0,1] op_sel_hi:[1,1] neg_lo:[0,1] neg_hi:[0,1]
  v_cvt_pk_bf16_f32 v73, v56, v57
  v_lshlrev_b32 v74, 16, v73
  v_and_b32 v75, s45, v73
  v_pk_mul_f32 v[74:75], v[74:75], v[72:73] op_sel_hi:[1,0]
  v_cvt_pk_bf16_f32 v92, v74, v75
  v_pk_add_f32 v[58:59], v[58:59], v[76:77] op_sel:[0,1] op_sel_hi:[1,1] neg_lo:[0,1] neg_hi:[0,1]
  v_cvt_pk_bf16_f32 v73, v58, v59
  v_lshlrev_b32 v74, 16, v73
  v_and_b32 v75, s45, v73
  v_pk_mul_f32 v[74:75], v[74:75], v[72:73] op_sel_hi:[1,0]
  v_cvt_pk_bf16_f32 v93, v74, v75
  v_pk_add_f32 v[60:61], v[60:61], v[76:77] op_sel:[0,1] op_sel_hi:[1,1] neg_lo:[0,1] neg_hi:[0,1]
  v_cvt_pk_bf16_f32 v73, v60, v61
  v_lshlrev_b32 v74, 16, v73
  v_and_b32 v75, s45, v73
  v_pk_mul_f32 v[74:75], v[74:75], v[72:73] op_sel_hi:[1,0]
  v_cvt_pk_bf16_f32 v94, v74, v75
  v_pk_add_f32 v[62:63], v[62:63], v[76:77] op_sel:[0,1] op_sel_hi:[1,1] neg_lo:[0,1] neg_hi:[0,1]
  v_cvt_pk_bf16_f32 v73, v62, v63
  v_lshlrev_b32 v74, 16, v73
  v_and_b32 v75, s45, v73
  v_pk_mul_f32 v[74:75], v[74:75], v[72:73] op_sel_hi:[1,0]
  v_cvt_pk_bf16_f32 v95, v74, v75
  buffer_store_dwordx4 v[80:83], v5, s[4:7], s36 offen offset:0 sc1
  buffer_store_dwordx4 v[84:87], v8, s[4:7], s36 offen offset:0 sc1
  buffer_store_dwordx4 v[88:91], v5, s[4:7], s36 offen offset:128 sc1
  buffer_store_dwordx4 v[92:95], v8, s[4:7], s36 offen offset:128 sc1
  s_add_u32 s40, s49, 1
  s_lshr_b32 s36, s40, 1
  s_lshl_b32 s36, s36, 15
  s_and_b32 s40, s40, 1
  s_lshl_b32 s40, s40, 8
  s_add_u32 s36, s36, s40
  s_add_u32 s36, s36, 2097152
  s_waitcnt vmcnt(4)
  v_lshlrev_b32 v32, 16, v144
  v_and_b32 v33, s45, v144
  v_lshlrev_b32 v34, 16, v145
  v_and_b32 v35, s45, v145
  v_lshlrev_b32 v36, 16, v146
  v_and_b32 v37, s45, v146
  v_lshlrev_b32 v38, 16, v147
  v_and_b32 v39, s45, v147
  v_lshlrev_b32 v40, 16, v148
  v_and_b32 v41, s45, v148
  v_lshlrev_b32 v42, 16, v149
  v_and_b32 v43, s45, v149
  v_lshlrev_b32 v44, 16, v150
  v_and_b32 v45, s45, v150
  v_lshlrev_b32 v46, 16, v151
  v_and_b32 v47, s45, v151
  v_lshlrev_b32 v48, 16, v152
  v_and_b32 v49, s45, v152
  v_lshlrev_b32 v50, 16, v153
  v_and_b32 v51, s45, v153
  v_lshlrev_b32 v52, 16, v154
  v_and_b32 v53, s45, v154
  v_lshlrev_b32 v54, 16, v155
  v_and_b32 v55, s45, v155
  v_lshlrev_b32 v56, 16, v156
  v_and_b32 v57, s45, v156
  v_lshlrev_b32 v58, 16, v157
  v_and_b32 v59, s45, v157
  v_lshlrev_b32 v60, 16, v158
  v_and_b32 v61, s45, v158
  v_lshlrev_b32 v62, 16, v159
  v_and_b32 v63, s45, v159
  v_pk_add_f32 v[64:65], v[32:33], v[34:35]
  v_pk_add_f32 v[66:67], v[36:37], v[38:39]
  v_pk_add_f32 v[64:65], v[64:65], v[40:41]
  v_pk_add_f32 v[66:67], v[66:67], v[42:43]
  v_pk_add_f32 v[64:65], v[64:65], v[44:45]
  v_pk_add_f32 v[66:67], v[66:67], v[46:47]
  v_pk_add_f32 v[64:65], v[64:65], v[66:67]
  v_add_f32 v64, v64, v65
  s_nop 1
  v_add_f32_dpp v64, v64, v64 row_ror:8 row_mask:0xf bank_mask:0xf
  v_mov_b32 v65, v64
  s_nop 1
  v_permlane16_swap_b32 v64, v65
  v_add_f32 v64, v64, v65
  v_mov_b32 v65, v64
  s_nop 1
  v_permlane32_swap_b32 v64, v65
  v_add_f32 v64, v64, v65
  ds_write_b32 v6, v64 offset:0
  v_pk_add_f32 v[72:73], v[48:49], v[50:51]
  v_pk_add_f32 v[74:75], v[52:53], v[54:55]
  v_pk_add_f32 v[72:73], v[72:73], v[56:57]
  v_pk_add_f32 v[74:75], v[74:75], v[58:59]
  v_pk_add_f32 v[72:73], v[72:73], v[60:61]
  v_pk_add_f32 v[74:75], v[74:75], v[62:63]
  v_pk_add_f32 v[72:73], v[72:73], v[74:75]
  v_add_f32 v72, v72, v73
  s_nop 1
  v_add_f32_dpp v72, v72, v72 row_ror:8 row_mask:0xf bank_mask:0xf
  v_mov_b32 v73, v72
  s_nop 1
  v_permlane16_swap_b32 v72, v73
  v_add_f32 v72, v72, v73
  v_mov_b32 v73, v72
  s_nop 1
  v_permlane32_swap_b32 v72, v73
  v_add_f32 v72, v72, v73
  ds_write_b32 v6, v72 offset:128
  s_waitcnt lgkmcnt(0)
  s_barrier
  ds_read_b128 v[64:67], v7 offset:0
  ds_read_b128 v[72:75], v7 offset:128
  s_waitcnt lgkmcnt(0)
  v_add_f32 v64, v64, v65
  v_add_f32 v66, v66, v67
  v_add_f32 v64, v64, v66
  v_mul_f32 v69, 0x3b000000, v64
  v_add_f32 v72, v72, v73
  v_add_f32 v74, v74, v75
  v_add_f32 v72, v72, v74
  v_mul_f32 v77, 0x3b000000, v72
  v_pk_add_f32 v[66:67], v[32:33], v[68:69] op_sel:[0,1] op_sel_hi:[1,1] neg_lo:[0,1] neg_hi:[0,1]
  v_pk_mul_f32 v[64:65], v[66:67], v[66:67]
  v_pk_add_f32 v[66:67], v[34:35], v[68:69] op_sel:[0,1] op_sel_hi:[1,1] neg_lo:[0,1] neg_hi:[0,1]
  v_pk_fma_f32 v[64:65], v[66:67], v[66:67], v[64:65]
  v_pk_add_f32 v[66:67], v[36:37], v[68:69] op_sel:[0,1] op_sel_hi:[1,1] neg_lo:[0,1] neg_hi:[0,1]
  v_pk_fma_f32 v[64:65], v[66:67], v[66:67], v[64:65]
  v_pk_add_f32 v[66:67], v[38:39], v[68:69] op_sel:[0,1] op_sel_hi:[1,1] neg_lo:[0,1] neg_hi:[0,1]
  v_pk_fma_f32 v[64:65], v[66:67], v[66:67], v[64:65]
  v_pk_add_f32 v[66:67], v[40:41], v[68:69] op_sel:[0,1] op_sel_hi:[1,1] neg_lo:[0,1] neg_hi:[0,1]
  v_pk_fma_f32 v[64:65], v[66:67], v[66:67], v[64:65]
  v_pk_add_f32 v[66:67], v[42:43], v[68:69] op_sel:[0,1] op_sel_hi:[1,1] neg_lo:[0,1] neg_hi:[0,1]
  v_pk_fma_f32 v[64:65], v[66:67], v[66:67], v[64:65]
  v_pk_add_f32 v[66:67], v[44:45], v[68:69] op_sel:[0,1] op_sel_hi:[1,1] neg_lo:[0,1] neg_hi:[0,1]
  v_pk_fma_f32 v[64:65], v[66:67], v[66:67], v[64:65]
  v_pk_add_f32 v[66:67], v[46:47], v[68:69] op_sel:[0,1] op_sel_hi:[1,1] neg_lo:[0,1] neg_hi:[0,1]
  v_pk_fma_f32 v[64:65], v[66:67], v[66:67], v[64:65]
  v_add_f32 v64, v64, v65
  s_nop 1
  v_add_f32_dpp v64, v64, v64 row_ror:8 row_mask:0xf bank_mask:0xf
  v_mov_b32 v65, v64
  s_nop 1
  v_permlane16_swap_b32 v64, v65
  v_add_f32 v64, v64, v65
  v_mov_b32 v65, v64
  s_nop 1
  v_permlane32_swap_b32 v64, v65
  v_add_f32 v64, v64, v65
  ds_write_b32 v6, v64 offset:256
  v_pk_add_f32 v[74:75], v[48:49], v[76:77] op_sel:[0,1] op_sel_hi:[1,1] neg_lo:[0,1] neg_hi:[0,1]
  v_pk_mul_f32 v[72:73], v[74:75], v[74:75]
  v_pk_add_f32 v[74:75], v[50:51], v[76:77] op_sel:[0,1] op_sel_hi:[1,1] neg_lo:[0,1] neg_hi:[0,1]
  v_pk_fma_f32 v[72:73], v[74:75], v[74:75], v[72:73]
  v_pk_add_f32 v[74:75], v[52:53], v[76:77] op_sel:[0,1] op_sel_hi:[1,1] neg_lo:[0,1] neg_hi:[0,1]
  v_pk_fma_f32 v[72:73], v[74:75], v[74:75], v[72:73]
  v_pk_add_f32 v[74:75], v[54:55], v[76:77] op_sel:[0,1] op_sel_hi:[1,1] neg_lo:[0,1] neg_hi:[0,1]
  v_pk_fma_f32 v[72:73], v[74:75], v[74:75], v[72:73]
  v_pk_add_f32 v[74:75], v[56:57], v[76:77] op_sel:[0,1] op_sel_hi:[1,1] neg_lo:[0,1] neg_hi:[0,1]
  v_pk_fma_f32 v[72:73], v[74:75], v[74:75], v[72:73]
  v_pk_add_f32 v[74:75], v[58:59], v[76:77] op_sel:[0,1] op_sel_hi:[1,1] neg_lo:[0,1] neg_hi:[0,1]
  v_pk_fma_f32 v[72:73], v[74:75], v[74:75], v[72:73]
  v_pk_add_f32 v[74:75], v[60:61], v[76:77] op_sel:[0,1] op_sel_hi:[1,1] neg_lo:[0,1] neg_hi:[0,1]
  v_pk_fma_f32 v[72:73], v[74:75], v[74:75], v[72:73]
  v_pk_add_f32 v[74:75], v[62:63], v[76:77] op_sel:[0,1] op_sel_hi:[1,1] neg_lo:[0,1] neg_hi:[0,1]
  v_pk_fma_f32 v[72:73], v[74:75], v[74:75], v[72:73]
  v_add_f32 v72, v72, v73
  s_nop 1
  v_add_f32_dpp v72, v72, v72 row_ror:8 row_mask:0xf bank_mask:0xf
  v_mov_b32 v73, v72
  s_nop 1
  v_permlane16_swap_b32 v72, v73
  v_add_f32 v72, v72, v73
  v_mov_b32 v73, v72
  s_nop 1
  v_permlane32_swap_b32 v72, v73
  v_add_f32 v72, v72, v73
  ds_write_b32 v6, v72 offset:384
  s_waitcnt lgkmcnt(0)
  s_barrier
  ds_read_b128 v[64:67], v7 offset:256
  ds_read_b128 v[72:75], v7 offset:384
  s_waitcnt lgkmcnt(0)
  v_add_f32 v64, v64, v65
  v_add_f32 v66, v66, v67
  v_add_f32 v64, v64, v66
  v_mul_f32 v68, 0x3b000000, v64
  v_add_f32 v72, v72, v73
  v_add_f32 v74, v74, v75
  v_add_f32 v72, v72, v74
  v_mul_f32 v76, 0x3b000000, v72
  v_cvt_pk_bf16_f32 v64, v68, v69
  v_and_b32 v69, s45, v64
  v_lshlrev_b32 v64, 16, v64
  v_add_f32 v64, 0x3727c5ac, v64
  v_cvt_pk_bf16_f32 v64, v64, v64
  v_and_b32 v64, s45, v64
  v_sqrt_f32 v64, v64
  s_nop 0
  v_cvt_pk_bf16_f32 v64, v64, v64
  v_and_b32 v64, s45, v64
  v_rcp_f32 v64, v64
  v_pk_add_f32 v[32:33], v[32:33], v[68:69] op_sel:[0,1] op_sel_hi:[1,1] neg_lo:[0,1] neg_hi:[0,1]
  v_cvt_pk_bf16_f32 v65, v32, v33
  v_lshlrev_b32 v66, 16, v65
  v_and_b32 v67, s45, v65
  v_pk_mul_f32 v[66:67], v[66:67], v[64:65] op_sel_hi:[1,0]
  v_cvt_pk_bf16_f32 v80, v66, v67
  v_pk_add_f32 v[34:35], v[34:35], v[68:69] op_sel:[0,1] op_sel_hi:[1,1] neg_lo:[0,1] neg_hi:[0,1]
  v_cvt_pk_bf16_f32 v65, v34, v35
  v_lshlrev_b32 v66, 16, v65
  v_and_b32 v67, s45, v65
  v_pk_mul_f32 v[66:67], v[66:67], v[64:65] op_sel_hi:[1,0]
  v_cvt_pk_bf16_f32 v81, v66, v67
  v_pk_add_f32 v[36:37], v[36:37], v[68:69] op_sel:[0,1] op_sel_hi:[1,1] neg_lo:[0,1] neg_hi:[0,1]
  v_cvt_pk_bf16_f32 v65, v36, v37
  v_lshlrev_b32 v66, 16, v65
  v_and_b32 v67, s45, v65
  v_pk_mul_f32 v[66:67], v[66:67], v[64:65] op_sel_hi:[1,0]
  v_cvt_pk_bf16_f32 v82, v66, v67
  v_pk_add_f32 v[38:39], v[38:39], v[68:69] op_sel:[0,1] op_sel_hi:[1,1] neg_lo:[0,1] neg_hi:[0,1]
  v_cvt_pk_bf16_f32 v65, v38, v39
  v_lshlrev_b32 v66, 16, v65
  v_and_b32 v67, s45, v65
  v_pk_mul_f32 v[66:67], v[66:67], v[64:65] op_sel_hi:[1,0]
  v_cvt_pk_bf16_f32 v83, v66, v67
  v_pk_add_f32 v[40:41], v[40:41], v[68:69] op_sel:[0,1] op_sel_hi:[1,1] neg_lo:[0,1] neg_hi:[0,1]
  v_cvt_pk_bf16_f32 v65, v40, v41
  v_lshlrev_b32 v66, 16, v65
  v_and_b32 v67, s45, v65
  v_pk_mul_f32 v[66:67], v[66:67], v[64:65] op_sel_hi:[1,0]
  v_cvt_pk_bf16_f32 v84, v66, v67
  v_pk_add_f32 v[42:43], v[42:43], v[68:69] op_sel:[0,1] op_sel_hi:[1,1] neg_lo:[0,1] neg_hi:[0,1]
  v_cvt_pk_bf16_f32 v65, v42, v43
  v_lshlrev_b32 v66, 16, v65
  v_and_b32 v67, s45, v65
  v_pk_mul_f32 v[66:67], v[66:67], v[64:65] op_sel_hi:[1,0]
  v_cvt_pk_bf16_f32 v85, v66, v67
  v_pk_add_f32 v[44:45], v[44:45], v[68:69] op_sel:[0,1] op_sel_hi:[1,1] neg_lo:[0,1] neg_hi:[0,1]
  v_cvt_pk_bf16_f32 v65, v44, v45
  v_lshlrev_b32 v66, 16, v65
  v_and_b32 v67, s45, v65
  v_pk_mul_f32 v[66:67], v[66:67], v[64:65] op_sel_hi:[1,0]
  v_cvt_pk_bf16_f32 v86, v66, v67
  v_pk_add_f32 v[46:47], v[46:47], v[68:69] op_sel:[0,1] op_sel_hi:[1,1] neg_lo:[0,1] neg_hi:[0,1]
  v_cvt_pk_bf16_f32 v65, v46, v47
  v_lshlrev_b32 v66, 16, v65
  v_and_b32 v67, s45, v65
  v_pk_mul_f32 v[66:67], v[66:67], v[64:65] op_sel_hi:[1,0]
  v_cvt_pk_bf16_f32 v87, v66, v67
  v_cvt_pk_bf16_f32 v72, v76, v77
  v_and_b32 v77, s45, v72
  v_lshlrev_b32 v72, 16, v72
  v_add_f32 v72, 0x3727c5ac, v72
  v_cvt_pk_bf16_f32 v72, v72, v72
  v_and_b32 v72, s45, v72
  v_sqrt_f32 v72, v72
  s_nop 0
  v_cvt_pk_bf16_f32 v72, v72, v72
  v_and_b32 v72, s45, v72
  v_rcp_f32 v72, v72
  v_pk_add_f32 v[48:49], v[48:49], v[76:77] op_sel:[0,1] op_sel_hi:[1,1] neg_lo:[0,1] neg_hi:[0,1]
  v_cvt_pk_bf16_f32 v73, v48, v49
  v_lshlrev_b32 v74, 16, v73
  v_and_b32 v75, s45, v73
  v_pk_mul_f32 v[74:75], v[74:75], v[72:73] op_sel_hi:[1,0]
  v_cvt_pk_bf16_f32 v88, v74, v75
  v_pk_add_f32 v[50:51], v[50:51], v[76:77] op_sel:[0,1] op_sel_hi:[1,1] neg_lo:[0,1] neg_hi:[0,1]
  v_cvt_pk_bf16_f32 v73, v50, v51
  v_lshlrev_b32 v74, 16, v73
  v_and_b32 v75, s45, v73
  v_pk_mul_f32 v[74:75], v[74:75], v[72:73] op_sel_hi:[1,0]
  v_cvt_pk_bf16_f32 v89, v74, v75
  v_pk_add_f32 v[52:53], v[52:53], v[76:77] op_sel:[0,1] op_sel_hi:[1,1] neg_lo:[0,1] neg_hi:[0,1]
  v_cvt_pk_bf16_f32 v73, v52, v53
  v_lshlrev_b32 v74, 16, v73
  v_and_b32 v75, s45, v73
  v_pk_mul_f32 v[74:75], v[74:75], v[72:73] op_sel_hi:[1,0]
  v_cvt_pk_bf16_f32 v90, v74, v75
  v_pk_add_f32 v[54:55], v[54:55], v[76:77] op_sel:[0,1] op_sel_hi:[1,1] neg_lo:[0,1] neg_hi:[0,1]
  v_cvt_pk_bf16_f32 v73, v54, v55
  v_lshlrev_b32 v74, 16, v73
  v_and_b32 v75, s45, v73
  v_pk_mul_f32 v[74:75], v[74:75], v[72:73] op_sel_hi:[1,0]
  v_cvt_pk_bf16_f32 v91, v74, v75
  v_pk_add_f32 v[56:57], v[56:57], v[76:77] op_sel:[0,1] op_sel_hi:[1,1] neg_lo:[0,1] neg_hi:[0,1]
  v_cvt_pk_bf16_f32 v73, v56, v57
  v_lshlrev_b32 v74, 16, v73
  v_and_b32 v75, s45, v73
  v_pk_mul_f32 v[74:75], v[74:75], v[72:73] op_sel_hi:[1,0]
  v_cvt_pk_bf16_f32 v92, v74, v75
  v_pk_add_f32 v[58:59], v[58:59], v[76:77] op_sel:[0,1] op_sel_hi:[1,1] neg_lo:[0,1] neg_hi:[0,1]
  v_cvt_pk_bf16_f32 v73, v58, v59
  v_lshlrev_b32 v74, 16, v73
  v_and_b32 v75, s45, v73
  v_pk_mul_f32 v[74:75], v[74:75], v[72:73] op_sel_hi:[1,0]
  v_cvt_pk_bf16_f32 v93, v74, v75
  v_pk_add_f32 v[60:61], v[60:61], v[76:77] op_sel:[0,1] op_sel_hi:[1,1] neg_lo:[0,1] neg_hi:[0,1]
  v_cvt_pk_bf16_f32 v73, v60, v61
  v_lshlrev_b32 v74, 16, v73
  v_and_b32 v75, s45, v73
  v_pk_mul_f32 v[74:75], v[74:75], v[72:73] op_sel_hi:[1,0]
  v_cvt_pk_bf16_f32 v94, v74, v75
  v_pk_add_f32 v[62:63], v[62:63], v[76:77] op_sel:[0,1] op_sel_hi:[1,1] neg_lo:[0,1] neg_hi:[0,1]
  v_cvt_pk_bf16_f32 v73, v62, v63
  v_lshlrev_b32 v74, 16, v73
  v_and_b32 v75, s45, v73
  v_pk_mul_f32 v[74:75], v[74:75], v[72:73] op_sel_hi:[1,0]
  v_cvt_pk_bf16_f32 v95, v74, v75
  buffer_store_dwordx4 v[80:83], v5, s[4:7], s36 offen offset:0 sc1
  buffer_store_dwordx4 v[84:87], v8, s[4:7], s36 offen offset:0 sc1
  buffer_store_dwordx4 v[88:91], v5, s[4:7], s36 offen offset:128 sc1
  buffer_store_dwordx4 v[92:95], v8, s[4:7], s36 offen offset:128 sc1
  s_waitcnt vmcnt(0)
  s_barrier
  s_lshl_b32 s40, s31, 2
  s_cmp_lg_u32 s28, 0
  s_cbranch_scc1 ar_44
  s_mov_b64 exec, 1
  buffer_atomic_add v9, v3, s[8:11], s40 offen sc1
  s_mov_b64 exec, -1
ar_44:
  v_mov_b32 v12, v11
  v_and_b32 v11, 7, v1
  v_lshlrev_b32 v11, 2, v11
  s_mov_b32 s42, 0
vf_45:
  buffer_load_dword v10, v11, s[8:11], 0 offen sc0 sc1
  s_add_u32 s42, s42, 1
  s_waitcnt vmcnt(0)
  v_readlane_b32 s43, v10, s31
  v_lshrrev_b32 v10, 22, v10
  v_cmp_ne_u32 vcc, 32, v10
  s_cbranch_vccz vk_46
  s_movk_i32 s41, 1
  s_cmp_gt_u32 s42, 262144
  s_cbranch_scc1 L_fail
  s_sleep 2
  s_branch vf_45
vk_46:
  s_and_b32 s40, s43, 0x1ff
  s_mul_i32 s40, s40, s40
  s_bfe_u32 s41, s43, 0xd0009
  s_lshl_b32 s41, s41, 5
  s_cmp_eq_u32 s40, s41
  s_cselect_b32 s47, 1, 0
  s_and_b32 s32, s46, 3
  s_lshr_b32 s40, s46, 2
  s_add_u32 s35, s35, s40
  s_lshl_b32 s40, s28, 4
  v_bfe_u32 v9, v1, 2, 2
  v_lshlrev_b32 v9, 6, v9
  v_bfe_u32 v10, v1, 0, 2
  v_lshl_add_u32 v9, v10, 2, v9
  v_add_u32 v9, s40, v9
  s_lshl_b32 s33, s32, 4
  s_lshl_b32 s40, s28, 2
  s_add_u32 s33, s33, s40
  s_lshl_b32 s32, s32, 7
  s_lshl_b32 s36, s35, 15
  s_add_u32 s36, s36, s32
  s_add_u32 s37, s36, 14680064
  buffer_load_dword v15, v5, s[4:7], s37 offen
  buffer_load_dword v15, v8, s[4:7], s37 offen
  s_add_u32 s37, s36, 10485760
  buffer_load_dword v15, v5, s[4:7], s37 offen
  buffer_load_dword v15, v8, s[4:7], s37 offen
  v_mov_b32 v14, 0
L_R1:
  s_lshl_b32 s36, s35, 15
  s_add_u32 s36, s36, s32
  s_lshl_b32 s43, s35, 9
  s_add_u32 s43, s43, 262144
  v_cmp_eq_u32 vcc, 0, v14
  s_cbranch_vccz L_R1_r
  s_mov_b32 s40, 0
poll_47:
  buffer_load_dword v10, v9, s[4:7], s43 offen sc1
  s_add_u32 s40, s40, 1
  s_waitcnt vmcnt(0)
  v_cmp_eq_u32 vcc, 0, v10
  s_cbranch_vccz pd_48
  s_movk_i32 s41, 14
  s_cmp_gt_u32 s40, 262144
  s_cbranch_scc1 L_fail
  s_sleep 1
  s_branch poll_47
pd_48:
L_R1_r:
  s_add_u32 s37, s36, 6291456
  s_cmp_ge_u32 s35, 64
  s_cbranch_scc1 L_R1_x1
  s_lshl_b32 s37, s35, 15
  s_lshl_b32 s40, s32, 6
  s_add_u32 s37, s37, s40
  buffer_load_dwordx2 v[16:17], v12, s[12:15], s37 offen offset:0
  buffer_load_dwordx2 v[18:19], v12, s[12:15], s37 offen offset:16
  buffer_load_dwordx2 v[20:21], v12, s[12:15], s37 offen offset:128
  buffer_load_dwordx2 v[22:23], v12, s[12:15], s37 offen offset:144
  s_branch L_R1_x2
L_R1_x1:
  buffer_load_dwordx4 v[16:19], v5, s[4:7], s37 offen offset:0 sc1
  buffer_load_dwordx4 v[20:23], v8, s[4:7], s37 offen offset:0 sc1
L_R1_x2:
  s_lshl_b32 s37, s35, 17
  s_add_u32 s37, s37, s32
  s_add_u32 s37, s37, 35651584
  buffer_load_dwordx4 v[96:99], v5, s[4:7], s37 offen sc1
  buffer_load_dwordx4 v[100:103], v8, s[4:7], s37 offen sc1
  s_add_u32 s37, s37, 0x8000
  buffer_load_dwordx4 v[104:107], v5, s[4:7], s37 offen sc1
  buffer_load_dwordx4 v[108:111], v8, s[4:7], s37 offen sc1
  s_add_u32 s37, s37, 0x8000
  buffer_load_dwordx4 v[112:115], v5, s[4:7], s37 offen sc1
  buffer_load_dwordx4 v[116:119], v8, s[4:7], s37 offen sc1
  s_add_u32 s37, s37, 0x8000
  buffer_load_dwordx4 v[120:123], v5, s[4:7], s37 offen sc1
  buffer_load_dwordx4 v[124:127], v8, s[4:7], s37 offen sc1
  s_add_u32 s37, s37, 0x8000
  s_waitcnt vmcnt(4)
  v_lshlrev_b32 v32, 16, v96
  v_and_b32 v33, s45, v96
  v_lshlrev_b32 v64, 16, v104
  v_and_b32 v65, s45, v104
  v_pk_add_f32 v[32:33], v[32:33], v[64:65]
  v_lshlrev_b32 v34, 16, v97
  v_and_b32 v35, s45, v97
  v_lshlrev_b32 v64, 16, v105
  v_and_b32 v65, s45, v105
  v_pk_add_f32 v[34:35], v[34:35], v[64:65]
  v_lshlrev_b32 v36, 16, v98
  v_and_b32 v37, s45, v98
  v_lshlrev_b32 v64, 16, v106
  v_and_b32 v65, s45, v106
  v_pk_add_f32 v[36:37], v[36:37], v[64:65]
  v_lshlrev_b32 v38, 16, v99
  v_and_b32 v39, s45, v99
  v_lshlrev_b32 v64, 16, v107
  v_and_b32 v65, s45, v107
  v_pk_add_f32 v[38:39], v[38:39], v[64:65]
  v_lshlrev_b32 v40, 16, v100
  v_and_b32 v41, s45, v100
  v_lshlrev_b32 v64, 16, v108
  v_and_b32 v65, s45, v108
  v_pk_add_f32 v[40:41], v[40:41], v[64:65]
  v_lshlrev_b32 v42, 16, v101
  v_and_b32 v43, s45, v101
  v_lshlrev_b32 v64, 16, v109
  v_and_b32 v65, s45, v109
  v_pk_add_f32 v[42:43], v[42:43], v[64:65]
  v_lshlrev_b32 v44, 16, v102
  v_and_b32 v45, s45, v102
  v_lshlrev_b32 v64, 16, v110
  v_and_b32 v65, s45, v110
  v_pk_add_f32 v[44:45], v[44:45], v[64:65]
  v_lshlrev_b32 v46, 16, v103
  v_and_b32 v47, s45, v103
  v_lshlrev_b32 v64, 16, v111
  v_and_b32 v65, s45, v111
  v_pk_add_f32 v[46:47], v[46:47], v[64:65]
  s_waitcnt vmcnt(0)
  s_add_u32 s37, s36, 14745600
  buffer_load_dword v15, v5, s[4:7], s37 offen
  buffer_load_dword v15, v8, s[4:7], s37 offen
  s_add_u32 s37, s36, 10551296
  buffer_load_dword v15, v5, s[4:7], s37 offen
  buffer_load_dword v15, v8, s[4:7], s37 offen
  s_add_u32 s43, s43, 1024
  buffer_load_dword v14, v9, s[4:7], s43 offen sc1
  v_lshlrev_b32 v64, 16, v112
  v_and_b32 v65, s45, v112
  v_lshlrev_b32 v66, 16, v120
  v_and_b32 v67, s45, v120
  v_pk_add_f32 v[64:65], v[64:65], v[66:67]
  v_pk_add_f32 v[64:65], v[64:65], v[32:33]
  v_cvt_pk_bf16_f32 v66, v64, v65
  v_lshlrev_b32 v64, 16, v66
  v_and_b32 v65, s45, v66
  v_lshlrev_b32 v66, 16, v16
  v_and_b32 v67, s45, v16
  v_pk_add_f32 v[64:65], v[64:65], v[66:67]
  v_cvt_pk_bf16_f32 v16, v64, v65
  v_lshlrev_b32 v64, 16, v113
  v_and_b32 v65, s45, v113
  v_lshlrev_b32 v66, 16, v121
  v_and_b32 v67, s45, v121
  v_pk_add_f32 v[64:65], v[64:65], v[66:67]
  v_pk_add_f32 v[64:65], v[64:65], v[34:35]
  v_cvt_pk_bf16_f32 v66, v64, v65
  v_lshlrev_b32 v64, 16, v66
  v_and_b32 v65, s45, v66
  v_lshlrev_b32 v66, 16, v17
  v_and_b32 v67, s45, v17
  v_pk_add_f32 v[64:65], v[64:65], v[66:67]
  v_cvt_pk_bf16_f32 v17, v64, v65
  v_lshlrev_b32 v64, 16, v114
  v_and_b32 v65, s45, v114
  v_lshlrev_b32 v66, 16, v122
  v_and_b32 v67, s45, v122
  v_pk_add_f32 v[64:65], v[64:65], v[66:67]
  v_pk_add_f32 v[64:65], v[64:65], v[36:37]
  v_cvt_pk_bf16_f32 v66, v64, v65
  v_lshlrev_b32 v64, 16, v66
  v_and_b32 v65, s45, v66
  v_lshlrev_b32 v66, 16, v18
  v_and_b32 v67, s45, v18
  v_pk_add_f32 v[64:65], v[64:65], v[66:67]
  v_cvt_pk_bf16_f32 v18, v64, v65
  v_lshlrev_b32 v64, 16, v115
  v_and_b32 v65, s45, v115
  v_lshlrev_b32 v66, 16, v123
  v_and_b32 v67, s45, v123
  v_pk_add_f32 v[64:65], v[64:65], v[66:67]
  v_pk_add_f32 v[64:65], v[64:65], v[38:39]
  v_cvt_pk_bf16_f32 v66, v64, v65
  v_lshlrev_b32 v64, 16, v66
  v_and_b32 v65, s45, v66
  v_lshlrev_b32 v66, 16, v19
  v_and_b32 v67, s45, v19
  v_pk_add_f32 v[64:65], v[64:65], v[66:67]
  v_cvt_pk_bf16_f32 v19, v64, v65
  v_lshlrev_b32 v64, 16, v116
  v_and_b32 v65, s45, v116
  v_lshlrev_b32 v66, 16, v124
  v_and_b32 v67, s45, v124
  v_pk_add_f32 v[64:65], v[64:65], v[66:67]
  v_pk_add_f32 v[64:65], v[64:65], v[40:41]
  v_cvt_pk_bf16_f32 v66, v64, v65
  v_lshlrev_b32 v64, 16, v66
  v_and_b32 v65, s45, v66
  v_lshlrev_b32 v66, 16, v20
  v_and_b32 v67, s45, v20
  v_pk_add_f32 v[64:65], v[64:65], v[66:67]
  v_cvt_pk_bf16_f32 v20, v64, v65
  v_lshlrev_b32 v64, 16, v117
  v_and_b32 v65, s45, v117
  v_lshlrev_b32 v66, 16, v125
  v_and_b32 v67, s45, v125
  v_pk_add_f32 v[64:65], v[64:65], v[66:67]
  v_pk_add_f32 v[64:65], v[64:65], v[42:43]
  v_cvt_pk_bf16_f32 v66, v64, v65
  v_lshlrev_b32 v64, 16, v66
  v_and_b32 v65, s45, v66
  v_lshlrev_b32 v66, 16, v21
  v_and_b32 v67, s45, v21
  v_pk_add_f32 v[64:65], v[64:65], v[66:67]
  v_cvt_pk_bf16_f32 v21, v64, v65
  v_lshlrev_b32 v64, 16, v118
  v_and_b32 v65, s45, v118
  v_lshlrev_b32 v66, 16, v126
  v_and_b32 v67, s45, v126
  v_pk_add_f32 v[64:65], v[64:65], v[66:67]
  v_pk_add_f32 v[64:65], v[64:65], v[44:45]
  v_cvt_pk_bf16_f32 v66, v64, v65
  v_lshlrev_b32 v64, 16, v66
  v_and_b32 v65, s45, v66
  v_lshlrev_b32 v66, 16, v22
  v_and_b32 v67, s45, v22
  v_pk_add_f32 v[64:65], v[64:65], v[66:67]
  v_cvt_pk_bf16_f32 v22, v64, v65
  v_lshlrev_b32 v64, 16, v119
  v_and_b32 v65, s45, v119
  v_lshlrev_b32 v66, 16, v127
  v_and_b32 v67, s45, v127
  v_pk_add_f32 v[64:65], v[64:65], v[66:67]
  v_pk_add_f32 v[64:65], v[64:65], v[46:47]
  v_cvt_pk_bf16_f32 v66, v64, v65
  v_lshlrev_b32 v64, 16, v66
  v_and_b32 v65, s45, v66
  v_lshlrev_b32 v66, 16, v23
  v_and_b32 v67, s45, v23
  v_pk_add_f32 v[64:65], v[64:65], v[66:67]
  v_cvt_pk_bf16_f32 v23, v64, v65
  v_lshlrev_b32 v32, 16, v16
  v_and_b32 v33, s45, v16
  v_lshlrev_b32 v34, 16, v17
  v_and_b32 v35, s45, v17
  v_lshlrev_b32 v36, 16, v18
  v_and_b32 v37, s45, v18
  v_lshlrev_b32 v38, 16, v19
  v_and_b32 v39, s45, v19
  v_lshlrev_b32 v40, 16, v20
  v_and_b32 v41, s45, v20
  v_lshlrev_b32 v42, 16, v21
  v_and_b32 v43, s45, v21
  v_lshlrev_b32 v44, 16, v22
  v_and_b32 v45, s45, v22
  v_lshlrev_b32 v46, 16, v23
  v_and_b32 v47, s45, v23
  v_pk_add_f32 v[64:65], v[32:33], v[34:35]
  v_pk_add_f32 v[66:67], v[36:37], v[38:39]
  v_pk_add_f32 v[64:65], v[64:65], v[40:41]
  v_pk_add_f32 v[66:67], v[66:67], v[42:43]
  v_pk_add_f32 v[64:65], v[64:65], v[44:45]
  v_pk_add_f32 v[66:67], v[66:67], v[46:47]
  v_pk_add_f32 v[64:65], v[64:65], v[66:67]
  v_add_f32 v64, v64, v65
  s_nop 1
  v_add_f32_dpp v64, v64, v64 row_ror:8 row_mask:0xf bank_mask:0xf
  v_mov_b32 v65, v64
  s_nop 1
  v_permlane16_swap_b32 v64, v65
  v_add_f32 v64, v64, v65
  v_mov_b32 v65, v64
  s_nop 1
  v_permlane32_swap_b32 v64, v65
  v_add_f32 v64, v64, v65
  ds_write_b32 v6, v64 offset:0
  s_waitcnt lgkmcnt(0)
  s_barrier
  ds_read_b128 v[64:67], v7 offset:0
  s_waitcnt lgkmcnt(0)
  v_add_f32 v64, v64, v65
  v_add_f32 v66, v66, v67
  v_add_f32 v64, v64, v66
  v_mul_f32 v69, 0x3b000000, v64
  v_pk_add_f32 v[66:67], v[32:33], v[68:69] op_sel:[0,1] op_sel_hi:[1,1] neg_lo:[0,1] neg_hi:[0,1]
  v_pk_mul_f32 v[64:65], v[66:67], v[66:67]
  v_pk_add_f32 v[66:67], v[34:35], v[68:69] op_sel:[0,1] op_sel_hi:[1,1] neg_lo:[0,1] neg_hi:[0,1]
  v_pk_fma_f32 v[64:65], v[66:67], v[66:67], v[64:65]
  v_pk_add_f32 v[66:67], v[36:37], v[68:69] op_sel:[0,1] op_sel_hi:[1,1] neg_lo:[0,1] neg_hi:[0,1]
  v_pk_fma_f32 v[64:65], v[66:67], v[66:67], v[64:65]
  v_pk_add_f32 v[66:67], v[38:39], v[68:69] op_sel:[0,1] op_sel_hi:[1,1] neg_lo:[0,1] neg_hi:[0,1]
  v_pk_fma_f32 v[64:65], v[66:67], v[66:67], v[64:65]
  v_pk_add_f32 v[66:67], v[40:41], v[68:69] op_sel:[0,1] op_sel_hi:[1,1] neg_lo:[0,1] neg_hi:[0,1]
  v_pk_fma_f32 v[64:65], v[66:67], v[66:67], v[64:65]
  v_pk_add_f32 v[66:67], v[42:43], v[68:69] op_sel:[0,1] op_sel_hi:[1,1] neg_lo:[0,1] neg_hi:[0,1]
  v_pk_fma_f32 v[64:65], v[66:67], v[66:67], v[64:65]
  v_pk_add_f32 v[66:67], v[44:45], v[68:69] op_sel:[0,1] op_sel_hi:[1,1] neg_lo:[0,1] neg_hi:[0,1]
  v_pk_fma_f32 v[64:65], v[66:67], v[66:67], v[64:65]
  v_pk_add_f32 v[66:67], v[46:47], v[68:69] op_sel:[0,1] op_sel_hi:[1,1] neg_lo:[0,1] neg_hi:[0,1]
  v_pk_fma_f32 v[64:65], v[66:67], v[66:67], v[64:65]
  v_add_f32 v64, v64, v65
  s_nop 1
  v_add_f32_dpp v64, v64, v64 row_ror:8 row_mask:0xf bank_mask:0xf
  v_mov_b32 v65, v64
  s_nop 1
  v_permlane16_swap_b32 v64, v65
  v_add_f32 v64, v64, v65
  v_mov_b32 v65, v64
  s_nop 1
  v_permlane32_swap_b32 v64, v65
  v_add_f32 v64, v64, v65
  ds_write_b32 v6, v64 offset:256
  s_waitcnt lgkmcnt(0)
  s_barrier
  ds_read_b128 v[64:67], v7 offset:256
  s_waitcnt lgkmcnt(0)
  v_add_f32 v64, v64, v65
  v_add_f32 v66, v66, v67
  v_add_f32 v64, v64, v66
  v_mul_f32 v68, 0x3b000000, v64
  v_cvt_pk_bf16_f32 v64, v68, v69
  v_and_b32 v69, s45, v64
  v_lshlrev_b32 v64, 16, v64
  v_add_f32 v64, 0x3727c5ac, v64
  v_cvt_pk_bf16_f32 v64, v64, v64
  v_and_b32 v64, s45, v64
  v_sqrt_f32 v64, v64
  s_nop 0
  v_cvt_pk_bf16_f32 v64, v64, v64
  v_and_b32 v64, s45, v64
  v_rcp_f32 v64, v64
  v_pk_add_f32 v[32:33], v[32:33], v[68:69] op_sel:[0,1] op_sel_hi:[1,1] neg_lo:[0,1] neg_hi:[0,1]
  v_cvt_pk_bf16_f32 v65, v32, v33
  v_lshlrev_b32 v66, 16, v65
  v_and_b32 v67, s45, v65
  v_pk_mul_f32 v[66:67], v[66:67], v[64:65] op_sel_hi:[1,0]
  v_cvt_pk_bf16_f32 v80, v66, v67
  v_pk_add_f32 v[34:35], v[34:35], v[68:69] op_sel:[0,1] op_sel_hi:[1,1] neg_lo:[0,1] neg_hi:[0,1]
  v_cvt_pk_bf16_f32 v65, v34, v35
  v_lshlrev_b32 v66, 16, v65
  v_and_b32 v67, s45, v65
  v_pk_mul_f32 v[66:67], v[66:67], v[64:65] op_sel_hi:[1,0]
  v_cvt_pk_bf16_f32 v81, v66, v67
  v_pk_add_f32 v[36:37], v[36:37], v[68:69] op_sel:[0,1] op_sel_hi:[1,1] neg_lo:[0,1] neg_hi:[0,1]
  v_cvt_pk_bf16_f32 v65, v36, v37
  v_lshlrev_b32 v66, 16, v65
  v_and_b32 v67, s45, v65
  v_pk_mul_f32 v[66:67], v[66:67], v[64:65] op_sel_hi:[1,0]
  v_cvt_pk_bf16_f32 v82, v66, v67
  v_pk_add_f32 v[38:39], v[38:39], v[68:69] op_sel:[0,1] op_sel_hi:[1,1] neg_lo:[0,1] neg_hi:[0,1]
  v_cvt_pk_bf16_f32 v65, v38, v39
  v_lshlrev_b32 v66, 16, v65
  v_and_b32 v67, s45, v65
  v_pk_mul_f32 v[66:67], v[66:67], v[64:65] op_sel_hi:[1,0]
  v_cvt_pk_bf16_f32 v83, v66, v67
  v_pk_add_f32 v[40:41], v[40:41], v[68:69] op_sel:[0,1] op_sel_hi:[1,1] neg_lo:[0,1] neg_hi:[0,1]
  v_cvt_pk_bf16_f32 v65, v40, v41
  v_lshlrev_b32 v66, 16, v65
  v_and_b32 v67, s45, v65
  v_pk_mul_f32 v[66:67], v[66:67], v[64:65] op_sel_hi:[1,0]
  v_cvt_pk_bf16_f32 v84, v66, v67
  v_pk_add_f32 v[42:43], v[42:43], v[68:69] op_sel:[0,1] op_sel_hi:[1,1] neg_lo:[0,1] neg_hi:[0,1]
  v_cvt_pk_bf16_f32 v65, v42, v43
  v_lshlrev_b32 v66, 16, v65
  v_and_b32 v67, s45, v65
  v_pk_mul_f32 v[66:67], v[66:67], v[64:65] op_sel_hi:[1,0]
  v_cvt_pk_bf16_f32 v85, v66, v67
  v_pk_add_f32 v[44:45], v[44:45], v[68:69] op_sel:[0,1] op_sel_hi:[1,1] neg_lo:[0,1] neg_hi:[0,1]
  v_cvt_pk_bf16_f32 v65, v44, v45
  v_lshlrev_b32 v66, 16, v65
  v_and_b32 v67, s45, v65
  v_pk_mul_f32 v[66:67], v[66:67], v[64:65] op_sel_hi:[1,0]
  v_cvt_pk_bf16_f32 v86, v66, v67
  v_pk_add_f32 v[46:47], v[46:47], v[68:69] op_sel:[0,1] op_sel_hi:[1,1] neg_lo:[0,1] neg_hi:[0,1]
  v_cvt_pk_bf16_f32 v65, v46, v47
  v_lshlrev_b32 v66, 16, v65
  v_and_b32 v67, s45, v65
  v_pk_mul_f32 v[66:67], v[66:67], v[64:65] op_sel_hi:[1,0]
  v_cvt_pk_bf16_f32 v87, v66, v67
  s_add_u32 s37, s36, 14680064
  s_add_u32 s38, s36, 10485760
  s_cmp_eq_u32 s47, 0
  s_cbranch_scc1 sf_49
  buffer_store_dwordx4 v[80:83], v5, s[4:7], s37 offen offset:0
  buffer_store_dwordx4 v[84:87], v8, s[4:7], s37 offen offset:0
  buffer_store_dwordx4 v[16:19], v5, s[4:7], s38 offen offset:0
  buffer_store_dwordx4 v[20:23], v8, s[4:7], s38 offen offset:0
  s_waitcnt vmcnt(0)
  s_lshl_b32 s40, s35, 9
  s_add_u32 s40, s40, 327680
  s_add_u32 s40, s40, s33
  s_mov_b64 exec, 1
  buffer_store_dword v4, v3, s[4:7], s40 offen
  s_mov_b64 exec, -1
  s_branch se_50
sf_49:
  buffer_store_dwordx4 v[80:83], v5, s[4:7], s37 offen offset:0 sc1
  buffer_store_dwordx4 v[84:87], v8, s[4:7], s37 offen offset:0 sc1
  buffer_store_dwordx4 v[16:19], v5, s[4:7], s38 offen offset:0 sc1
  buffer_store_dwordx4 v[20:23], v8, s[4:7], s38 offen offset:0 sc1
  s_waitcnt vmcnt(0)
  s_lshl_b32 s40, s35, 9
  s_add_u32 s40, s40, 327680
  s_add_u32 s40, s40, s33
  s_mov_b64 exec, 1
  buffer_store_dword v4, v3, s[4:7], s40 offen sc1
  s_mov_b64 exec, -1
se_50:
  s_add_u32 s35, s35, 2
  s_cmp_lt_u32 s35, s34
  s_cbranch_scc1 L_R1
  s_endpgm
J_R2:
  s_lshl_b32 s40, s28, 13
  v_bfe_u32 v5, v1, 3, 3
  v_lshlrev_b32 v5, 9, v5
  v_bfe_u32 v10, v1, 0, 3
  v_lshl_add_u32 v5, v10, 4, v5
  v_add_u32 v5, s40, v5
  v_bfe_u32 v7, v1, 0, 3
  v_lshlrev_b32 v7, 4, v7
  v_add_u32 v7, 131072, v7
  s_lshl_b32 s40, s28, 2
  v_add_u32 v6, s40, v7
  v_add_u32 v8, 4096, v5
  s_waitcnt vmcnt(0)
  s_barrier
  s_lshl_b32 s40, s31, 2
  s_cmp_lg_u32 s28, 0
  s_cbranch_scc1 ar_51
  s_mov_b64 exec, 1
  buffer_atomic_add v9, v3, s[8:11], s40 offen sc1
  s_mov_b64 exec, -1
ar_51:
  v_and_b32 v11, 7, v1
  v_lshlrev_b32 v11, 2, v11
  s_mov_b32 s42, 0
vf_52:
  buffer_load_dword v10, v11, s[8:11], 0 offen sc0 sc1
  s_add_u32 s42, s42, 1
  s_waitcnt vmcnt(0)
  v_readlane_b32 s43, v10, s31
  v_lshrrev_b32 v10, 22, v10
  v_cmp_ne_u32 vcc, 32, v10
  s_cbranch_vccz vk_53
  s_movk_i32 s41, 1
  s_cmp_gt_u32 s42, 262144
  s_cbranch_scc1 L_fail
  s_sleep 2
  s_branch vf_52
vk_53:
  s_and_b32 s40, s43, 0x1ff
  s_mul_i32 s40, s40, s40
  s_bfe_u32 s41, s43, 0xd0009
  s_lshl_b32 s41, s41, 5
  s_cmp_eq_u32 s40, s41
  s_cselect_b32 s47, 1, 0
  s_sub_u32 s32, s46, 27
  s_lshl_b32 s40, s28, 4
  v_bfe_u32 v9, v1, 0, 2
  v_lshlrev_b32 v9, 2, v9
  v_add_u32 v9, s40, v9
  s_lshl_b32 s33, s32, 4
  s_lshl_b32 s40, s28, 2
  s_add_u32 s33, s33, s40
  s_lshl_b32 s32, s32, 7
  s_lshl_b32 s36, s35, 15
  s_add_u32 s36, s36, s32
  v_mov_b32 v14, 0
L_R2:
  s_lshl_b32 s36, s35, 15
  s_add_u32 s36, s36, s32
  s_lshl_b32 s43, s35, 9
  s_add_u32 s43, s43, 458752
  v_cmp_eq_u32 vcc, 0, v14
  s_cbranch_vccz L_R2_r
  s_mov_b32 s40, 0
poll_54:
  buffer_load_dword v10, v9, s[4:7], s43 offen sc1
  s_add_u32 s40, s40, 1
  s_waitcnt vmcnt(0)
  v_cmp_eq_u32 vcc, 0, v10
  s_cbranch_vccz pd_55
  s_movk_i32 s41, 10
  s_cmp_gt_u32 s40, 262144
  s_cbranch_scc1 L_fail
  s_sleep 1
  s_branch poll_54
pd_55:
L_R2_r:
  s_add_u32 s37, s36, 199229440
  buffer_load_dwordx4 v[16:19], v5, s[4:7], s37 offen offset:0 sc1
  buffer_load_dwordx4 v[20:23], v8, s[4:7], s37 offen offset:0 sc1
  s_waitcnt vmcnt(0)
  s_add_u32 s43, s43, 512
  buffer_load_dword v14, v9, s[4:7], s43 offen sc1
  v_lshlrev_b32 v32, 16, v16
  v_and_b32 v33, s45, v16
  v_lshlrev_b32 v34, 16, v17
  v_and_b32 v35, s45, v17
  v_lshlrev_b32 v36, 16, v18
  v_and_b32 v37, s45, v18
  v_lshlrev_b32 v38, 16, v19
  v_and_b32 v39, s45, v19
  v_lshlrev_b32 v40, 16, v20
  v_and_b32 v41, s45, v20
  v_lshlrev_b32 v42, 16, v21
  v_and_b32 v43, s45, v21
  v_lshlrev_b32 v44, 16, v22
  v_and_b32 v45, s45, v22
  v_lshlrev_b32 v46, 16, v23
  v_and_b32 v47, s45, v23
  v_pk_add_f32 v[64:65], v[32:33], v[34:35]
  v_pk_add_f32 v[66:67], v[36:37], v[38:39]
  v_pk_add_f32 v[64:65], v[64:65], v[40:41]
  v_pk_add_f32 v[66:67], v[66:67], v[42:43]
  v_pk_add_f32 v[64:65], v[64:65], v[44:45]
  v_pk_add_f32 v[66:67], v[66:67], v[46:47]
  v_pk_add_f32 v[64:65], v[64:65], v[66:67]
  v_add_f32 v64, v64, v65
  s_nop 1
  v_add_f32_dpp v64, v64, v64 row_ror:8 row_mask:0xf bank_mask:0xf
  v_mov_b32 v65, v64
  s_nop 1
  v_permlane16_swap_b32 v64, v65
  v_add_f32 v64, v64, v65
  v_mov_b32 v65, v64
  s_nop 1
  v_permlane32_swap_b32 v64, v65
  v_add_f32 v64, v64, v65
  ds_write_b32 v6, v64 offset:0
  s_waitcnt lgkmcnt(0)
  s_barrier
  ds_read_b128 v[64:67], v7 offset:0
  s_waitcnt lgkmcnt(0)
  v_add_f32 v64, v64, v65
  v_add_f32 v66, v66, v67
  v_add_f32 v64, v64, v66
  v_mul_f32 v69, 0x3b000000, v64
  v_pk_add_f32 v[66:67], v[32:33], v[68:69] op_sel:[0,1] op_sel_hi:[1,1] neg_lo:[0,1] neg_hi:[0,1]
  v_pk_mul_f32 v[64:65], v[66:67], v[66:67]
  v_pk_add_f32 v[66:67], v[34:35], v[68:69] op_sel:[0,1] op_sel_hi:[1,1] neg_lo:[0,1] neg_hi:[0,1]
  v_pk_fma_f32 v[64:65], v[66:67], v[66:67], v[64:65]
  v_pk_add_f32 v[66:67], v[36:37], v[68:69] op_sel:[0,1] op_sel_hi:[1,1] neg_lo:[0,1] neg_hi:[0,1]
  v_pk_fma_f32 v[64:65], v[66:67], v[66:67], v[64:65]
  v_pk_add_f32 v[66:67], v[38:39], v[68:69] op_sel:[0,1] op_sel_hi:[1,1] neg_lo:[0,1] neg_hi:[0,1]
  v_pk_fma_f32 v[64:65], v[66:67], v[66:67], v[64:65]
  v_pk_add_f32 v[66:67], v[40:41], v[68:69] op_sel:[0,1] op_sel_hi:[1,1] neg_lo:[0,1] neg_hi:[0,1]
  v_pk_fma_f32 v[64:65], v[66:67], v[66:67], v[64:65]
  v_pk_add_f32 v[66:67], v[42:43], v[68:69] op_sel:[0,1] op_sel_hi:[1,1] neg_lo:[0,1] neg_hi:[0,1]
  v_pk_fma_f32 v[64:65], v[66:67], v[66:67], v[64:65]
  v_pk_add_f32 v[66:67], v[44:45], v[68:69] op_sel:[0,1] op_sel_hi:[1,1] neg_lo:[0,1] neg_hi:[0,1]
  v_pk_fma_f32 v[64:65], v[66:67], v[66:67], v[64:65]
  v_pk_add_f32 v[66:67], v[46:47], v[68:69] op_sel:[0,1] op_sel_hi:[1,1] neg_lo:[0,1] neg_hi:[0,1]
  v_pk_fma_f32 v[64:65], v[66:67], v[66:67], v[64:65]
  v_add_f32 v64, v64, v65
  s_nop 1
  v_add_f32_dpp v64, v64, v64 row_ror:8 row_mask:0xf bank_mask:0xf
  v_mov_b32 v65, v64
  s_nop 1
  v_permlane16_swap_b32 v64, v65
  v_add_f32 v64, v64, v65
  v_mov_b32 v65, v64
  s_nop 1
  v_permlane32_swap_b32 v64, v65
  v_add_f32 v64, v64, v65
  ds_write_b32 v6, v64 offset:256
  s_waitcnt lgkmcnt(0)
  s_barrier
  ds_read_b128 v[64:67], v7 offset:256
  s_waitcnt lgkmcnt(0)
  v_add_f32 v64, v64, v65
  v_add_f32 v66, v66, v67
  v_add_f32 v64, v64, v66
  v_mul_f32 v68, 0x3b000000, v64
  v_cvt_pk_bf16_f32 v64, v68, v69
  v_and_b32 v69, s45, v64
  v_lshlrev_b32 v64, 16, v64
  v_add_f32 v64, 0x3727c5ac, v64
  v_cvt_pk_bf16_f32 v64, v64, v64
  v_and_b32 v64, s45, v64
  v_sqrt_f32 v64, v64
  s_nop 0
  v_cvt_pk_bf16_f32 v64, v64, v64
  v_and_b32 v64, s45, v64
  v_rcp_f32 v64, v64
  v_pk_add_f32 v[32:33], v[32:33], v[68:69] op_sel:[0,1] op_sel_hi:[1,1] neg_lo:[0,1] neg_hi:[0,1]
  v_cvt_pk_bf16_f32 v65, v32, v33
  v_lshlrev_b32 v66, 16, v65
  v_and_b32 v67, s45, v65
  v_pk_mul_f32 v[66:67], v[66:67], v[64:65] op_sel_hi:[1,0]
  v_cvt_pk_bf16_f32 v80, v66, v67
  v_pk_add_f32 v[34:35], v[34:35], v[68:69] op_sel:[0,1] op_sel_hi:[1,1] neg_lo:[0,1] neg_hi:[0,1]
  v_cvt_pk_bf16_f32 v65, v34, v35
  v_lshlrev_b32 v66, 16, v65
  v_and_b32 v67, s45, v65
  v_pk_mul_f32 v[66:67], v[66:67], v[64:65] op_sel_hi:[1,0]
  v_cvt_pk_bf16_f32 v81, v66, v67
  v_pk_add_f32 v[36:37], v[36:37], v[68:69] op_sel:[0,1] op_sel_hi:[1,1] neg_lo:[0,1] neg_hi:[0,1]
  v_cvt_pk_bf16_f32 v65, v36, v37
  v_lshlrev_b32 v66, 16, v65
  v_and_b32 v67, s45, v65
  v_pk_mul_f32 v[66:67], v[66:67], v[64:65] op_sel_hi:[1,0]
  v_cvt_pk_bf16_f32 v82, v66, v67
  v_pk_add_f32 v[38:39], v[38:39], v[68:69] op_sel:[0,1] op_sel_hi:[1,1] neg_lo:[0,1] neg_hi:[0,1]
  v_cvt_pk_bf16_f32 v65, v38, v39
  v_lshlrev_b32 v66, 16, v65
  v_and_b32 v67, s45, v65
  v_pk_mul_f32 v[66:67], v[66:67], v[64:65] op_sel_hi:[1,0]
  v_cvt_pk_bf16_f32 v83, v66, v67
  v_pk_add_f32 v[40:41], v[40:41], v[68:69] op_sel:[0,1] op_sel_hi:[1,1] neg_lo:[0,1] neg_hi:[0,1]
  v_cvt_pk_bf16_f32 v65, v40, v41
  v_lshlrev_b32 v66, 16, v65
  v_and_b32 v67, s45, v65
  v_pk_mul_f32 v[66:67], v[66:67], v[64:65] op_sel_hi:[1,0]
  v_cvt_pk_bf16_f32 v84, v66, v67
  v_pk_add_f32 v[42:43], v[42:43], v[68:69] op_sel:[0,1] op_sel_hi:[1,1] neg_lo:[0,1] neg_hi:[0,1]
  v_cvt_pk_bf16_f32 v65, v42, v43
  v_lshlrev_b32 v66, 16, v65
  v_and_b32 v67, s45, v65
  v_pk_mul_f32 v[66:67], v[66:67], v[64:65] op_sel_hi:[1,0]
  v_cvt_pk_bf16_f32 v85, v66, v67
  v_pk_add_f32 v[44:45], v[44:45], v[68:69] op_sel:[0,1] op_sel_hi:[1,1] neg_lo:[0,1] neg_hi:[0,1]
  v_cvt_pk_bf16_f32 v65, v44, v45
  v_lshlrev_b32 v66, 16, v65
  v_and_b32 v67, s45, v65
  v_pk_mul_f32 v[66:67], v[66:67], v[64:65] op_sel_hi:[1,0]
  v_cvt_pk_bf16_f32 v86, v66, v67
  v_pk_add_f32 v[46:47], v[46:47], v[68:69] op_sel:[0,1] op_sel_hi:[1,1] neg_lo:[0,1] neg_hi:[0,1]
  v_cvt_pk_bf16_f32 v65, v46, v47
  v_lshlrev_b32 v66, 16, v65
  v_and_b32 v67, s45, v65
  v_pk_mul_f32 v[66:67], v[66:67], v[64:65] op_sel_hi:[1,0]
  v_cvt_pk_bf16_f32 v87, v66, v67
  s_add_u32 s37, s36, 4194304
  s_add_u32 s38, s36, 8388608
  buffer_store_dwordx4 v[80:83], v5, s[4:7], s37 offen offset:0 sc1
  buffer_store_dwordx4 v[84:87], v8, s[4:7], s37 offen offset:0 sc1
  buffer_store_dwordx4 v[16:19], v5, s[4:7], s38 offen offset:0 sc1
  buffer_store_dwordx4 v[20:23], v8, s[4:7], s38 offen offset:0 sc1
  s_waitcnt vmcnt(0)
  s_add_u32 s37, s35, 64
  s_lshl_b32 s40, s37, 9
  s_add_u32 s40, s40, 0
  s_add_u32 s40, s40, s33
  s_mov_b64 exec, 1
  buffer_store_dword v4, v3, s[4:7], s40 offen sc1
  s_mov_b64 exec, -1
  s_add_u32 s35, s35, 1
  s_cmp_lt_u32 s35, s34
  s_cbranch_scc1 L_R2
  s_endpgm
L_fail:
  s_mov_b64 exec, 1
  v_mov_b32 v12, s41
  v_mov_b32 v13, s29
  v_mov_b32 v14, s35
  v_mov_b32 v15, s28
  v_mov_b32 v3, 0
  buffer_store_dwordx4 v[12:15], v3, s[8:11], 0 offen offset:128
  s_waitcnt vmcnt(0)
L_end:
  s_endpgm
.section .rodata,"a"
.p2align 6
.amdhsa_kernel interleave_layers__memory_aug_recurrent_mem_tr__glu_gated_bilinear__prompt_kernel
  .amdhsa_next_free_vgpr 512
  .amdhsa_next_free_sgpr 102
  .amdhsa_accum_offset 256
  .amdhsa_group_segment_fixed_size 0
  .amdhsa_kernarg_size 112
  .amdhsa_user_sgpr_count 2
  .amdhsa_user_sgpr_kernarg_segment_ptr 1
  .amdhsa_system_sgpr_workgroup_id_x 1
.end_amdhsa_kernel
```
